```python
import torch

def _softmax(x, axis=-1):
    return torch.softmax(x, dim=axis)
def _gelu(x):
    return torch.nn.functional.gelu(x, approximate="tanh")
def _silu(x):
    return torch.nn.functional.silu(x)
def _sigmoid(x):
    return torch.sigmoid(x)
def _layernorm(x, axis=-1, eps=1e-5):
    m = x.mean(dim=axis, keepdim=True)
    v = x.var(dim=axis, keepdim=True, unbiased=False)
    return (x - m) / torch.sqrt(v + eps)
def _scatter_add(tgt, idx, src, axis=0):
    return tgt.clone().index_add_(axis, idx, src)
def _segment_sum(src, seg, n):
    out = torch.zeros((n,) + src.shape[1:], dtype=src.dtype)
    return out.index_add_(0, seg, src)
def _pad(x, pw):
    flat = tuple(v for pair in reversed(pw) for v in pair)
    return torch.nn.functional.pad(x, flat)

kernel_name = 'interleave_layers__mha_block_cached__compressed_kv_cla__decode'

def setup_inputs():

    _w = (lambda a: (lambda t: t.to(torch.bfloat16) if t.is_floating_point() else t)(torch.as_tensor(a)))
    def _A_setup():
        B, Sq, D = 1, 1, 576
        H, Sk, Dh = 32, 8192, 128
        return {
            "x": _w((lambda *s: torch.randn(*s, dtype=torch.bfloat16) * 0.05)(B, Sq, D)),
            "k_cache": _w((lambda *s: torch.randn(*s, dtype=torch.bfloat16) * 0.8)(B, H, Sk, Dh)),
            "v_cache": _w((lambda *s: torch.randn(*s, dtype=torch.bfloat16) * 1.6)(B, H, Sk, Dh)),
            "wq": _w((lambda *s: torch.randn(*s, dtype=torch.bfloat16) * 0.8)(D, H * Dh) * (D ** -0.5)),
            "wo": _w((lambda *s: torch.randn(*s, dtype=torch.bfloat16) * 1.6)(H * Dh, D) * ((H * Dh) ** -0.5)),
        }
    _A_in = _A_setup()

    def _B_setup():
        B, H, Sq, Sk, D, M = 1, 32, 1, 8192, 128, 576
        Dc = 4 * D
        return {
            "x": _w((lambda *s: torch.randn(*s, dtype=torch.bfloat16) * 0.05)(B, Sq, M)),
            "c_kv": _w((lambda *s: torch.randn(*s, dtype=torch.bfloat16) * 0.4)(B, Sk, Dc)),
            "w_q": _w((lambda *s: torch.randn(*s, dtype=torch.bfloat16) * 3.2)(M, H, D) * (M ** -0.5)),
            "w_uk": _w((lambda *s: torch.randn(*s, dtype=torch.bfloat16) * 3.2)(Dc, H, D) * (Dc ** -0.5)),
            "w_uv": _w((lambda *s: torch.randn(*s, dtype=torch.bfloat16) * 0.4)(Dc, H, D) * (Dc ** -0.5)),
            "w_o": _w((lambda *s: torch.randn(*s, dtype=torch.bfloat16) * 0.4)(H, D, M) * ((H * D) ** -0.5)),
        }
    _B_in = _B_setup()

    return {
        "A_x": _A_in["x"],
        "A_k_cache": _A_in["k_cache"],
        "A_v_cache": _A_in["v_cache"],
        "A_wq": _A_in["wq"],
        "A_wo": _A_in["wo"],
        "B_x": _B_in["x"],
        "B_c_kv": _B_in["c_kv"],
        "B_w_q": _B_in["w_q"],
        "B_w_uk": _B_in["w_uk"],
        "B_w_uv": _B_in["w_uv"],
        "B_w_o": _B_in["w_o"],
    }

def reference(A_x, A_k_cache, A_v_cache, A_wq, A_wo, B_x, B_c_kv, B_w_q, B_w_uk, B_w_uv, B_w_o):
    def _A_ref(x, k_cache, v_cache, wq, wo):
        B, Sq, D = x.shape
        H, Dh = 32, 128
        q = (lambda x, *d: x.permute(*d))((x @ wq).reshape(B, Sq, H, Dh), 0, 2, 1, 3)
        scores = torch.einsum("bhqd,bhkd->bhqk", q, k_cache) * (Dh ** -0.5)
        p = _softmax(scores, axis=-1)
        o = torch.einsum("bhqk,bhkd->bhqd", p, v_cache)
        return (lambda x, *d: x.permute(*d))(o, 0, 2, 1, 3).reshape(B, Sq, H * Dh) @ wo

    def _B_ref(x, c_kv, w_q, w_uk, w_uv, w_o):
        B, Sq, M = x.shape[0], x.shape[1], x.shape[2]
        Sk = c_kv.shape[1]
        H, D = w_q.shape[1], w_q.shape[2]
        q = torch.einsum("bqm,mhd->bhqd", x, w_q)
        k = torch.einsum("bkc,chd->bhkd", c_kv, w_uk)
        v = torch.einsum("bkc,chd->bhkd", c_kv, w_uv)
        scores = torch.einsum("bhqd,bhkd->bhqk", q, k) * (D ** -0.5)
        off = Sk - Sq
        qi = torch.arange(Sq)[:, None]
        kj = torch.arange(Sk)[None, :]
        cmask = kj <= (qi + off)
        scores = torch.where(cmask[None, None], scores, -1e9)
        p = _softmax(scores, axis=-1)
        ctx = torch.einsum("bhqk,bhkd->bhqd", p, v)
        return torch.einsum("bhqd,hdm->bqm", ctx, w_o)

    x = A_x
    x = x + _A_ref(_layernorm(x, axis=-1), A_k_cache, A_v_cache, A_wq, A_wo)
    x = x + _B_ref(_layernorm(x, axis=-1), B_c_kv, B_w_q, B_w_uk, B_w_uv, B_w_o)
    x = x + _A_ref(_layernorm(x, axis=-1), A_k_cache, A_v_cache, A_wq, A_wo)
    x = x + _B_ref(_layernorm(x, axis=-1), B_c_kv, B_w_q, B_w_uk, B_w_uv, B_w_o)
    return x
```

```asm
; @launch grid=(256,1,1) block=(256,1,1) lds=163840
.amdgcn_target "amdgcn-amd-amdhsa--gfx950"
.text
.globl interleave_layers__mha_block_cached__compressed_kv_cla__decode_kernel
.p2align 8
.type interleave_layers__mha_block_cached__compressed_kv_cla__decode_kernel,@function
interleave_layers__mha_block_cached__compressed_kv_cla__decode_kernel:
    s_cmp_ge_u32 s2, 256
    s_cbranch_scc0 L_go
L_abort:
    s_endpgm
L_go:
    s_load_dwordx2 s[4:5], s[0:1], 8
    s_load_dwordx2 s[40:41], s[0:1], 104
    v_lshrrev_b32 v1, 6, v0
    v_lshlrev_b32 v12, 4, v0
    v_and_b32 v0, 63, v0
    v_readfirstlane_b32 s3, v1
    s_and_b32 s60, s2, 7
    s_lshr_b32 s61, s2, 3
    s_lshl_b32 s64, s60, 5
    s_add_u32 s64, s64, s61
    s_lshr_b32 s62, s64, 3
    s_and_b32 s63, s61, 7
    s_mov_b32 s64, s62
    s_lshl_b32 s64, s64, 21
    s_bfe_u32 s70, s3, 65536
    s_lshl_b32 s70, s70, 13
    s_add_u32 s64, s64, s70
    s_bfe_u32 s70, s3, 65537
    s_lshl_b32 s70, s70, 14
    s_add_u32 s64, s64, s70
    s_bfe_u32 s70, s63, 65536
    s_lshl_b32 s70, s70, 17
    s_add_u32 s64, s64, s70
    s_bfe_u32 s70, s63, 65537
    s_lshl_b32 s70, s70, 20
    s_add_u32 s64, s64, s70
    s_bfe_u32 s70, s63, 65538
    s_lshl_b32 s70, s70, 19
    s_add_u32 s64, s64, s70
    v_bfe_u32 v72, v0, 3, 1
    v_lshlrev_b32 v72, 6, v72
    v_lshrrev_b32 v73, 4, v0
    v_lshl_add_u32 v72, v73, 4, v72
    v_bfe_u32 v73, v0, 0, 1
    v_lshl_add_u32 v72, v73, 16, v72
    v_bfe_u32 v73, v0, 1, 1
    v_lshl_add_u32 v72, v73, 11, v72
    v_bfe_u32 v73, v0, 2, 1
    v_lshl_add_u32 v72, v73, 12, v72
    v_mov_b32 v8, -1
    v_mov_b32 v9, -1
    v_mov_b32 v10, -1
    v_mov_b32 v11, -1
    s_mov_b32 s101, 0
    s_lshl_b32 s81, s60, 5
    s_add_u32 s81, s81, s61
    s_lshl_b32 s81, s81, 10
    s_mov_b32 s6, 0x4000000
    s_mov_b32 s7, 0x20000
    s_mov_b32 s42, 0x10000000
    s_mov_b32 s43, 0x20000
    s_waitcnt lgkmcnt(0)
    s_xor_b32 s78, s64, 0
    buffer_load_dwordx4 a[0:3], v72, s[4:7], s78 offen offset:0 nt
    buffer_load_dwordx4 a[4:7], v72, s[4:7], s78 offen offset:128 nt
    s_cmp_lg_u32 s3, 0
    s_cbranch_scc1 L_noclr_1
    s_xor_b32 s75, s81, 0
    buffer_store_dwordx4 v[8:11], v12, s[40:43], s75 offen sc1
    s_xor_b32 s75, s81, 270336
    buffer_store_dwordx4 v[8:11], v12, s[40:43], s75 offen sc1
    s_xor_b32 s75, s81, 540672
    buffer_store_dwordx4 v[8:11], v12, s[40:43], s75 offen sc1
    s_xor_b32 s75, s81, 811008
    buffer_store_dwordx4 v[8:11], v12, s[40:43], s75 offen sc1
L_noclr_1:
    buffer_load_dwordx4 a[8:11], v72, s[4:7], s78 offen offset:256 nt
    buffer_load_dwordx4 a[12:15], v72, s[4:7], s78 offen offset:384 nt
    buffer_load_dwordx4 a[16:19], v72, s[4:7], s78 offen offset:512 nt
    buffer_load_dwordx4 a[20:23], v72, s[4:7], s78 offen offset:640 nt
    s_load_dwordx2 s[8:9], s[0:1], 16
    s_mov_b32 s10, 0x4000000
    s_mov_b32 s11, 0x20000
    s_load_dwordx2 s[44:45], s[0:1], 0
    s_mov_b32 s46, 0x480
    s_mov_b32 s47, 0x20000
    s_load_dwordx2 s[12:13], s[0:1], 24
    s_mov_b32 s14, 0x480000
    s_mov_b32 s15, 0x20000
    s_load_dwordx2 s[52:53], s[0:1], 96
    s_mov_b32 s54, 0x100
    s_mov_b32 s55, 0x20000
    s_load_dwordx2 s[16:17], s[0:1], 32
    s_mov_b32 s18, 0x480000
    s_mov_b32 s19, 0x20000
    s_load_dwordx2 s[20:21], s[0:1], 48
    s_mov_b32 s22, 0x800000
    s_mov_b32 s23, 0x20000
    s_load_dwordx2 s[24:25], s[0:1], 56
    s_mov_b32 s26, 0x480000
    s_mov_b32 s27, 0x20000
    s_load_dwordx2 s[28:29], s[0:1], 64
    s_mov_b32 s30, 0x400000
    s_mov_b32 s31, 0x20000
    s_load_dwordx2 s[32:33], s[0:1], 72
    s_mov_b32 s34, 0x400000
    s_mov_b32 s35, 0x20000
    s_load_dwordx2 s[36:37], s[0:1], 80
    s_mov_b32 s38, 0x480000
    s_mov_b32 s39, 0x20000
    s_load_dwordx2 s[48:49], s[0:1], 88
    s_mov_b32 s50, 0x480
    s_mov_b32 s51, 0x20000
    s_mul_i32 s65, s3, 20480
    s_lshl_b32 s66, s3, 14
    s_add_u32 s66, s66, 81920
    s_lshl_b32 s88, s3, 12
    s_add_u32 s88, s88, 147456
    s_cmp_lt_u32 s63, 6
    s_cselect_b32 s67, 0, 1073741824
    s_cmp_lt_u32 s61, 18
    s_cselect_b32 s68, 0, 1073741824
    s_cmp_eq_u32 s3, 0
    s_cselect_b32 s89, 0, 1073741824
    s_bfe_u32 s86, s61, 0x10003
    s_lshr_b32 s87, s61, 4
    s_lshl_b32 s87, s87, 3
    s_add_u32 s87, s87, s63
    s_mul_i32 s98, s63, 786432
    s_lshr_b32 s71, s64, 21
    s_lshl_b32 s71, s71, 8
    s_add_u32 s98, s98, s71
    s_lshl_b32 s71, s3, 6
    s_add_u32 s98, s98, s71
    s_and_b32 s71, s61, 1
    s_lshl_b32 s99, s60, 1
    s_add_u32 s99, s99, s71
    s_lshl_b32 s99, s99, 1
    s_lshr_b32 s71, s3, 1
    s_add_u32 s72, s99, s71
    s_mov_b32 s99, s72
    s_mul_i32 s99, s99, 147456
    s_and_b32 s71, s61, 30
    s_and_b32 s72, s3, 1
    s_add_u32 s71, s71, s72
    s_lshl_b32 s71, s71, 6
    s_add_u32 s99, s99, s71
    s_and_b32 s93, s60, 3
    s_lshl_b32 s93, s93, 4
    s_add_u32 s93, s93, s87
    s_lshl_b32 s93, s93, 17
    s_lshl_b32 s71, s3, 8
    s_add_u32 s93, s93, s71
    s_lshr_b32 s71, s60, 2
    s_lshl_b32 s71, s71, 13
    s_add_u32 s93, s93, s71
    s_lshl_b32 s58, s60, 17
    s_add_u32 s58, s58, 1572864
    s_mul_i32 s59, s60, 62464
    s_add_u32 s59, s59, 0
    s_sub_u32 s59, s59, s58
    s_getreg_b32 s69, hwreg(HW_REG_XCC_ID, 0, 3)
    s_and_b32 s70, s69, 3
    s_lshl_b32 s70, s70, 3
    s_lshl_b32 s70, 1, s70
    v_mov_b32 v16, s70
    s_lshr_b32 s71, s69, 2
    s_lshl_b32 s72, s60, 1
    s_add_u32 s79, s71, s72
    s_lshl_b32 s71, s71, 2
    s_lshl_b32 s72, s60, 5
    s_add_u32 s71, s71, s72
    s_add_u32 s71, s71, s89
    v_mov_b32 v17, 1073741824
    v_writelane_b32 v17, s71, 0
    s_mov_b32 s101, 0
    s_waitcnt lgkmcnt(0)
    v_and_b32 v13, 3, v0
    v_lshlrev_b32 v13, 6, v13
    v_lshrrev_b32 v14, 4, v0
    v_lshl_add_u32 v13, v14, 4, v13
    v_add_u32 v13, s67, v13
    s_mul_i32 s70, s63, 192
    v_mov_b32 v76, 0x3f803f80
    v_mov_b32 v77, 0x3f803f80
    v_mov_b32 v78, 0x3f803f80
    v_mov_b32 v79, 0x3f803f80
    s_mov_b32 exec_lo, 0x77777777
    s_mov_b32 exec_hi, 0x77777777
    buffer_load_dwordx4 v[76:79], v13, s[44:47], s70 offen
    s_mov_b64 exec, -1
    v_and_b32 v13, 7, v0
    v_lshlrev_b32 v13, 3, v13
    v_lshl_add_u32 v13, v14, 1, v13
    v_lshl_add_u32 v13, s3, 6, v13
    s_cmp_eq_u32 s3, 3
    s_cselect_b32 s71, 1073741824, s67
    s_cselect_b32 s72, 1.0, 0
    v_add_u32 v13, s71, v13
    buffer_load_ushort v4, v13, s[44:47], s70 offen
    v_lshrrev_b32 v2, 5, v0
    v_lshlrev_b32 v2, 9, v2
    v_bfe_u32 v7, v0, 2, 3
    v_lshl_add_u32 v2, v7, 6, v2
    v_bfe_u32 v7, v0, 4, 1
    v_lshl_add_u32 v2, v7, 5, v2
    v_and_b32 v7, 3, v0
    v_lshl_add_u32 v2, v7, 3, v2
    v_add_u32 v2, s66, v2
    v_xor_b32 v7, 32, v2
    v_lshlrev_b32 v14, 12, v0
    s_lshr_b32 s90, s2, 2
    s_cmp_eq_u32 s90, 63
    s_cselect_b32 s90, s89, 1073741824
    v_add_u32 v14, s90, v14
    s_and_b32 s90, s93, 0xffe00000
    s_mov_b64 exec, 0xff
    buffer_load_dword v71, v14, s[20:23], s90 offen
    s_mov_b64 exec, -1
    s_cmp_lg_u32 s101, 0
    s_cbranch_scc1 L_lag_2
    s_waitcnt vmcnt(7)
L_lag_2:
    buffer_load_dwordx4 a[24:27], v72, s[4:7], s78 offen offset:768 nt
    buffer_load_dwordx4 a[28:31], v72, s[4:7], s78 offen offset:896 nt
    s_xor_b32 s78, s64, 40960
    s_waitcnt vmcnt(9)
    s_cmp_lg_u32 s101, 0
    s_cbranch_scc1 L_lag_3
    s_waitcnt vmcnt(7)
L_lag_3:
    buffer_load_dwordx4 a[32:35], v72, s[4:7], s78 offen offset:0 nt
    buffer_load_dwordx4 a[36:39], v72, s[4:7], s78 offen offset:128 nt
    s_waitcnt vmcnt(9)
    s_cmp_lg_u32 s101, 0
    s_cbranch_scc1 L_lag_4
    s_waitcnt vmcnt(7)
L_lag_4:
    buffer_atomic_add v16, v17, s[52:55], 0 offen sc1
    buffer_load_dwordx4 a[40:43], v72, s[4:7], s78 offen offset:256 nt
    buffer_load_dwordx4 a[44:47], v72, s[4:7], s78 offen offset:384 nt
    v_bfe_u32 v14, v0, 4, 1
    v_bfe_u32 v15, v0, 2, 2
    v_lshl_add_u32 v14, v14, 3, v15
    v_mul_u32_u24 v14, 8192, v14
    v_lshrrev_b32 v15, 5, v0
    v_lshl_add_u32 v14, v15, 6, v14
    v_bfe_u32 v15, v0, 4, 1
    v_lshlrev_b32 v15, 1, v15
    v_xor_b32 v15, v0, v15
    v_and_b32 v15, 3, v15
    v_lshl_add_u32 v14, v15, 4, v14
    s_and_b32 s90, s3, 1
    s_mul_i32 s90, s90, 131008
    s_add_u32 s90, s90, s67
    v_add_u32 v14, s90, v14
    s_add_u32 m0, s66, 6144
    s_add_u32 s91, s98, 0
    buffer_load_dwordx4 v14, s[12:15], s91 offen  lds
    s_add_u32 m0, s66, 7168
    s_add_u32 s91, s98, 32768
    buffer_load_dwordx4 v14, s[12:15], s91 offen  lds
    s_add_u32 m0, s66, 8192
    s_add_u32 s91, s98, 262144
    buffer_load_dwordx4 v14, s[12:15], s91 offen  lds
    s_add_u32 m0, s66, 9216
    s_add_u32 s91, s98, 294912
    buffer_load_dwordx4 v14, s[12:15], s91 offen  lds
    s_add_u32 m0, s66, 10240
    s_add_u32 s91, s98, 524288
    buffer_load_dwordx4 v14, s[12:15], s91 offen  lds
    s_add_u32 m0, s66, 11264
    s_add_u32 s91, s98, 557056
    buffer_load_dwordx4 v14, s[12:15], s91 offen  lds
    s_waitcnt vmcnt(16)
    s_cmp_lg_u32 s101, 0
    s_cbranch_scc1 L_lag_5
    s_waitcnt vmcnt(11)
L_lag_5:
    buffer_load_dwordx4 a[48:51], v72, s[4:7], s78 offen offset:512 nt
    buffer_load_dwordx4 a[52:55], v72, s[4:7], s78 offen offset:640 nt
    s_waitcnt vmcnt(13)
    s_cmp_lg_u32 s101, 0
    s_cbranch_scc1 L_lag_6
    s_waitcnt vmcnt(11)
L_lag_6:
    buffer_load_dwordx4 a[56:59], v72, s[4:7], s78 offen offset:768 nt
    buffer_load_dwordx4 a[60:63], v72, s[4:7], s78 offen offset:896 nt
    s_xor_b32 s78, s64, 1024
    s_waitcnt vmcnt(13)
    s_cmp_lg_u32 s101, 0
    s_cbranch_scc1 L_lag_7
    s_waitcnt vmcnt(10)
L_lag_7:
    buffer_load_dwordx4 a[64:67], v72, s[4:7], s78 offen offset:0 nt
    buffer_load_dwordx4 a[68:71], v72, s[4:7], s78 offen offset:128 nt
    s_waitcnt vmcnt(12)
    s_cmp_lg_u32 s101, 0
    s_cbranch_scc1 L_lag_8
    s_waitcnt vmcnt(4)
L_lag_8:
    buffer_load_dwordx4 a[72:75], v72, s[4:7], s78 offen offset:256 nt
    buffer_load_dwordx4 a[76:79], v72, s[4:7], s78 offen offset:384 nt
    v_bfe_u32 v14, v0, 4, 1
    v_bfe_u32 v15, v0, 2, 2
    v_lshl_add_u32 v14, v14, 3, v15
    v_mul_u32_u24 v14, 8192, v14
    v_lshrrev_b32 v15, 5, v0
    v_lshl_add_u32 v14, v15, 6, v14
    v_bfe_u32 v15, v0, 4, 1
    v_lshlrev_b32 v15, 1, v15
    v_xor_b32 v15, v0, v15
    v_and_b32 v15, 3, v15
    v_lshl_add_u32 v14, v15, 4, v14
    s_and_b32 s90, s3, 1
    s_mul_i32 s90, s90, 131008
    s_add_u32 s90, s90, s67
    v_add_u32 v14, s90, v14
    s_add_u32 m0, s66, 0
    s_add_u32 s91, s98, 0
    buffer_load_dwordx4 v14, s[24:27], s91 offen  lds
    s_add_u32 m0, s66, 1024
    s_add_u32 s91, s98, 32768
    buffer_load_dwordx4 v14, s[24:27], s91 offen  lds
    s_add_u32 m0, s66, 2048
    s_add_u32 s91, s98, 262144
    buffer_load_dwordx4 v14, s[24:27], s91 offen  lds
    s_add_u32 m0, s66, 3072
    s_add_u32 s91, s98, 294912
    buffer_load_dwordx4 v14, s[24:27], s91 offen  lds
    s_add_u32 m0, s66, 4096
    s_add_u32 s91, s98, 524288
    buffer_load_dwordx4 v14, s[24:27], s91 offen  lds
    s_add_u32 m0, s66, 5120
    s_add_u32 s91, s98, 557056
    buffer_load_dwordx4 v14, s[24:27], s91 offen  lds
    s_waitcnt vmcnt(12)
    s_cmp_lg_u32 s101, 0
    s_cbranch_scc1 L_lag_9
    s_waitcnt vmcnt(10)
L_lag_9:
    buffer_load_dwordx4 a[80:83], v72, s[4:7], s78 offen offset:512 nt
    buffer_load_dwordx4 a[84:87], v72, s[4:7], s78 offen offset:640 nt
    s_waitcnt vmcnt(12)
    s_cmp_lg_u32 s101, 0
    s_cbranch_scc1 L_lag_10
    s_waitcnt vmcnt(10)
L_lag_10:
    buffer_load_dwordx4 a[88:91], v72, s[4:7], s78 offen offset:768 nt
    buffer_load_dwordx4 a[92:95], v72, s[4:7], s78 offen offset:896 nt
    s_xor_b32 s78, s64, 41984
    s_waitcnt vmcnt(12)
    s_cmp_lg_u32 s101, 0
    s_cbranch_scc1 L_lag_11
    s_waitcnt vmcnt(10)
L_lag_11:
    buffer_load_dwordx4 a[96:99], v72, s[4:7], s78 offen offset:0 nt
    buffer_load_dwordx4 a[100:103], v72, s[4:7], s78 offen offset:128 nt
    s_waitcnt vmcnt(12)
    s_cmp_lg_u32 s101, 0
    s_cbranch_scc1 L_lag_12
    s_waitcnt vmcnt(4)
L_lag_12:
    buffer_load_dwordx4 a[104:107], v72, s[4:7], s78 offen offset:256 nt
    buffer_load_dwordx4 a[108:111], v72, s[4:7], s78 offen offset:384 nt
    buffer_load_dwordx4 a[112:115], v72, s[4:7], s78 offen offset:512 nt
    buffer_load_dwordx4 a[116:119], v72, s[4:7], s78 offen offset:640 nt
    buffer_load_dwordx4 a[120:123], v72, s[4:7], s78 offen offset:768 nt
    buffer_load_dwordx4 a[124:127], v72, s[4:7], s78 offen offset:896 nt
    s_waitcnt vmcnt(12)
    v_lshl_or_b32 v4, v4, 16, s72
    s_barrier
    v_lshrrev_b32 v64, 5, v0
    s_and_b32 s90, s3, 1
    v_subrev_u32 v64, s90, v64
    v_mul_i32_i24 v64, 15872, v64
    v_add_u32 v64, v64, v2
    v_xor_b32 v65, 32, v64
    ds_read_b64_tr_b16 v[36:37], v64 offset:0
    ds_read_b64_tr_b16 v[38:39], v64 offset:1024
    ds_read_b64_tr_b16 v[40:41], v65 offset:0
    ds_read_b64_tr_b16 v[42:43], v65 offset:1024
    ds_read_b64_tr_b16 v[44:45], v64 offset:2048
    ds_read_b64_tr_b16 v[46:47], v64 offset:3072
    ds_read_b64_tr_b16 v[48:49], v65 offset:2048
    ds_read_b64_tr_b16 v[50:51], v65 offset:3072
    ds_read_b64_tr_b16 v[52:53], v64 offset:4096
    ds_read_b64_tr_b16 v[54:55], v64 offset:5120
    ds_read_b64_tr_b16 v[56:57], v65 offset:4096
    ds_read_b64_tr_b16 v[58:59], v65 offset:5120
    s_waitcnt lgkmcnt(0)
    v_mfma_f32_16x16x32_bf16 v[8:11], v[76:79], v[36:39], 0
    v_mfma_f32_16x16x32_bf16 v[12:15], v[76:79], v[40:43], 0
    v_mfma_f32_16x16x32_bf16 v[16:19], v[76:79], v[44:47], 0
    v_mfma_f32_16x16x32_bf16 v[20:23], v[76:79], v[48:51], 0
    v_mfma_f32_16x16x32_bf16 v[24:27], v[76:79], v[52:55], 0
    v_mfma_f32_16x16x32_bf16 v[28:31], v[76:79], v[56:59], 0
    s_nop 4
    v_add_f32 v62, v11, v19
    v_add_f32 v63, v15, v23
    v_add_f32 v62, v62, v27
    v_add_f32 v63, v63, v31
    v_lshrrev_b32 v64, 5, v0
    s_and_b32 s90, s3, 1
    v_subrev_u32 v64, s90, v64
    v_mul_i32_i24 v64, 15872, v64
    v_add_u32 v64, v64, v2
    v_xor_b32 v65, 32, v64
    ds_read_b64_tr_b16 v[36:37], v64 offset:6144
    ds_read_b64_tr_b16 v[38:39], v64 offset:7168
    ds_read_b64_tr_b16 v[40:41], v65 offset:6144
    ds_read_b64_tr_b16 v[42:43], v65 offset:7168
    ds_read_b64_tr_b16 v[44:45], v64 offset:8192
    ds_read_b64_tr_b16 v[46:47], v64 offset:9216
    ds_read_b64_tr_b16 v[48:49], v65 offset:8192
    ds_read_b64_tr_b16 v[50:51], v65 offset:9216
    ds_read_b64_tr_b16 v[52:53], v64 offset:10240
    ds_read_b64_tr_b16 v[54:55], v64 offset:11264
    ds_read_b64_tr_b16 v[56:57], v65 offset:10240
    ds_read_b64_tr_b16 v[58:59], v65 offset:11264
    s_waitcnt lgkmcnt(0)
    v_mfma_f32_16x16x32_bf16 v[32:35], v[76:79], v[76:79], 0
    v_mfma_f32_16x16x32_bf16 v[8:11], v[76:79], v[36:39], 0
    v_mfma_f32_16x16x32_bf16 v[12:15], v[76:79], v[40:43], 0
    v_mfma_f32_16x16x32_bf16 v[16:19], v[76:79], v[44:47], 0
    v_mfma_f32_16x16x32_bf16 v[20:23], v[76:79], v[48:51], 0
    v_mfma_f32_16x16x32_bf16 v[24:27], v[76:79], v[52:55], 0
    v_mfma_f32_16x16x32_bf16 v[28:31], v[76:79], v[56:59], 0
    s_nop 4
    v_add_f32 v60, v11, v19
    v_add_f32 v61, v15, v23
    v_add_f32 v60, v60, v27
    v_add_f32 v61, v61, v31
    v_mov_b32_dpp v10, v32 row_newbcast:0 row_mask:0xf bank_mask:0xf
    v_mov_b32_dpp v11, v35 row_newbcast:0 row_mask:0xf bank_mask:0xf
    v_add_f32 v8, v8, v17
    v_add_f32_dpp v10, v33, v10 row_newbcast:1 row_mask:0xf bank_mask:0xf
    v_add_f32_dpp v11, v35, v11 row_newbcast:1 row_mask:0xf bank_mask:0xf
    v_add_f32 v9, v12, v21
    v_add_f32_dpp v10, v34, v10 row_newbcast:2 row_mask:0xf bank_mask:0xf
    v_add_f32_dpp v11, v35, v11 row_newbcast:2 row_mask:0xf bank_mask:0xf
    v_add_f32 v8, v8, v26
    v_add_f32 v9, v9, v30
    s_xor_b32 s78, s64, 262144
    s_waitcnt vmcnt(6)
    s_cmp_lg_u32 s101, 0
    s_cbranch_scc1 L_lag_13
    s_waitcnt vmcnt(4)
L_lag_13:
    buffer_load_dwordx4 a[128:131], v72, s[4:7], s78 offen offset:0 nt
    buffer_load_dwordx4 a[132:135], v72, s[4:7], s78 offen offset:128 nt
    s_waitcnt vmcnt(6)
    s_cmp_lg_u32 s101, 0
    s_cbranch_scc1 L_lag_14
    s_waitcnt vmcnt(4)
L_lag_14:
    buffer_load_dwordx4 a[136:139], v72, s[4:7], s78 offen offset:256 nt
    buffer_load_dwordx4 a[140:143], v72, s[4:7], s78 offen offset:384 nt
    s_waitcnt vmcnt(6)
    s_cmp_lg_u32 s101, 0
    s_cbranch_scc1 L_lag_15
    s_waitcnt vmcnt(4)
L_lag_15:
    buffer_load_dwordx4 a[144:147], v72, s[4:7], s78 offen offset:512 nt
    buffer_load_dwordx4 a[148:151], v72, s[4:7], s78 offen offset:640 nt
    s_waitcnt vmcnt(6)
    s_cmp_lg_u32 s101, 0
    s_cbranch_scc1 L_lag_16
    s_waitcnt vmcnt(4)
L_lag_16:
    buffer_load_dwordx4 a[152:155], v72, s[4:7], s78 offen offset:768 nt
    buffer_load_dwordx4 a[156:159], v72, s[4:7], s78 offen offset:896 nt
    v_bfe_u32 v40, v0, 1, 3
    v_lshlrev_b32 v40, 5, v40
    v_and_b32 v41, 1, v0
    v_lshl_add_u32 v40, v41, 2, v40
    s_mov_b32 s80, 0
    buffer_load_dword v41, v40, s[52:55], 0 offen sc1
    s_xor_b32 s78, s64, 303104
    s_waitcnt vmcnt(7)
    s_cmp_lg_u32 s101, 0
    s_cbranch_scc1 L_lag_17
    s_waitcnt vmcnt(5)
L_lag_17:
    buffer_load_dwordx4 a[160:163], v72, s[4:7], s78 offen offset:0 nt
    buffer_load_dwordx4 a[164:167], v72, s[4:7], s78 offen offset:128 nt
    s_waitcnt vmcnt(7)
    s_cmp_lg_u32 s101, 0
    s_cbranch_scc1 L_lag_18
    s_waitcnt vmcnt(5)
L_lag_18:
    buffer_load_dwordx4 a[168:171], v72, s[4:7], s78 offen offset:256 nt
    buffer_load_dwordx4 a[172:175], v72, s[4:7], s78 offen offset:384 nt
    s_waitcnt vmcnt(7)
    s_cmp_lg_u32 s101, 0
    s_cbranch_scc1 L_lag_19
    s_waitcnt vmcnt(5)
L_lag_19:
    buffer_load_dwordx4 a[176:179], v72, s[4:7], s78 offen offset:512 nt
    buffer_load_dwordx4 a[180:183], v72, s[4:7], s78 offen offset:640 nt
    s_waitcnt vmcnt(7)
    s_cmp_lg_u32 s101, 0
    s_cbranch_scc1 L_lag_20
    s_waitcnt vmcnt(4)
L_lag_20:
    buffer_load_dwordx4 a[184:187], v72, s[4:7], s78 offen offset:768 nt
    buffer_load_dwordx4 a[188:191], v72, s[4:7], s78 offen offset:896 nt
    s_waitcnt vmcnt(8)
L_cnt_chk:
    v_sad_u8 v42, v41, 0, 0
    s_nop 1
    v_add_u32_dpp v42, v42, v42 row_ror:1 row_mask:0xf bank_mask:0xf
    s_nop 1
    v_add_u32_dpp v42, v42, v42 row_ror:2 row_mask:0xf bank_mask:0xf
    s_nop 1
    v_add_u32_dpp v42, v42, v42 row_ror:4 row_mask:0xf bank_mask:0xf
    s_nop 1
    v_add_u32_dpp v42, v42, v42 row_ror:8 row_mask:0xf bank_mask:0xf
    v_cmp_ne_u32 vcc, 0x100, v42
    s_cbranch_vccnz L_retry_21
    s_lshr_b32 s70, s61, 3
    s_mul_i32 s44, s70, 6144
    s_mul_i32 s71, s3, 1536
    s_add_u32 s44, s44, s71
    s_add_u32 s44, s44, s58
    s_mul_i32 s45, s70, 2176
    s_lshl_b32 s71, s63, 4
    s_add_u32 s45, s45, s71
    s_add_u32 s45, s45, s58
    s_and_b32 s46, s61, 1
    s_lshl_b32 s46, s46, 1
    s_lshr_b32 s71, s3, 1
    s_add_u32 s46, s46, s71
    s_mul_i32 s46, s46, 2176
    s_add_u32 s46, s46, s58
    s_lshl_b32 s1, s60, 1
    s_add_u32 s1, s1, s86
    s_lshl_b32 s1, s1, 4
    s_add_u32 s1, s1, s87
    s_lshl_b32 s1, s1, 7
    s_add_u32 s1, s1, 2621440
    v_sad_u8 v42, v41, 0, 0
    v_cmp_lt_u32 vcc, 16, v42
    s_mov_b32 s55, s60
    s_lshr_b32 s52, s69, 2
    s_xor_b32 s52, s52, 0
    s_lshl_b32 s52, s52, 13
    s_and_b32 s70, s60, 3
    s_lshl_b32 s70, s70, 1
    s_add_u32 s70, s70, 1
    s_lshr_b32 s53, vcc_lo, s70
    s_lshr_b32 s70, s60, 2
    s_xor_b32 s53, s53, s70
    s_xor_b32 s53, s53, 0
    s_and_b32 s53, s53, 1
    s_lshl_b32 s53, s53, 13
    s_and_b32 s70, s87, 6
    s_add_u32 s70, s70, 1
    s_lshr_b32 s54, vcc_lo, s70
    s_lshr_b32 s70, s87, 3
    s_xor_b32 s54, s54, s70
    s_xor_b32 s54, s54, 0
    s_and_b32 s54, s54, 1
    s_lshl_b32 s54, s54, 13
    s_and_b32 s70, s60, 3
    s_lshl_b32 s70, s70, 1
    s_add_u32 s70, s70, s86
    s_lshl_b32 s70, s70, 19
    s_lshl_b32 s71, s3, 8
    s_add_u32 s70, s70, s71
    s_add_u32 s70, s70, 4194304
    s_and_b32 s71, s60, 2
    s_lshl_b32 s71, s71, 12
    s_xor_b32 s71, s71, s53
    s_xor_b32 s71, s71, 0
    s_add_u32 s70, s70, s71
    s_lshl_b32 s71, s87, 15
    s_add_u32 s47, s70, s71
    s_and_b32 s71, s87, 8
    s_add_u32 s71, s71, s87
    s_lshl_b32 s71, s71, 10
    s_add_u32 s0, s70, s71
    v_readlane_b32 s70, v41, s79
    s_and_b32 s71, s69, 3
    s_lshl_b32 s71, s71, 3
    s_lshr_b32 s70, s70, s71
    s_and_b32 s70, s70, 0xff
    s_cmp_eq_u32 s70, 32
    s_cbranch_scc1 L_fast
    s_branch L_slow
L_retry_21:
    s_add_u32 s80, s80, 1
    s_cmp_ge_u32 s80, 1048576
    s_cbranch_scc1 L_abort
    s_nop 3
    buffer_load_dword v41, v40, s[52:55], 0 offen sc1
    s_waitcnt vmcnt(0)
    s_branch L_cnt_chk
L_fast:
    s_add_u32 s76, s44, s59
    s_add_u32 s76, s76, 13312
    s_add_u32 s77, s76, 24576
    s_lshl_b32 s70, s63, 8
    s_add_u32 s70, s70, s67
    v_lshl_add_u32 v76, v0, 4, s70
    s_mov_b64 exec, 0xffff
    buffer_store_dwordx4 v[8:11], v76, s[40:43], s76 offen
    buffer_store_dwordx4 v[60:63], v76, s[40:43], s77 offen
    s_mov_b64 exec, -1
    s_xor_b32 s78, s64, 263168
    s_waitcnt vmcnt(8)
    s_cmp_lg_u32 s101, 0
    s_cbranch_scc1 L_lag_22
    s_waitcnt vmcnt(6)
L_lag_22:
    buffer_load_dwordx4 a[192:195], v72, s[4:7], s78 offen offset:0 nt
    buffer_load_dwordx4 a[196:199], v72, s[4:7], s78 offen offset:128 nt
    s_lshl_b32 s97, s2, 2
    s_add_u32 s97, s97, s3
    s_lshl_b32 s96, s60, 21
    s_add_u32 s56, s20, s96
    s_addc_u32 s57, s21, 0
    s_add_u32 s94, s40, 507904
    s_addc_u32 s95, s41, 0
    s_cmp_eq_u32 s97, 995
    s_cselect_b64 s[56:57], s[94:95], s[56:57]
    s_cselect_b32 s97, 994, s97
    s_and_b32 s97, s97, 1011
    s_mov_b32 s96, 0
    s_cmp_lg_u32 s97, 994
    s_cbranch_scc1 L_np_23
    s_memtime s[70:71]
    s_load_dword s90, s[56:57], 0x2000 glc
    s_waitcnt lgkmcnt(0)
    s_memtime s[72:73]
    s_waitcnt lgkmcnt(0)
    s_sub_u32 s95, s72, s70
    s_memtime s[70:71]
    s_load_dword s90, s[56:57], 0x0 glc
    s_waitcnt lgkmcnt(0)
    s_memtime s[72:73]
    s_waitcnt lgkmcnt(0)
    s_sub_u32 s94, s72, s70
    s_cmp_gt_u32 s94, s95
    s_addc_u32 s96, s96, 0
L_np_23:
    s_waitcnt vmcnt(8)
    s_cmp_lg_u32 s101, 0
    s_cbranch_scc1 L_lag_24
    s_waitcnt vmcnt(6)
L_lag_24:
    buffer_load_dwordx4 a[200:203], v72, s[4:7], s78 offen offset:256 nt
    buffer_load_dwordx4 a[204:207], v72, s[4:7], s78 offen offset:384 nt
    s_waitcnt vmcnt(8)
    s_cmp_lg_u32 s101, 0
    s_cbranch_scc1 L_lag_25
    s_waitcnt vmcnt(6)
L_lag_25:
    buffer_load_dwordx4 a[208:211], v72, s[4:7], s78 offen offset:512 nt
    buffer_load_dwordx4 a[212:215], v72, s[4:7], s78 offen offset:640 nt
    s_waitcnt vmcnt(8)
    s_cmp_lg_u32 s101, 0
    s_cbranch_scc1 L_lag_26
    s_waitcnt vmcnt(4)
L_lag_26:
    buffer_load_dwordx4 a[216:219], v72, s[4:7], s78 offen offset:768 nt
    s_cmp_lg_u32 s97, 994
    s_cbranch_scc1 L_np_27
    s_memtime s[70:71]
    s_load_dword s90, s[56:57], 0x1000 glc
    s_waitcnt lgkmcnt(0)
    s_memtime s[72:73]
    s_waitcnt lgkmcnt(0)
    s_sub_u32 s94, s72, s70
    s_memtime s[70:71]
    s_load_dword s90, s[56:57], 0x3000 glc
    s_waitcnt lgkmcnt(0)
    s_memtime s[72:73]
    s_waitcnt lgkmcnt(0)
    s_sub_u32 s95, s72, s70
    s_cmp_gt_u32 s94, s95
    s_addc_u32 s96, s96, 0
L_np_27:
    buffer_load_dwordx4 a[220:223], v72, s[4:7], s78 offen offset:896 nt
    s_xor_b32 s78, s64, 304128
    s_waitcnt vmcnt(6)
    s_cmp_lg_u32 s101, 0
    s_cbranch_scc1 L_lag_28
    s_waitcnt vmcnt(4)
L_lag_28:
    buffer_load_dwordx4 a[224:227], v72, s[4:7], s78 offen offset:0 nt
    buffer_load_dwordx4 a[228:231], v72, s[4:7], s78 offen offset:128 nt
    s_waitcnt vmcnt(6)
    s_cmp_lg_u32 s101, 0
    s_cbranch_scc1 L_lag_29
    s_waitcnt vmcnt(4)
L_lag_29:
    buffer_load_dwordx4 a[232:235], v72, s[4:7], s78 offen offset:256 nt
    buffer_load_dwordx4 a[236:239], v72, s[4:7], s78 offen offset:384 nt
    s_cmp_lg_u32 s97, 994
    s_cbranch_scc1 L_np_30
    s_memtime s[70:71]
    s_load_dword s90, s[56:57], 0x6000 glc
    s_waitcnt lgkmcnt(0)
    s_memtime s[72:73]
    s_waitcnt lgkmcnt(0)
    s_sub_u32 s95, s72, s70
    s_memtime s[70:71]
    s_load_dword s90, s[56:57], 0x4000 glc
    s_waitcnt lgkmcnt(0)
    s_memtime s[72:73]
    s_waitcnt lgkmcnt(0)
    s_sub_u32 s94, s72, s70
    s_cmp_gt_u32 s94, s95
    s_addc_u32 s96, s96, 0
    s_cmp_gt_u32 s96, 1
    s_cselect_b32 s95, 0x2000, 0
    s_add_u32 s94, s60, 1
    s_cmp_eq_u32 s3, 3
    s_cselect_b32 s70, s52, 0
    s_cselect_b32 s94, 0, s94
    s_xor_b32 s95, s95, s70
    s_lshl_b32 s94, s94, 7
    v_mov_b32 v64, s95
    v_mov_b32 v65, 499712
    buffer_store_dword v64, v65, s[40:43], s94 offen sc1
L_np_30:
    s_waitcnt vmcnt(6)
    s_cmp_lg_u32 s101, 0
    s_cbranch_scc1 L_lag_31
    s_waitcnt vmcnt(4)
L_lag_31:
    buffer_load_dwordx4 a[240:243], v72, s[4:7], s78 offen offset:512 nt
    buffer_load_dwordx4 a[244:247], v72, s[4:7], s78 offen offset:640 nt
    s_waitcnt vmcnt(6)
    s_cmp_lg_u32 s101, 0
    s_cbranch_scc1 L_lag_32
    s_waitcnt vmcnt(4)
L_lag_32:
    buffer_load_dwordx4 a[248:251], v72, s[4:7], s78 offen offset:768 nt
    buffer_load_dwordx4 a[252:255], v72, s[4:7], s78 offen offset:896 nt
    v_lshrrev_b32 v73, 5, v0
    v_lshlrev_b32 v73, 6, v73
    v_bfe_u32 v74, v0, 2, 1
    v_lshl_add_u32 v73, v74, 8, v73
    v_bfe_u32 v74, v0, 3, 1
    v_lshl_add_u32 v73, v74, 9, v73
    v_bfe_u32 v74, v0, 4, 1
    v_lshl_add_u32 v73, v74, 11, v73
    v_bfe_u32 v74, v0, 4, 1
    v_lshlrev_b32 v74, 1, v74
    v_xor_b32 v74, v0, v74
    v_and_b32 v74, 3, v74
    v_lshl_add_u32 v73, v74, 4, v73
    v_lshrrev_b32 v3, 5, v0
    v_lshlrev_b32 v3, 11, v3
    v_bfe_u32 v79, v0, 2, 3
    v_lshl_add_u32 v3, v79, 6, v3
    v_bfe_u32 v79, v0, 4, 1
    v_lshl_add_u32 v3, v79, 5, v3
    v_and_b32 v79, 3, v0
    v_lshl_add_u32 v3, v79, 3, v3
    v_add_u32 v3, s65, v3
    v_xor_b32 v79, 32, v3
    v_lshlrev_b32 v36, 4, v0
    v_and_b32 v37, 32, v0
    v_lshl_add_u32 v37, v37, 26, v36
    v_lshrrev_b32 v22, 4, v0
    v_and_b32 v23, 1, v22
    v_lshlrev_b32 v22, 4, v22
    v_mul_u32_u24 v23, 4080, v23
    v_add_u32 v22, v23, v22
    v_and_b32 v23, 15, v0
    v_lshl_add_u32 v22, v23, 1, v22
    s_lshl_b32 s70, s3, 6
    s_add_u32 s70, s70, 154880
    v_add_u32 v22, s70, v22
    v_and_b32 v24, 1, v0
    v_lshlrev_b32 v24, 6, v24
    v_lshrrev_b32 v25, 4, v0
    v_lshl_add_u32 v24, v25, 4, v24
    v_add_u32 v24, 154880, v24
    s_mov_b32 s80, 0
    s_waitcnt vmcnt(6)
    s_cmp_lg_u32 s101, 0
    s_cbranch_scc1 L_lag_33
    s_waitcnt vmcnt(4)
L_lag_33:
    s_add_u32 m0, s65, 16384
    s_xor_b32 s78, s64, 0
    buffer_load_dwordx4 v73, s[8:11], s78 offen nt lds
    s_add_u32 m0, s65, 17408
    s_xor_b32 s78, s64, 65536
    buffer_load_dwordx4 v73, s[8:11], s78 offen nt lds
    s_waitcnt vmcnt(6)
    s_cmp_lg_u32 s101, 0
    s_cbranch_scc1 L_lag_34
    s_waitcnt vmcnt(4)
L_lag_34:
    s_add_u32 m0, s65, 18432
    s_xor_b32 s78, s64, 4096
    buffer_load_dwordx4 v73, s[8:11], s78 offen nt lds
    s_add_u32 m0, s65, 19456
    s_xor_b32 s78, s64, 69632
    buffer_load_dwordx4 v73, s[8:11], s78 offen nt lds
    s_waitcnt vmcnt(6)
    s_cmp_lg_u32 s101, 0
    s_cbranch_scc1 L_lag_35
    s_waitcnt vmcnt(4)
L_lag_35:
    s_add_u32 m0, s65, 0
    s_xor_b32 s78, s64, 128
    buffer_load_dwordx4 v73, s[8:11], s78 offen nt lds
    s_add_u32 m0, s65, 1024
    s_xor_b32 s78, s64, 65664
    buffer_load_dwordx4 v73, s[8:11], s78 offen nt lds
    s_waitcnt vmcnt(6)
    s_cmp_lg_u32 s101, 0
    s_cbranch_scc1 L_lag_36
    s_waitcnt vmcnt(4)
L_lag_36:
    s_add_u32 m0, s65, 2048
    s_xor_b32 s78, s64, 4224
    buffer_load_dwordx4 v73, s[8:11], s78 offen nt lds
    s_add_u32 m0, s65, 3072
    s_xor_b32 s78, s64, 69760
    buffer_load_dwordx4 v73, s[8:11], s78 offen nt lds
    s_waitcnt vmcnt(6)
    s_cmp_lg_u32 s101, 0
    s_cbranch_scc1 L_lag_37
    s_waitcnt vmcnt(4)
L_lag_37:
    s_add_u32 m0, s65, 4096
    s_xor_b32 s78, s64, 40960
    buffer_load_dwordx4 v73, s[8:11], s78 offen nt lds
    s_add_u32 m0, s65, 5120
    s_xor_b32 s78, s64, 106496
    buffer_load_dwordx4 v73, s[8:11], s78 offen nt lds
    s_waitcnt vmcnt(6)
    ds_read_b64_tr_b16 v[80:81], v3 offset:16384
    ds_read_b64_tr_b16 v[82:83], v3 offset:17408
    ds_read_b64_tr_b16 v[88:89], v79 offset:16384
    ds_read_b64_tr_b16 v[90:91], v79 offset:17408
    ds_read_b64_tr_b16 v[96:97], v3 offset:16896
    ds_read_b64_tr_b16 v[98:99], v3 offset:17920
    ds_read_b64_tr_b16 v[104:105], v79 offset:16896
    ds_read_b64_tr_b16 v[106:107], v79 offset:17920
    s_and_b32 s70, s69, 5
    s_cmp_eq_u32 s70, 5
    s_cselect_b32 s101, 1, 0
    s_cmp_lg_u32 s101, 0
    s_cbranch_scc1 L_lag_38
    s_waitcnt vmcnt(4)
L_lag_38:
    s_add_u32 m0, s65, 6144
    s_xor_b32 s78, s64, 45056
    buffer_load_dwordx4 v73, s[8:11], s78 offen nt lds
    s_add_u32 m0, s65, 7168
    s_xor_b32 s78, s64, 110592
    buffer_load_dwordx4 v73, s[8:11], s78 offen nt lds
    s_waitcnt lgkmcnt(0)
    s_waitcnt vmcnt(6)
    s_cmp_lg_u32 s101, 0
    s_cbranch_scc1 L_lag_39
    s_waitcnt vmcnt(4)
L_lag_39:
    s_add_u32 m0, s65, 8192
    s_xor_b32 s78, s64, 41088
    buffer_load_dwordx4 v73, s[8:11], s78 offen nt lds
    s_add_u32 m0, s65, 9216
    s_xor_b32 s78, s64, 106624
    buffer_load_dwordx4 v73, s[8:11], s78 offen nt lds
    s_waitcnt vmcnt(6)
    ds_read_b64_tr_b16 v[112:113], v3 offset:0
    ds_read_b64_tr_b16 v[114:115], v3 offset:1024
    ds_read_b64_tr_b16 v[120:121], v79 offset:0
    ds_read_b64_tr_b16 v[122:123], v79 offset:1024
    ds_read_b64_tr_b16 v[128:129], v3 offset:512
    ds_read_b64_tr_b16 v[130:131], v3 offset:1536
    ds_read_b64_tr_b16 v[136:137], v79 offset:512
    ds_read_b64_tr_b16 v[138:139], v79 offset:1536
    buffer_load_dwordx4 v[40:43], v36, s[40:43], s76 offen sc1
    buffer_load_dwordx4 v[44:47], v37, s[40:43], s76 offen offset:1024 sc1
    buffer_load_dwordx4 v[26:29], v36, s[40:43], s77 offen sc1
    buffer_load_dwordx4 v[30:33], v37, s[40:43], s77 offen offset:1024 sc1
    s_cmp_lg_u32 s101, 0
    s_cbranch_scc1 L_lag_40
    s_waitcnt vmcnt(8)
L_lag_40:
    s_add_u32 m0, s65, 10240
    s_xor_b32 s78, s64, 45184
    buffer_load_dwordx4 v73, s[8:11], s78 offen nt lds
    s_add_u32 m0, s65, 11264
    s_xor_b32 s78, s64, 110720
    buffer_load_dwordx4 v73, s[8:11], s78 offen nt lds
    s_waitcnt lgkmcnt(0)
    s_waitcnt vmcnt(10)
    s_cmp_lg_u32 s101, 0
    s_cbranch_scc1 L_lag_41
    s_waitcnt vmcnt(8)
L_lag_41:
    s_add_u32 m0, s65, 12288
    s_xor_b32 s78, s64, 1024
    buffer_load_dwordx4 v73, s[8:11], s78 offen nt lds
    s_add_u32 m0, s65, 13312
    s_xor_b32 s78, s64, 66560
    buffer_load_dwordx4 v73, s[8:11], s78 offen nt lds
    s_waitcnt vmcnt(10)
    ds_read_b64_tr_b16 v[84:85], v3 offset:4096
    ds_read_b64_tr_b16 v[86:87], v3 offset:5120
    ds_read_b64_tr_b16 v[92:93], v79 offset:4096
    ds_read_b64_tr_b16 v[94:95], v79 offset:5120
    ds_read_b64_tr_b16 v[100:101], v3 offset:4608
    ds_read_b64_tr_b16 v[102:103], v3 offset:5632
    ds_read_b64_tr_b16 v[108:109], v79 offset:4608
    ds_read_b64_tr_b16 v[110:111], v79 offset:5632
    s_cmp_lg_u32 s101, 0
    s_cbranch_scc1 L_lag_42
    s_waitcnt vmcnt(8)
L_lag_42:
    s_add_u32 m0, s65, 14336
    s_xor_b32 s78, s64, 5120
    buffer_load_dwordx4 v73, s[8:11], s78 offen nt lds
    s_add_u32 m0, s65, 15360
    s_xor_b32 s78, s64, 70656
    buffer_load_dwordx4 v73, s[8:11], s78 offen nt lds
    s_waitcnt lgkmcnt(0)
    s_waitcnt vmcnt(10)
    s_cmp_lg_u32 s101, 0
    s_cbranch_scc1 L_lag_43
    s_waitcnt vmcnt(4)
L_lag_43:
    s_add_u32 m0, s65, 16384
    s_xor_b32 s78, s64, 1152
    buffer_load_dwordx4 v73, s[8:11], s78 offen nt lds
    s_add_u32 m0, s65, 17408
    s_xor_b32 s78, s64, 66688
    buffer_load_dwordx4 v73, s[8:11], s78 offen nt lds
    s_waitcnt vmcnt(6)
    ds_read_b64_tr_b16 v[116:117], v3 offset:8192
    ds_read_b64_tr_b16 v[118:119], v3 offset:9216
    ds_read_b64_tr_b16 v[124:125], v79 offset:8192
    ds_read_b64_tr_b16 v[126:127], v79 offset:9216
    ds_read_b64_tr_b16 v[132:133], v3 offset:8704
    ds_read_b64_tr_b16 v[134:135], v3 offset:9728
    ds_read_b64_tr_b16 v[140:141], v79 offset:8704
    ds_read_b64_tr_b16 v[142:143], v79 offset:9728
    s_add_u32 m0, s65, 18432
    s_xor_b32 s78, s64, 5248
    buffer_load_dwordx4 v73, s[8:11], s78 offen nt lds
    s_add_u32 m0, s65, 19456
    s_xor_b32 s78, s64, 70784
    buffer_load_dwordx4 v73, s[8:11], s78 offen nt lds
    s_add_u32 m0, s65, 0
    s_xor_b32 s78, s64, 41984
    buffer_load_dwordx4 v73, s[8:11], s78 offen nt lds
    s_add_u32 m0, s65, 1024
    s_xor_b32 s78, s64, 107520
    buffer_load_dwordx4 v73, s[8:11], s78 offen nt lds
    s_add_u32 m0, s65, 2048
    s_xor_b32 s78, s64, 46080
    buffer_load_dwordx4 v73, s[8:11], s78 offen nt lds
    s_add_u32 m0, s65, 3072
    s_xor_b32 s78, s64, 111616
    buffer_load_dwordx4 v73, s[8:11], s78 offen nt lds
    s_add_u32 m0, s65, 4096
    s_xor_b32 s78, s64, 42112
    buffer_load_dwordx4 v73, s[8:11], s78 offen nt lds
    s_add_u32 m0, s65, 5120
    s_xor_b32 s78, s64, 107648
    buffer_load_dwordx4 v73, s[8:11], s78 offen nt lds
    s_add_u32 m0, s65, 6144
    s_xor_b32 s78, s64, 46208
    buffer_load_dwordx4 v73, s[8:11], s78 offen nt lds
    s_add_u32 m0, s65, 7168
    s_xor_b32 s78, s64, 111744
    buffer_load_dwordx4 v73, s[8:11], s78 offen nt lds
    s_waitcnt lgkmcnt(0)
L_qw_44:
    v_pk_add_f32 v[12:13], v[26:27], v[30:31]
    v_pk_add_f32 v[14:15], v[28:29], v[32:33]
    s_nop 0
    v_permlane32_swap_b32 v12, v13
    v_permlane32_swap_b32 v14, v15
    v_add_f32 v12, v12, v13
    v_add_f32 v14, v14, v15
    s_nop 1
    v_permlane16_swap_b32 v12, v14
    v_add_f32 v12, v12, v14
    v_mul_f32 v5, 0x3ae38e39, v12
    v_cmp_u_f32 vcc, v5, v5
    s_cbranch_vccnz L_retry_45
    v_mov_b32 v6, v5
    s_nop 1
    v_permlane16_swap_b32 v5, v6
    v_pk_add_f32 v[12:13], v[40:41], v[44:45]
    v_pk_add_f32 v[14:15], v[42:43], v[46:47]
    s_nop 0
    v_permlane32_swap_b32 v12, v13
    v_permlane32_swap_b32 v14, v15
    v_add_f32 v12, v12, v13
    v_add_f32 v14, v14, v15
    s_nop 1
    v_permlane16_swap_b32 v12, v14
    v_add_f32 v12, v12, v14
    s_nop 0
    v_readlane_b32 s71, v12, 48
    v_readlane_b32 s72, v12, 16
    v_cmp_u_f32 vcc, v12, v12
    v_fma_f32 v13, -s71, v5, v12
    v_cvt_pk_bf16_f32 v13, v13, v13
    ds_write_b16 v22, v13
    s_cbranch_vccnz L_retry_46
    v_mov_b32 v14, 0x3ae38e39
    v_mul_f32 v15, s71, v14
    v_mul_f32 v14, s72, v14
    v_fma_f32 v14, -v15, v15, v14
    v_max_f32 v14, 0, v14
    v_add_f32 v14, 0x3727c5ac, v14
    v_rsq_f32 v14, v14
    s_waitcnt lgkmcnt(0)
    s_barrier
    ds_read_b128 v[48:51], v24
    ds_read_b128 v[52:55], v24 offset:128
    v_mul_f32 v14, 0x3e0293ee, v14
    s_nop 0
    v_readfirstlane_b32 s81, v14
    s_waitcnt lgkmcnt(0)
    v_mfma_f32_16x16x32_bf16 v[16:19], v[48:51], a[0:3], 0
    v_mfma_f32_16x16x32_bf16 v[16:19], v[52:55], a[4:7], v[16:19]
    v_mfma_f32_16x16x32_bf16 v[20:23], v[48:51], a[8:11], 0
    v_mfma_f32_16x16x32_bf16 v[20:23], v[52:55], a[12:15], v[20:23]
    v_mfma_f32_16x16x32_bf16 v[24:27], v[48:51], a[16:19], 0
    v_mfma_f32_16x16x32_bf16 v[24:27], v[52:55], a[20:23], v[24:27]
    v_mfma_f32_16x16x32_bf16 v[28:31], v[48:51], a[24:27], 0
    v_mfma_f32_16x16x32_bf16 v[28:31], v[52:55], a[28:31], v[28:31]
    s_nop 1
    v_add_f32_dpp v32, v17, v16 row_ror:8 row_mask:0x1 bank_mask:0x3
    v_mfma_f32_16x16x32_bf16 v[16:19], v[48:51], a[32:35], 0
    v_mfma_f32_16x16x32_bf16 v[16:19], v[52:55], a[36:39], v[16:19]
    v_add_f32_dpp v33, v21, v20 row_ror:8 row_mask:0x1 bank_mask:0x3
    v_mfma_f32_16x16x32_bf16 v[20:23], v[48:51], a[40:43], 0
    v_mfma_f32_16x16x32_bf16 v[20:23], v[52:55], a[44:47], v[20:23]
    v_add_f32_dpp v34, v25, v24 row_ror:8 row_mask:0x1 bank_mask:0x3
    v_mfma_f32_16x16x32_bf16 v[24:27], v[48:51], a[48:51], 0
    v_mfma_f32_16x16x32_bf16 v[24:27], v[52:55], a[52:55], v[24:27]
    v_add_f32_dpp v35, v29, v28 row_ror:8 row_mask:0x1 bank_mask:0x3
    v_mfma_f32_16x16x32_bf16 v[28:31], v[48:51], a[56:59], 0
    v_mfma_f32_16x16x32_bf16 v[28:31], v[52:55], a[60:63], v[28:31]
    v_add_f32_dpp v32, v16, v17 row_ror:8 row_mask:0x1 bank_mask:0xc
    v_mfma_f32_16x16x32_bf16 v[16:19], v[48:51], a[64:67], 0
    v_mfma_f32_16x16x32_bf16 v[16:19], v[52:55], a[68:71], v[16:19]
    v_add_f32_dpp v33, v20, v21 row_ror:8 row_mask:0x1 bank_mask:0xc
    v_mfma_f32_16x16x32_bf16 v[20:23], v[48:51], a[72:75], 0
    v_mfma_f32_16x16x32_bf16 v[20:23], v[52:55], a[76:79], v[20:23]
    v_add_f32_dpp v34, v24, v25 row_ror:8 row_mask:0x1 bank_mask:0xc
    v_mfma_f32_16x16x32_bf16 v[24:27], v[48:51], a[80:83], 0
    v_mfma_f32_16x16x32_bf16 v[24:27], v[52:55], a[84:87], v[24:27]
    v_add_f32_dpp v35, v28, v29 row_ror:8 row_mask:0x1 bank_mask:0xc
    v_mfma_f32_16x16x32_bf16 v[28:31], v[48:51], a[88:91], 0
    v_mfma_f32_16x16x32_bf16 v[28:31], v[52:55], a[92:95], v[28:31]
    v_add_f32_dpp v32, v17, v16 row_ror:8 row_mask:0x2 bank_mask:0x3
    v_mfma_f32_16x16x32_bf16 v[16:19], v[48:51], a[96:99], 0
    v_mfma_f32_16x16x32_bf16 v[16:19], v[52:55], a[100:103], v[16:19]
    v_add_f32_dpp v33, v21, v20 row_ror:8 row_mask:0x2 bank_mask:0x3
    v_mfma_f32_16x16x32_bf16 v[20:23], v[48:51], a[104:107], 0
    v_mfma_f32_16x16x32_bf16 v[20:23], v[52:55], a[108:111], v[20:23]
    v_add_f32_dpp v34, v25, v24 row_ror:8 row_mask:0x2 bank_mask:0x3
    v_mfma_f32_16x16x32_bf16 v[24:27], v[48:51], a[112:115], 0
    v_mfma_f32_16x16x32_bf16 v[24:27], v[52:55], a[116:119], v[24:27]
    v_add_f32_dpp v35, v29, v28 row_ror:8 row_mask:0x2 bank_mask:0x3
    v_mfma_f32_16x16x32_bf16 v[28:31], v[48:51], a[120:123], 0
    v_mfma_f32_16x16x32_bf16 v[28:31], v[52:55], a[124:127], v[28:31]
    v_add_f32_dpp v32, v16, v17 row_ror:8 row_mask:0x2 bank_mask:0xc
    v_mfma_f32_16x16x32_bf16 v[16:19], v[48:51], a[128:131], 0
    v_mfma_f32_16x16x32_bf16 v[16:19], v[52:55], a[132:135], v[16:19]
    v_add_f32_dpp v33, v20, v21 row_ror:8 row_mask:0x2 bank_mask:0xc
    v_mfma_f32_16x16x32_bf16 v[20:23], v[48:51], a[136:139], 0
    v_mfma_f32_16x16x32_bf16 v[20:23], v[52:55], a[140:143], v[20:23]
    v_add_f32_dpp v34, v24, v25 row_ror:8 row_mask:0x2 bank_mask:0xc
    v_mfma_f32_16x16x32_bf16 v[24:27], v[48:51], a[144:147], 0
    v_mfma_f32_16x16x32_bf16 v[24:27], v[52:55], a[148:151], v[24:27]
    v_add_f32_dpp v35, v28, v29 row_ror:8 row_mask:0x2 bank_mask:0xc
    v_mfma_f32_16x16x32_bf16 v[28:31], v[48:51], a[152:155], 0
    v_mfma_f32_16x16x32_bf16 v[28:31], v[52:55], a[156:159], v[28:31]
    v_add_f32_dpp v32, v17, v16 row_ror:8 row_mask:0x4 bank_mask:0x3
    v_mfma_f32_16x16x32_bf16 v[16:19], v[48:51], a[160:163], 0
    v_mfma_f32_16x16x32_bf16 v[16:19], v[52:55], a[164:167], v[16:19]
    v_add_f32_dpp v33, v21, v20 row_ror:8 row_mask:0x4 bank_mask:0x3
    v_mfma_f32_16x16x32_bf16 v[20:23], v[48:51], a[168:171], 0
    v_mfma_f32_16x16x32_bf16 v[20:23], v[52:55], a[172:175], v[20:23]
    v_add_f32_dpp v34, v25, v24 row_ror:8 row_mask:0x4 bank_mask:0x3
    v_mfma_f32_16x16x32_bf16 v[24:27], v[48:51], a[176:179], 0
    v_mfma_f32_16x16x32_bf16 v[24:27], v[52:55], a[180:183], v[24:27]
    v_add_f32_dpp v35, v29, v28 row_ror:8 row_mask:0x4 bank_mask:0x3
    v_mfma_f32_16x16x32_bf16 v[28:31], v[48:51], a[184:187], 0
    v_mfma_f32_16x16x32_bf16 v[28:31], v[52:55], a[188:191], v[28:31]
    v_add_f32_dpp v32, v16, v17 row_ror:8 row_mask:0x4 bank_mask:0xc
    v_mfma_f32_16x16x32_bf16 v[16:19], v[48:51], a[192:195], 0
    v_mfma_f32_16x16x32_bf16 v[16:19], v[52:55], a[196:199], v[16:19]
    v_add_f32_dpp v33, v20, v21 row_ror:8 row_mask:0x4 bank_mask:0xc
    v_mfma_f32_16x16x32_bf16 v[20:23], v[48:51], a[200:203], 0
    v_mfma_f32_16x16x32_bf16 v[20:23], v[52:55], a[204:207], v[20:23]
    v_add_f32_dpp v34, v24, v25 row_ror:8 row_mask:0x4 bank_mask:0xc
    v_mfma_f32_16x16x32_bf16 v[24:27], v[48:51], a[208:211], 0
    v_mfma_f32_16x16x32_bf16 v[24:27], v[52:55], a[212:215], v[24:27]
    v_add_f32_dpp v35, v28, v29 row_ror:8 row_mask:0x4 bank_mask:0xc
    v_mfma_f32_16x16x32_bf16 v[28:31], v[48:51], a[216:219], 0
    v_mfma_f32_16x16x32_bf16 v[28:31], v[52:55], a[220:223], v[28:31]
    v_add_f32_dpp v32, v17, v16 row_ror:8 row_mask:0x8 bank_mask:0x3
    v_mfma_f32_16x16x32_bf16 v[16:19], v[48:51], a[224:227], 0
    v_mfma_f32_16x16x32_bf16 v[16:19], v[52:55], a[228:231], v[16:19]
    v_add_f32_dpp v33, v21, v20 row_ror:8 row_mask:0x8 bank_mask:0x3
    v_mfma_f32_16x16x32_bf16 v[20:23], v[48:51], a[232:235], 0
    v_mfma_f32_16x16x32_bf16 v[20:23], v[52:55], a[236:239], v[20:23]
    v_add_f32_dpp v34, v25, v24 row_ror:8 row_mask:0x8 bank_mask:0x3
    v_mfma_f32_16x16x32_bf16 v[24:27], v[48:51], a[240:243], 0
    v_mfma_f32_16x16x32_bf16 v[24:27], v[52:55], a[244:247], v[24:27]
    v_add_f32_dpp v35, v29, v28 row_ror:8 row_mask:0x8 bank_mask:0x3
    v_mfma_f32_16x16x32_bf16 v[28:31], v[48:51], a[248:251], 0
    v_mfma_f32_16x16x32_bf16 v[28:31], v[52:55], a[252:255], v[28:31]
    v_add_f32_dpp v32, v16, v17 row_ror:8 row_mask:0x8 bank_mask:0xc
    s_nop 0
    v_add_f32_dpp v33, v20, v21 row_ror:8 row_mask:0x8 bank_mask:0xc
    s_nop 1
    v_add_f32_dpp v34, v24, v25 row_ror:8 row_mask:0x8 bank_mask:0xc
    s_nop 1
    v_add_f32_dpp v35, v28, v29 row_ror:8 row_mask:0x8 bank_mask:0xc
    v_max3_f32 v36, v32, v33, v34
    v_max_f32 v36, v36, v35
    v_mul_f32 v32, s81, v32
    v_mul_f32 v33, s81, v33
    v_max_f32_dpp v36, v36, v36 quad_perm:[1,0,3,2] row_mask:0xf bank_mask:0xf
    v_mul_f32 v34, s81, v34
    v_mul_f32 v35, s81, v35
    v_max_f32_dpp v36, v36, v36 quad_perm:[2,3,0,1] row_mask:0xf bank_mask:0xf
    v_lshl_add_u32 v38, v0, 3, s88
    v_lshrrev_b32 v78, 4, v0
    v_max_f32_dpp v36, v36, v36 row_half_mirror row_mask:0xf bank_mask:0xf
    v_lshl_add_u32 v78, v78, 4, s88
    s_nop 0
    v_max_f32_dpp v36, v36, v36 row_mirror row_mask:0xf bank_mask:0xf
    s_nop 1
    v_max_f32_dpp v36, v36, v36 row_bcast:15 row_mask:0xa bank_mask:0xf
    s_nop 1
    v_max_f32_dpp v36, v36, v36 row_bcast:31 row_mask:0xc bank_mask:0xf
    v_mul_f32 v36, s81, v36
    s_nop 0
    v_readlane_b32 s75, v36, 63
    s_nop 1
    v_subrev_f32 v32, s75, v32
    v_subrev_f32 v33, s75, v33
    v_subrev_f32 v34, s75, v34
    v_subrev_f32 v35, s75, v35
    v_exp_f32 v32, v32
    v_exp_f32 v33, v33
    v_exp_f32 v34, v34
    v_exp_f32 v35, v35
    v_cvt_pk_bf16_f32 v36, v32, v33
    v_cvt_pk_bf16_f32 v37, v34, v35
    ds_write_b64 v38, v[36:37] offset:512
    v_add_f32 v32, v32, v33
    v_add_f32 v34, v34, v35
    v_add_f32 v33, v32, v34
    v_mov_b32 v32, s75
    s_lshl_b32 s70, s3, 3
    v_add_f32_dpp v33, v33, v33 quad_perm:[1,0,3,2] row_mask:0xf bank_mask:0xf
    s_add_u32 s70, s70, 151296
    v_mov_b32 v34, s70
    v_add_f32_dpp v33, v33, v33 quad_perm:[2,3,0,1] row_mask:0xf bank_mask:0xf
    s_nop 1
    v_add_f32_dpp v33, v33, v33 row_half_mirror row_mask:0xf bank_mask:0xf
    s_nop 1
    v_add_f32_dpp v33, v33, v33 row_mirror row_mask:0xf bank_mask:0xf
    s_nop 1
    v_add_f32_dpp v33, v33, v33 row_bcast:15 row_mask:0xa bank_mask:0xf
    s_nop 1
    v_add_f32_dpp v33, v33, v33 row_bcast:31 row_mask:0xc bank_mask:0xf
    s_nop 0
    v_readlane_b32 s71, v33, 63
    s_nop 1
    v_mov_b32 v33, s71
    ds_write_b64 v34, v[32:33]
    ds_read_b128 v[16:19], v78 offset:512
    ds_read_b128 v[74:77], v78 offset:576
    s_waitcnt lgkmcnt(0)
    v_mfma_f32_16x16x32_bf16 v[40:43], v[16:19], v[80:83], 0
    v_mfma_f32_16x16x32_bf16 v[44:47], v[16:19], v[88:91], 0
    v_mfma_f32_16x16x32_bf16 v[48:51], v[16:19], v[96:99], 0
    v_mfma_f32_16x16x32_bf16 v[52:55], v[16:19], v[104:107], 0
    v_mfma_f32_16x16x32_bf16 v[56:59], v[16:19], v[112:115], 0
    v_mfma_f32_16x16x32_bf16 v[60:63], v[16:19], v[120:123], 0
    v_mfma_f32_16x16x32_bf16 v[64:67], v[16:19], v[128:131], 0
    v_mfma_f32_16x16x32_bf16 v[68:71], v[16:19], v[136:139], 0
    v_mfma_f32_16x16x32_bf16 v[40:43], v[74:77], v[84:87], v[40:43]
    v_mfma_f32_16x16x32_bf16 v[44:47], v[74:77], v[92:95], v[44:47]
    v_mfma_f32_16x16x32_bf16 v[48:51], v[74:77], v[100:103], v[48:51]
    v_mfma_f32_16x16x32_bf16 v[52:55], v[74:77], v[108:111], v[52:55]
    v_mfma_f32_16x16x32_bf16 v[56:59], v[74:77], v[116:119], v[56:59]
    v_mfma_f32_16x16x32_bf16 v[60:63], v[74:77], v[124:127], v[60:63]
    v_mfma_f32_16x16x32_bf16 v[64:67], v[74:77], v[132:135], v[64:67]
    v_mfma_f32_16x16x32_bf16 v[68:71], v[74:77], v[140:143], v[68:71]
    s_waitcnt vmcnt(12)
    ds_read_b128 v[74:77], v78 offset:640
    ds_read_b64_tr_b16 v[144:145], v3 offset:12288
    ds_read_b64_tr_b16 v[146:147], v3 offset:13312
    ds_read_b64_tr_b16 v[152:153], v79 offset:12288
    ds_read_b64_tr_b16 v[154:155], v79 offset:13312
    ds_read_b64_tr_b16 v[160:161], v3 offset:12800
    ds_read_b64_tr_b16 v[162:163], v3 offset:13824
    ds_read_b64_tr_b16 v[168:169], v79 offset:12800
    ds_read_b64_tr_b16 v[170:171], v79 offset:13824
    v_bfe_u32 v16, v0, 4, 1
    v_bfe_u32 v17, v0, 2, 2
    v_lshl_add_u32 v16, v16, 3, v17
    v_mul_u32_u24 v16, 1152, v16
    v_lshrrev_b32 v17, 5, v0
    v_lshl_add_u32 v16, v17, 6, v16
    v_bfe_u32 v17, v0, 4, 1
    v_lshlrev_b32 v17, 1, v17
    v_xor_b32 v17, v0, v17
    v_and_b32 v17, 3, v17
    v_lshl_add_u32 v16, v17, 4, v16
    s_and_b32 s90, s3, 1
    s_mul_i32 s90, s90, 18368
    s_add_u32 s90, s90, s68
    v_add_u32 v16, s90, v16
    s_add_u32 m0, s66, 6144
    s_add_u32 s91, s99, 0
    buffer_load_dwordx4 v16, s[16:19], s91 offen  lds
    s_add_u32 m0, s66, 7168
    s_add_u32 s91, s99, 4608
    buffer_load_dwordx4 v16, s[16:19], s91 offen  lds
    s_add_u32 m0, s66, 8192
    s_add_u32 s91, s99, 36864
    buffer_load_dwordx4 v16, s[16:19], s91 offen  lds
    s_add_u32 m0, s66, 9216
    s_add_u32 s91, s99, 41472
    buffer_load_dwordx4 v16, s[16:19], s91 offen  lds
    s_add_u32 m0, s66, 10240
    s_add_u32 s91, s99, 73728
    buffer_load_dwordx4 v16, s[16:19], s91 offen  lds
    s_add_u32 m0, s66, 11264
    s_add_u32 s91, s99, 78336
    buffer_load_dwordx4 v16, s[16:19], s91 offen  lds
    s_add_u32 m0, s66, 12288
    s_add_u32 s91, s99, 110592
    buffer_load_dwordx4 v16, s[16:19], s91 offen  lds
    s_add_u32 m0, s66, 13312
    s_add_u32 s91, s99, 115200
    buffer_load_dwordx4 v16, s[16:19], s91 offen  lds
    s_waitcnt lgkmcnt(0)
    v_mfma_f32_16x16x32_bf16 v[40:43], v[74:77], v[144:147], v[40:43]
    v_mfma_f32_16x16x32_bf16 v[44:47], v[74:77], v[152:155], v[44:47]
    v_mfma_f32_16x16x32_bf16 v[48:51], v[74:77], v[160:163], v[48:51]
    v_mfma_f32_16x16x32_bf16 v[52:55], v[74:77], v[168:171], v[52:55]
    s_waitcnt vmcnt(16)
    ds_read_b64_tr_b16 v[176:177], v3 offset:16384
    ds_read_b64_tr_b16 v[178:179], v3 offset:17408
    ds_read_b64_tr_b16 v[184:185], v79 offset:16384
    ds_read_b64_tr_b16 v[186:187], v79 offset:17408
    ds_read_b64_tr_b16 v[192:193], v3 offset:16896
    ds_read_b64_tr_b16 v[194:195], v3 offset:17920
    ds_read_b64_tr_b16 v[200:201], v79 offset:16896
    ds_read_b64_tr_b16 v[202:203], v79 offset:17920
    s_and_b32 s70, s60, 3
    s_add_u32 s70, s70, 1
    s_lshl_b32 s70, s70, 7
    v_lshrrev_b32 v28, 5, v0
    v_mul_u32_u24 v28, s70, v28
    v_add_u32 v28, 499712, v28
    buffer_load_dword v29, v28, s[40:43], 0 offen sc1
    s_waitcnt lgkmcnt(0)
    v_mfma_f32_16x16x32_bf16 v[56:59], v[74:77], v[176:179], v[56:59]
    v_mfma_f32_16x16x32_bf16 v[60:63], v[74:77], v[184:187], v[60:63]
    v_mfma_f32_16x16x32_bf16 v[64:67], v[74:77], v[192:195], v[64:67]
    v_mfma_f32_16x16x32_bf16 v[68:71], v[74:77], v[200:203], v[68:71]
    s_waitcnt vmcnt(15)
    s_cmp_lg_u32 s101, 0
    s_cbranch_scc1 L_lag_47
    s_waitcnt vmcnt(13)
L_lag_47:
    s_add_u32 m0, s65, 8192
    s_xor_b32 s78, s64, 262144
    buffer_load_dwordx4 v73, s[8:11], s78 offen nt lds
    s_add_u32 m0, s65, 9216
    s_xor_b32 s78, s64, 327680
    buffer_load_dwordx4 v73, s[8:11], s78 offen nt lds
    s_waitcnt vmcnt(15)
    ds_read_b128 v[74:77], v78 offset:704
    ds_read_b64_tr_b16 v[148:149], v3 offset:0
    ds_read_b64_tr_b16 v[150:151], v3 offset:1024
    ds_read_b64_tr_b16 v[156:157], v79 offset:0
    ds_read_b64_tr_b16 v[158:159], v79 offset:1024
    ds_read_b64_tr_b16 v[164:165], v3 offset:512
    ds_read_b64_tr_b16 v[166:167], v3 offset:1536
    ds_read_b64_tr_b16 v[172:173], v79 offset:512
    ds_read_b64_tr_b16 v[174:175], v79 offset:1536
    s_cmp_lg_u32 s101, 0
    s_cbranch_scc1 L_lag_48
    s_waitcnt vmcnt(13)
L_lag_48:
    s_add_u32 m0, s65, 10240
    s_xor_b32 s78, s64, 266240
    buffer_load_dwordx4 v73, s[8:11], s78 offen nt lds
    s_add_u32 m0, s65, 11264
    s_xor_b32 s78, s64, 331776
    buffer_load_dwordx4 v73, s[8:11], s78 offen nt lds
    s_waitcnt lgkmcnt(0)
    v_mfma_f32_16x16x32_bf16 v[40:43], v[74:77], v[148:151], v[40:43]
    v_mfma_f32_16x16x32_bf16 v[44:47], v[74:77], v[156:159], v[44:47]
    v_mfma_f32_16x16x32_bf16 v[48:51], v[74:77], v[164:167], v[48:51]
    v_mfma_f32_16x16x32_bf16 v[52:55], v[74:77], v[172:175], v[52:55]
    s_waitcnt vmcnt(15)
    s_cmp_lg_u32 s101, 0
    s_cbranch_scc1 L_lag_49
    s_waitcnt vmcnt(13)
L_lag_49:
    s_add_u32 m0, s65, 12288
    s_xor_b32 s78, s64, 262272
    buffer_load_dwordx4 v73, s[8:11], s78 offen nt lds
    s_add_u32 m0, s65, 13312
    s_xor_b32 s78, s64, 327808
    buffer_load_dwordx4 v73, s[8:11], s78 offen nt lds
    s_waitcnt vmcnt(15)
    ds_read_b64_tr_b16 v[180:181], v3 offset:4096
    ds_read_b64_tr_b16 v[182:183], v3 offset:5120
    ds_read_b64_tr_b16 v[188:189], v79 offset:4096
    ds_read_b64_tr_b16 v[190:191], v79 offset:5120
    ds_read_b64_tr_b16 v[196:197], v3 offset:4608
    ds_read_b64_tr_b16 v[198:199], v3 offset:5632
    ds_read_b64_tr_b16 v[204:205], v79 offset:4608
    ds_read_b64_tr_b16 v[206:207], v79 offset:5632
    s_cmp_lg_u32 s101, 0
    s_cbranch_scc1 L_lag_50
    s_waitcnt vmcnt(4)
L_lag_50:
    s_add_u32 m0, s65, 14336
    s_xor_b32 s78, s64, 266368
    buffer_load_dwordx4 v73, s[8:11], s78 offen nt lds
    s_add_u32 m0, s65, 15360
    s_xor_b32 s78, s64, 331904
    buffer_load_dwordx4 v73, s[8:11], s78 offen nt lds
    s_waitcnt lgkmcnt(0)
    v_mfma_f32_16x16x32_bf16 v[56:59], v[74:77], v[180:183], v[56:59]
    v_mfma_f32_16x16x32_bf16 v[60:63], v[74:77], v[188:191], v[60:63]
    v_mfma_f32_16x16x32_bf16 v[64:67], v[74:77], v[196:199], v[64:67]
    v_mfma_f32_16x16x32_bf16 v[68:71], v[74:77], v[204:207], v[68:71]
    s_waitcnt vmcnt(6)
    s_cmp_lg_u32 s101, 0
    s_cbranch_scc1 L_lag_51
    s_waitcnt vmcnt(4)
L_lag_51:
    s_add_u32 m0, s65, 16384
    s_xor_b32 s78, s64, 303104
    buffer_load_dwordx4 v73, s[8:11], s78 offen nt lds
    s_add_u32 m0, s65, 17408
    s_xor_b32 s78, s64, 368640
    buffer_load_dwordx4 v73, s[8:11], s78 offen nt lds
    s_waitcnt vmcnt(6)
    ds_read_b128 v[74:77], v78 offset:768
    ds_read_b64_tr_b16 v[208:209], v3 offset:8192
    ds_read_b64_tr_b16 v[210:211], v3 offset:9216
    ds_read_b64_tr_b16 v[216:217], v79 offset:8192
    ds_read_b64_tr_b16 v[218:219], v79 offset:9216
    ds_read_b64_tr_b16 v[224:225], v3 offset:8704
    ds_read_b64_tr_b16 v[226:227], v3 offset:9728
    ds_read_b64_tr_b16 v[232:233], v79 offset:8704
    ds_read_b64_tr_b16 v[234:235], v79 offset:9728
    s_mov_b32 s80, 0
L_pz_52:
    v_cmp_eq_u32 vcc, -1, v29
    s_cbranch_vccnz L_retry_53
    v_and_b32 v29, 0x2000, v29
    s_nop 0
    v_readlane_b32 s70, v29, 0
    v_readlane_b32 s71, v29, 32
    s_xor_b32 s52, s52, s70
    s_xor_b32 s53, s53, s70
    s_xor_b32 s54, s54, s70
    s_xor_b32 s47, s47, s70
    s_xor_b32 s0, s0, s70
    s_xor_b32 s93, s93, s71
    s_lshr_b32 s71, s71, 11
    s_xor_b32 s55, s55, s71
    s_add_u32 m0, s65, 18432
    s_xor_b32 s78, s64, 307200
    buffer_load_dwordx4 v73, s[8:11], s78 offen nt lds
    s_add_u32 m0, s65, 19456
    s_xor_b32 s78, s64, 372736
    buffer_load_dwordx4 v73, s[8:11], s78 offen nt lds
    s_add_u32 m0, s65, 0
    s_xor_b32 s78, s64, 303232
    buffer_load_dwordx4 v73, s[8:11], s78 offen nt lds
    s_add_u32 m0, s65, 1024
    s_xor_b32 s78, s64, 368768
    buffer_load_dwordx4 v73, s[8:11], s78 offen nt lds
    s_add_u32 m0, s65, 2048
    s_xor_b32 s78, s64, 307328
    buffer_load_dwordx4 v73, s[8:11], s78 offen nt lds
    s_add_u32 m0, s65, 3072
    s_xor_b32 s78, s64, 372864
    buffer_load_dwordx4 v73, s[8:11], s78 offen nt lds
    s_waitcnt lgkmcnt(0)
    v_mfma_f32_16x16x32_bf16 v[40:43], v[74:77], v[208:211], v[40:43]
    v_mfma_f32_16x16x32_bf16 v[44:47], v[74:77], v[216:219], v[44:47]
    v_mfma_f32_16x16x32_bf16 v[48:51], v[74:77], v[224:227], v[48:51]
    v_mfma_f32_16x16x32_bf16 v[52:55], v[74:77], v[232:235], v[52:55]
    s_barrier
    v_mov_b32 v34, 151296
    ds_read_b128 v[8:11], v34
    ds_read_b128 v[12:15], v34 offset:16
    v_lshrrev_b32 v38, 2, v0
    v_and_b32 v39, 3, v0
    v_lshlrev_b32 v39, 2, v39
    v_lshl_add_u32 v38, v38, 7, v39
    s_lshl_b32 s70, s63, 3
    s_sub_u32 s70, 2048, s70
    s_add_u32 s70, s70, s89
    v_mov_b32 v39, 1073741824
    v_writelane_b32 v39, s70, 0
    s_add_u32 s73, s45, s59
    s_add_u32 s73, s73, 0
    v_and_b32 v34, 15, v0
    v_lshrrev_b32 v35, 4, v0
    v_mul_u32_u24 v35, 576, v35
    v_lshl_add_u32 v34, v34, 2, v35
    s_add_u32 s70, s88, 1024
    v_add_u32 v34, s70, v34
    v_lshlrev_b32 v35, 3, v0
    v_add_u32 v35, 148480, v35
    s_waitcnt lgkmcnt(0)
    v_max3_f32 v36, v8, v10, v12
    v_max_f32 v36, v36, v14
    v_sub_f32 v8, v8, v36
    v_sub_f32 v10, v10, v36
    v_exp_f32 v8, v8
    v_sub_f32 v12, v12, v36
    v_exp_f32 v10, v10
    v_sub_f32 v14, v14, v36
    v_exp_f32 v12, v12
    v_mul_f32 v37, v8, v9
    v_exp_f32 v14, v14
    v_fmac_f32 v37, v10, v11
    v_fmac_f32 v37, v12, v13
    v_fmac_f32 v37, v14, v15
    buffer_store_dwordx2 v[36:37], v39, s[40:43], s73 offen
    v_mov_b32 v16, -1
    v_mov_b32 v17, -1
    v_mov_b32 v18, -1
    v_mov_b32 v19, -1
    v_lshlrev_b32 v20, 4, v0
    s_lshl_b32 s90, s61, 2
    s_add_u32 s90, s90, s3
    s_mul_i32 s91, s90, 640
    s_add_u32 s91, s91, s58
    s_mov_b32 exec_hi, 0xff
    buffer_store_dwordx4 v[16:19], v20, s[40:43], s91 offen
    buffer_load_dword v72, v20, s[40:43], s91 offen sc1
    s_mov_b32 exec_hi, -1
    s_lshl_b32 s91, s90, 7
    s_add_u32 s91, s91, s58
    s_add_u32 s91, s91, s59
    v_mov_b32 v20, 0
    buffer_load_dword v72, v20, s[40:43], s91 offen sc1
    v_mov_b32 v20, s89
    buffer_load_dword v72, v20, s[40:43], s1 offen sc1
    s_waitcnt vmcnt(13)
    ds_read_b64_tr_b16 v[240:241], v3 offset:12288
    ds_read_b64_tr_b16 v[242:243], v3 offset:13312
    ds_read_b64_tr_b16 v[244:245], v79 offset:12288
    ds_read_b64_tr_b16 v[246:247], v79 offset:13312
    ds_read_b64_tr_b16 v[248:249], v3 offset:12800
    ds_read_b64_tr_b16 v[250:251], v3 offset:13824
    ds_read_b64_tr_b16 v[252:253], v79 offset:12800
    ds_read_b64_tr_b16 v[254:255], v79 offset:13824
    s_and_b32 s70, s69, 5
    s_cmp_eq_u32 s70, 5
    s_cselect_b32 s101, 1, 0
    s_waitcnt lgkmcnt(0)
    v_mfma_f32_16x16x32_bf16 v[56:59], v[74:77], v[240:243], v[56:59]
    v_mfma_f32_16x16x32_bf16 v[60:63], v[74:77], v[244:247], v[60:63]
    v_mfma_f32_16x16x32_bf16 v[64:67], v[74:77], v[248:251], v[64:67]
    v_mfma_f32_16x16x32_bf16 v[68:71], v[74:77], v[252:255], v[68:71]
    s_waitcnt vmcnt(11)
    s_cmp_lg_u32 s101, 0
    s_cbranch_scc1 L_lag_54
    s_waitcnt vmcnt(9)
L_lag_54:
    s_add_u32 m0, s65, 4096
    s_xor_b32 s78, s64, 263168
    buffer_load_dwordx4 v73, s[8:11], s78 offen nt lds
    s_add_u32 m0, s65, 5120
    s_xor_b32 s78, s64, 328704
    buffer_load_dwordx4 v73, s[8:11], s78 offen nt lds
    s_waitcnt vmcnt(11)
    ds_read_b128 v[74:77], v78 offset:832
    ds_read_b64_tr_b16 v[212:213], v3 offset:16384
    ds_read_b64_tr_b16 v[214:215], v3 offset:17408
    ds_read_b64_tr_b16 v[220:221], v79 offset:16384
    ds_read_b64_tr_b16 v[222:223], v79 offset:17408
    ds_read_b64_tr_b16 v[228:229], v3 offset:16896
    ds_read_b64_tr_b16 v[230:231], v3 offset:17920
    ds_read_b64_tr_b16 v[236:237], v79 offset:16896
    ds_read_b64_tr_b16 v[238:239], v79 offset:17920
    s_getpc_b64 s[56:57]
L_pc_55:
    s_lshl_b32 s90, s61, 2
    s_add_u32 s90, s90, s3
    s_lshl_b32 s90, s90, 8
    v_and_b32 v16, 1, v0
    v_lshl_add_u32 v16, v16, 7, s90
    v_min_u32 v16, L_end_fast-L_pc_55-4, v16
    v_mov_b32 v17, s57
    v_add_co_u32 v16, vcc, s56, v16
    s_nop 1
    v_addc_co_u32 v17, vcc, 0, v17, vcc
    global_load_dword v72, v[16:17], off
    s_cmp_lg_u32 s101, 0
    s_cbranch_scc1 L_lag_56
    s_waitcnt vmcnt(10)
L_lag_56:
    s_add_u32 m0, s65, 6144
    s_xor_b32 s78, s64, 267264
    buffer_load_dwordx4 v73, s[8:11], s78 offen nt lds
    s_add_u32 m0, s65, 7168
    s_xor_b32 s78, s64, 332800
    buffer_load_dwordx4 v73, s[8:11], s78 offen nt lds
    s_waitcnt lgkmcnt(0)
    v_mfma_f32_16x16x32_bf16 v[40:43], v[74:77], v[212:215], v[40:43]
    v_mfma_f32_16x16x32_bf16 v[44:47], v[74:77], v[220:223], v[44:47]
    v_mfma_f32_16x16x32_bf16 v[48:51], v[74:77], v[228:231], v[48:51]
    v_mfma_f32_16x16x32_bf16 v[52:55], v[74:77], v[236:239], v[52:55]
    s_waitcnt vmcnt(12)
    s_cmp_lg_u32 s101, 0
    s_cbranch_scc1 L_lag_57
    s_waitcnt vmcnt(10)
L_lag_57:
    s_add_u32 m0, s65, 8192
    s_xor_b32 s78, s64, 263296
    buffer_load_dwordx4 v73, s[8:11], s78 offen nt lds
    s_add_u32 m0, s65, 9216
    s_xor_b32 s78, s64, 328832
    buffer_load_dwordx4 v73, s[8:11], s78 offen nt lds
    s_waitcnt vmcnt(12)
    ds_read_b64_tr_b16 v[16:17], v3 offset:0
    ds_read_b64_tr_b16 v[18:19], v3 offset:1024
    ds_read_b64_tr_b16 v[20:21], v79 offset:0
    ds_read_b64_tr_b16 v[22:23], v79 offset:1024
    ds_read_b64_tr_b16 v[24:25], v3 offset:512
    ds_read_b64_tr_b16 v[26:27], v3 offset:1536
    ds_read_b64_tr_b16 v[28:29], v79 offset:512
    ds_read_b64_tr_b16 v[30:31], v79 offset:1536
    s_cmp_lg_u32 s101, 0
    s_cbranch_scc1 L_lag_58
    s_waitcnt vmcnt(5)
L_lag_58:
    s_add_u32 m0, s65, 10240
    s_xor_b32 s78, s64, 267392
    buffer_load_dwordx4 v73, s[8:11], s78 offen nt lds
    s_add_u32 m0, s65, 11264
    s_xor_b32 s78, s64, 332928
    buffer_load_dwordx4 v73, s[8:11], s78 offen nt lds
    s_waitcnt lgkmcnt(0)
    v_mfma_f32_16x16x32_bf16 v[56:59], v[74:77], v[16:19], v[56:59]
    v_mfma_f32_16x16x32_bf16 v[60:63], v[74:77], v[20:23], v[60:63]
    v_mfma_f32_16x16x32_bf16 v[64:67], v[74:77], v[24:27], v[64:67]
    v_mfma_f32_16x16x32_bf16 v[68:71], v[74:77], v[28:31], v[68:71]
    s_waitcnt vmcnt(7)
    s_cmp_lg_u32 s101, 0
    s_cbranch_scc1 L_lag_59
    s_waitcnt vmcnt(4)
L_lag_59:
    s_add_u32 m0, s65, 12288
    s_xor_b32 s78, s64, 304128
    buffer_load_dwordx4 v73, s[8:11], s78 offen nt lds
    s_add_u32 m0, s65, 13312
    s_xor_b32 s78, s64, 369664
    buffer_load_dwordx4 v73, s[8:11], s78 offen nt lds
    s_waitcnt vmcnt(6)
    ds_read_b128 v[74:77], v78 offset:896
    ds_read_b64_tr_b16 v[16:17], v3 offset:4096
    ds_read_b64_tr_b16 v[18:19], v3 offset:5120
    ds_read_b64_tr_b16 v[20:21], v79 offset:4096
    ds_read_b64_tr_b16 v[22:23], v79 offset:5120
    ds_read_b64_tr_b16 v[24:25], v3 offset:4608
    ds_read_b64_tr_b16 v[26:27], v3 offset:5632
    ds_read_b64_tr_b16 v[28:29], v79 offset:4608
    ds_read_b64_tr_b16 v[30:31], v79 offset:5632
    s_lshr_b32 s90, s61, 3
    s_lshl_b32 s90, s90, 1
    s_and_b32 s91, s61, 1
    s_add_u32 s90, s90, s91
    s_xor_b32 s92, s67, 1073741824
    s_lshl_b32 s90, s90, 2
    s_add_u32 s90, s90, s3
    s_mul_i32 s90, s90, 64
    v_min_u32 v32, 63, v0
    v_add_u32 v32, s90, v32
    v_min_u32 v32, 2047, v32
    v_lshrrev_b32 v33, 3, v32
    v_and_b32 v32, 7, v32
    v_lshlrev_b32 v32, 7, v32
    v_lshl_add_u32 v32, v33, 13, v32
    s_lshl_b32 s91, s60, 10
    v_add_u32 v32, s92, v32
    buffer_load_dword v72, v32, s[28:31], s91 offen
    v_and_b32 v32, 7, v0
    v_lshlrev_b32 v32, 4, v32
    v_bfe_u32 v33, v0, 3, 1
    v_lshl_add_u32 v32, v33, 9, v32
    v_lshrrev_b32 v33, 4, v0
    v_lshl_add_u32 v32, v33, 7, v32
    v_lshl_add_u32 v33, v33, 2, v0
    v_and_b32 v33, 7, v33
    v_lshlrev_b32 v33, 3, v33
    s_add_u32 s79, s46, s59
    s_add_u32 s79, s79, 0
    buffer_load_dwordx2 v[36:37], v33, s[40:43], s79 offen offset:2048 sc1
    s_cmp_lg_u32 s101, 0
    s_cbranch_scc1 L_lag_60
    s_waitcnt vmcnt(6)
L_lag_60:
    s_add_u32 m0, s65, 14336
    s_xor_b32 s78, s64, 308224
    buffer_load_dwordx4 v73, s[8:11], s78 offen nt lds
    s_add_u32 m0, s65, 15360
    s_xor_b32 s78, s64, 373760
    buffer_load_dwordx4 v73, s[8:11], s78 offen nt lds
    s_waitcnt lgkmcnt(0)
    v_mfma_f32_16x16x32_bf16 v[40:43], v[74:77], v[16:19], v[40:43]
    v_mfma_f32_16x16x32_bf16 v[44:47], v[74:77], v[20:23], v[44:47]
    v_mfma_f32_16x16x32_bf16 v[48:51], v[74:77], v[24:27], v[48:51]
    v_mfma_f32_16x16x32_bf16 v[52:55], v[74:77], v[28:31], v[52:55]
    s_waitcnt vmcnt(8)
    s_cmp_lg_u32 s101, 0
    s_cbranch_scc1 L_lag_61
    s_waitcnt vmcnt(6)
L_lag_61:
    s_add_u32 m0, s65, 16384
    s_xor_b32 s78, s64, 304256
    buffer_load_dwordx4 v73, s[8:11], s78 offen nt lds
    s_add_u32 m0, s65, 17408
    s_xor_b32 s78, s64, 369792
    buffer_load_dwordx4 v73, s[8:11], s78 offen nt lds
    s_waitcnt vmcnt(8)
    ds_read_b64_tr_b16 v[16:17], v3 offset:8192
    ds_read_b64_tr_b16 v[18:19], v3 offset:9216
    ds_read_b64_tr_b16 v[20:21], v79 offset:8192
    ds_read_b64_tr_b16 v[22:23], v79 offset:9216
    ds_read_b64_tr_b16 v[24:25], v3 offset:8704
    ds_read_b64_tr_b16 v[26:27], v3 offset:9728
    ds_read_b64_tr_b16 v[28:29], v79 offset:8704
    ds_read_b64_tr_b16 v[30:31], v79 offset:9728
    s_cmp_lg_u32 s101, 0
    s_cbranch_scc1 L_lag_62
    s_waitcnt vmcnt(6)
L_lag_62:
    s_add_u32 m0, s65, 18432
    s_xor_b32 s78, s64, 308352
    buffer_load_dwordx4 v73, s[8:11], s78 offen nt lds
    s_add_u32 m0, s65, 19456
    s_xor_b32 s78, s64, 373888
    buffer_load_dwordx4 v73, s[8:11], s78 offen nt lds
    s_waitcnt lgkmcnt(0)
    v_mfma_f32_16x16x32_bf16 v[56:59], v[74:77], v[16:19], v[56:59]
    v_mfma_f32_16x16x32_bf16 v[60:63], v[74:77], v[20:23], v[60:63]
    v_mfma_f32_16x16x32_bf16 v[64:67], v[74:77], v[24:27], v[64:67]
    v_mfma_f32_16x16x32_bf16 v[68:71], v[74:77], v[28:31], v[68:71]
    s_waitcnt vmcnt(4)
    ds_read_b128 v[74:77], v78 offset:960
    ds_read_b64_tr_b16 v[16:17], v3 offset:12288
    ds_read_b64_tr_b16 v[18:19], v3 offset:13312
    ds_read_b64_tr_b16 v[20:21], v79 offset:12288
    ds_read_b64_tr_b16 v[22:23], v79 offset:13312
    ds_read_b64_tr_b16 v[24:25], v3 offset:12800
    ds_read_b64_tr_b16 v[26:27], v3 offset:13824
    ds_read_b64_tr_b16 v[28:29], v79 offset:12800
    ds_read_b64_tr_b16 v[30:31], v79 offset:13824
    v_max_f32_dpp v9, v36, v36 row_ror:1 row_mask:0xf bank_mask:0xf
    s_nop 1
    v_max_f32_dpp v9, v9, v9 row_ror:2 row_mask:0xf bank_mask:0xf
    s_nop 1
    v_max_f32_dpp v9, v9, v9 row_ror:4 row_mask:0xf bank_mask:0xf
    v_sub_f32 v9, v36, v9
    v_exp_f32 v9, v9
    s_nop 0
    v_mul_f32 v11, v9, v37
    s_nop 1
    v_add_f32_dpp v11, v11, v11 row_ror:1 row_mask:0xf bank_mask:0xf
    s_nop 1
    v_add_f32_dpp v11, v11, v11 row_ror:2 row_mask:0xf bank_mask:0xf
    s_nop 1
    v_add_f32_dpp v11, v11, v11 row_ror:4 row_mask:0xf bank_mask:0xf
    v_rcp_f32 v11, v11
    s_nop 0
    v_mul_f32 v9, v9, v11
    s_nop 1
    v_mov_b32_dpp v36, v9 row_newbcast:0 row_mask:0xf bank_mask:0xf
    v_mov_b32_dpp v37, v9 row_newbcast:1 row_mask:0xf bank_mask:0xf
    v_mov_b32_dpp v72, v9 row_newbcast:2 row_mask:0xf bank_mask:0xf
    v_mov_b32_dpp v73, v9 row_newbcast:3 row_mask:0xf bank_mask:0xf
    s_waitcnt lgkmcnt(0)
    v_mfma_f32_16x16x32_bf16 v[40:43], v[74:77], v[16:19], v[40:43]
    v_mfma_f32_16x16x32_bf16 v[44:47], v[74:77], v[20:23], v[44:47]
    v_mfma_f32_16x16x32_bf16 v[48:51], v[74:77], v[24:27], v[48:51]
    v_mfma_f32_16x16x32_bf16 v[52:55], v[74:77], v[28:31], v[52:55]
    s_waitcnt vmcnt(0)
    ds_read_b64_tr_b16 v[16:17], v3 offset:16384
    ds_read_b64_tr_b16 v[18:19], v3 offset:17408
    ds_read_b64_tr_b16 v[20:21], v79 offset:16384
    ds_read_b64_tr_b16 v[22:23], v79 offset:17408
    ds_read_b64_tr_b16 v[24:25], v3 offset:16896
    ds_read_b64_tr_b16 v[26:27], v3 offset:17920
    ds_read_b64_tr_b16 v[28:29], v79 offset:16896
    ds_read_b64_tr_b16 v[30:31], v79 offset:17920
    s_waitcnt lgkmcnt(6)
    v_mfma_f32_16x16x32_bf16 v[56:59], v[74:77], v[16:19], v[56:59]
    s_waitcnt lgkmcnt(4)
    v_mfma_f32_16x16x32_bf16 v[60:63], v[74:77], v[20:23], v[60:63]
    s_waitcnt lgkmcnt(2)
    v_mfma_f32_16x16x32_bf16 v[64:67], v[74:77], v[24:27], v[64:67]
    s_waitcnt lgkmcnt(0)
    v_mfma_f32_16x16x32_bf16 v[68:71], v[74:77], v[28:31], v[68:71]
    ds_write2_b32 v34, v40, v44 offset0:0 offset1:16
    ds_write2_b32 v34, v48, v52 offset0:32 offset1:48
    v_mov_b32 v24, -1
    v_mov_b32 v25, -1
    v_mov_b32 v26, -1
    v_mov_b32 v27, -1
    ds_write2_b32 v34, v56, v60 offset0:64 offset1:80
    v_mov_b32 v28, -1
    ds_write2_b32 v34, v64, v68 offset0:96 offset1:112
    v_mov_b32 v29, -1
    v_mov_b32 v30, -1
    v_mov_b32 v31, -1
    s_cmp_lg_u32 s3, 0
    s_waitcnt lgkmcnt(0)
    s_barrier
    s_cbranch_scc1 L_skip_63
    ds_read_b64 v[16:17], v35
    ds_read_b64 v[18:19], v35 offset:4096
    ds_read_b64 v[20:21], v35 offset:8192
    ds_read_b64 v[22:23], v35 offset:12288
    s_waitcnt lgkmcnt(3)
    v_pk_mul_f32 v[16:17], v[16:17], v[8:9] op_sel_hi:[1,0]
    s_waitcnt lgkmcnt(2)
    v_pk_fma_f32 v[16:17], v[18:19], v[10:11], v[16:17] op_sel_hi:[1,0,1]
    s_waitcnt lgkmcnt(1)
    v_pk_fma_f32 v[16:17], v[20:21], v[12:13], v[16:17] op_sel_hi:[1,0,1]
    s_waitcnt lgkmcnt(0)
    v_pk_fma_f32 v[16:17], v[22:23], v[14:15], v[16:17] op_sel_hi:[1,0,1]
    v_cvt_pk_bf16_f32 v16, v16, v17
    buffer_store_dword v16, v38, s[40:43], s73 offen
L_skip_63:
    s_cmp_ge_u32 s61, 18
    s_cbranch_scc1 L_idle_64
    buffer_load_dwordx4 v[24:27], v32, s[40:43], s79 offen offset:0 sc1
    buffer_load_dwordx4 v[28:31], v32, s[40:43], s79 offen offset:1024 sc1
    v_lshrrev_b32 v18, 5, v0
    s_add_u32 s70, s88, 3584
    v_lshl_add_u32 v78, v0, 2, s70
    s_and_b32 s90, s3, 1
    s_mov_b32 s71, 151040
    v_and_b32 v74, 7, v0
    v_subrev_u32 v18, s90, v18
    v_lshlrev_b32 v74, 4, v74
    v_bfe_u32 v79, v0, 2, 1
    v_mul_i32_i24 v18, 15872, v18
    v_lshl_add_u32 v79, v79, 7, v74
    v_bfe_u32 v75, v0, 4, 1
    v_add_u32 v18, v18, v2
    v_lshl_add_u32 v75, v75, 13, v74
    v_bfe_u32 v8, v0, 3, 1
    v_xor_b32 v19, 32, v18
    v_lshl_add_u32 v75, v8, 11, v75
    v_lshl_add_u32 v74, v8, 8, v74
    ds_read_b64_tr_b16 v[40:41], v18 offset:6144
    v_lshlrev_b32 v8, 12, v8
    v_add3_u32 v79, v79, v8, s71
    ds_read_b64_tr_b16 v[42:43], v18 offset:7168
    s_and_b32 s70, s61, 30
    buffer_load_dwordx4 v[24:27], v32, s[40:43], s79 offen offset:0 sc1
    buffer_load_dwordx4 v[28:31], v32, s[40:43], s79 offen offset:1024 sc1
    s_add_u32 s73, s70, 0
    ds_read_b64_tr_b16 v[44:45], v19 offset:6144
    s_and_b32 s71, s73, -4
    s_add_u32 s73, s73, s71
    ds_read_b64_tr_b16 v[46:47], v19 offset:7168
    s_lshl_b32 s73, s73, 11
    s_add_u32 s73, s73, 901120
    ds_read_b64_tr_b16 v[48:49], v18 offset:8192
    s_and_b32 s71, s61, 1
    s_lshl_b32 s69, s60, 1
    ds_read_b64_tr_b16 v[50:51], v18 offset:9216
    s_add_u32 s69, s69, s71
    s_lshl_b32 s69, s69, 7
    ds_read_b64_tr_b16 v[52:53], v19 offset:8192
    s_add_u32 s73, s73, s69
    s_add_u32 s70, s70, s61
    ds_read_b64_tr_b16 v[54:55], v19 offset:9216
    s_lshl_b32 s70, s70, 7
    s_add_u32 s69, s58, s70
    ds_read_b64_tr_b16 v[56:57], v18 offset:10240
    s_add_u32 s69, s69, s59
    s_add_u32 s69, s69, 8704
    ds_read_b64_tr_b16 v[58:59], v18 offset:11264
    ds_read_b64_tr_b16 v[60:61], v19 offset:10240
    ds_read_b64_tr_b16 v[62:63], v19 offset:11264
    ds_read_b64_tr_b16 v[64:65], v18 offset:12288
    ds_read_b64_tr_b16 v[66:67], v18 offset:13312
    ds_read_b64_tr_b16 v[68:69], v19 offset:12288
    ds_read_b64_tr_b16 v[70:71], v19 offset:13312
    s_mov_b32 s80, 0
L_mlw_66:
    v_cmp_u_f32 vcc, v36, v36
    s_cbranch_vccnz L_mlr_67
    v_bfe_u32 v76, v0, 2, 3
    v_lshlrev_b32 v76, 10, v76
    v_lshrrev_b32 v77, 5, v0
    v_lshl_add_u32 v76, v77, 6, v76
    v_bfe_u32 v77, v0, 4, 1
    v_lshlrev_b32 v77, 1, v77
    v_xor_b32 v77, v0, v77
    v_and_b32 v77, 3, v77
    v_lshl_add_u32 v76, v77, 4, v76
    s_mov_b32 s80, 0
L_spin_68:
    buffer_load_dwordx4 v[24:27], v32, s[40:43], s79 offen offset:0 sc1
    buffer_load_dwordx4 v[28:31], v32, s[40:43], s79 offen offset:1024 sc1
    s_add_u32 s80, s80, 1024
    s_cbranch_scc1 L_abort
    s_waitcnt vmcnt(2)
    v_cmp_u_f32 vcc, v27, v31
    s_cbranch_vccnz L_spin_68
    s_waitcnt lgkmcnt(0)
    v_mfma_f32_16x16x32_bf16 v[16:19], v[24:27], v[48:51], 0
    v_mfma_f32_16x16x32_bf16 v[16:19], v[28:31], v[64:67], v[16:19]
    v_mfma_f32_16x16x32_bf16 v[12:15], v[24:27], v[44:47], 0
    v_mfma_f32_16x16x32_bf16 v[12:15], v[28:31], v[60:63], v[12:15]
    v_mfma_f32_16x16x32_bf16 v[8:11], v[24:27], v[40:43], 0
    v_mfma_f32_16x16x32_bf16 v[8:11], v[28:31], v[56:59], v[8:11]
    v_mfma_f32_16x16x32_bf16 v[20:23], v[24:27], v[52:55], 0
    v_mfma_f32_16x16x32_bf16 v[20:23], v[28:31], v[68:71], v[20:23]
    s_nop 1
    v_pk_mul_f32 v[16:17], v[16:17], v[36:37]
    v_pk_fma_f32 v[16:17], v[18:19], v[72:73], v[16:17]
    v_add_f32 v16, v16, v17
    v_pk_mul_f32 v[12:13], v[12:13], v[36:37]
    v_pk_fma_f32 v[12:13], v[14:15], v[72:73], v[12:13]
    v_add_f32 v12, v12, v13
    v_pk_mul_f32 v[8:9], v[8:9], v[36:37]
    v_pk_fma_f32 v[8:9], v[10:11], v[72:73], v[8:9]
    v_add_f32 v8, v8, v9
    v_permlane32_swap_b32 v16, v12
    v_add_f32 v8, v8, v12
    v_pk_mul_f32 v[20:21], v[20:21], v[36:37]
    v_pk_fma_f32 v[20:21], v[22:23], v[72:73], v[20:21]
    v_add_f32 v20, v20, v21
    v_add_f32 v20, v20, v16
    s_nop 1
    v_permlane16_swap_b32 v8, v20
    v_add_f32 v34, v8, v20
    ds_write_b32 v78, v34
    v_cmp_u_f32 vcc, v34, v34
    s_cbranch_vccnz L_spin_68
    s_cmp_lg_u32 s3, 0
    s_waitcnt lgkmcnt(0)
    s_barrier
    s_cbranch_scc1 L_skip_71
    s_mov_b32 exec_hi, 0
    ds_read_b128 v[8:11], v79
    ds_read_b128 v[12:15], v79 offset:8192
    s_waitcnt vmcnt(0) lgkmcnt(0)
    v_pk_add_f32 v[32:33], v[8:9], v[12:13]
    v_pk_add_f32 v[34:35], v[10:11], v[14:15]
    buffer_store_dwordx4 v[32:35], v75, s[40:43], s73 offen sc1
    buffer_store_dwordx4 v[32:35], v74, s[40:43], s69 offen
    s_mov_b64 exec, -1
    s_branch L_skip_71x
L_skip_71:
    s_waitcnt vmcnt(0)
L_skip_71x:
L_join_65:
    s_add_u32 m0, s66, 8192
    s_add_u32 s91, s93, 65536
    buffer_load_dwordx4 v76, s[20:23], s91 offen nt lds
    s_add_u32 m0, s66, 9088
    s_nop 0
    buffer_load_dwordx4 v76, s[20:23], s91 offen offset:128 nt lds
    s_add_u32 m0, s66, 10240
    s_add_u32 s91, s93, 81920
    buffer_load_dwordx4 v76, s[20:23], s91 offen nt lds
    s_add_u32 m0, s66, 11136
    s_nop 0
    buffer_load_dwordx4 v76, s[20:23], s91 offen offset:128 nt lds
    s_add_u32 m0, s66, 12288
    s_add_u32 s91, s93, 98304
    buffer_load_dwordx4 v76, s[20:23], s91 offen nt lds
    s_add_u32 m0, s66, 13184
    s_nop 0
    buffer_load_dwordx4 v76, s[20:23], s91 offen offset:128 nt lds
    s_add_u32 m0, s66, 14336
    s_add_u32 s91, s93, 114688
    buffer_load_dwordx4 v76, s[20:23], s91 offen nt lds
    s_add_u32 m0, s66, 15232
    s_nop 0
    buffer_load_dwordx4 v76, s[20:23], s91 offen offset:128 nt lds
    v_lshrrev_b32 v22, 5, v0
    s_and_b32 s90, s3, 1
    v_subrev_u32 v22, s90, v22
    v_mul_i32_i24 v22, 15872, v22
    v_add_u32 v22, v22, v2
    v_xor_b32 v23, 32, v22
    ds_read_b64_tr_b16 v[36:37], v22 offset:0
    ds_read_b64_tr_b16 v[38:39], v22 offset:1024
    ds_read_b64_tr_b16 v[40:41], v23 offset:0
    ds_read_b64_tr_b16 v[42:43], v23 offset:1024
    ds_read_b64_tr_b16 v[44:45], v22 offset:2048
    ds_read_b64_tr_b16 v[46:47], v22 offset:3072
    ds_read_b64_tr_b16 v[48:49], v23 offset:2048
    ds_read_b64_tr_b16 v[50:51], v23 offset:3072
    ds_read_b64_tr_b16 v[52:53], v22 offset:4096
    ds_read_b64_tr_b16 v[54:55], v22 offset:5120
    ds_read_b64_tr_b16 v[56:57], v23 offset:4096
    ds_read_b64_tr_b16 v[58:59], v23 offset:5120
    s_waitcnt lgkmcnt(0)
    s_barrier
    s_add_u32 s79, s44, 0
    s_cmp_ge_u32 s63, 6
    s_cbranch_scc1 L_qidle_72
    v_lshrrev_b32 v14, 3, v0
    v_lshlrev_b32 v12, 8, v14
    v_and_b32 v13, 7, v0
    v_lshl_add_u32 v12, v13, 4, v12
    s_mul_i32 s70, s63, 3
    s_add_u32 s70, s70, s3
    s_add_u32 s76, s70, 0
    s_and_b32 s71, s76, -4
    s_add_u32 s76, s76, s71
    s_lshl_b32 s76, s76, 11
    s_add_u32 s76, s76, 901120
    s_add_u32 s76, s76, s52
    s_sub_u32 s70, s70, s60
    s_lshl_b32 s70, s70, 8
    s_add_u32 s70, s70, s58
    s_add_u32 s70, s70, s59
    s_add_u32 s70, s70, 8704
    s_sub_u32 s70, s70, s76
    v_add_u32 v12, s76, v12
    s_mov_b32 s76, 0
    v_cmp_eq_u32 vcc, s60, v14
    v_add_u32 v15, s70, v12
    s_nop 0
    v_cndmask_b32 v12, v12, v15, vcc
    s_cmp_eq_u32 s3, 3
    s_cselect_b32 s70, 1073741824, 0
    v_add_u32 v12, s70, v12
    v_lshrrev_b32 v14, 4, v0
    v_lshlrev_b32 v13, 3, v13
    v_lshl_add_u32 v13, v14, 1, v13
    s_lshl_b32 s70, s3, 6
    s_add_u32 s70, s70, 150784
    v_add_u32 v13, s70, v13
    v_lshlrev_b32 v14, 4, v14
    v_and_b32 v15, 3, v0
    v_lshl_add_u32 v14, v15, 6, v14
    v_add_u32 v14, 150784, v14
    v_mov_b32 v24, -1
    v_mov_b32 v25, -1
    v_mov_b32 v26, -1
    v_mov_b32 v27, -1
    v_mov_b32 v28, -1
    v_mov_b32 v29, -1
    v_mov_b32 v30, -1
    v_mov_b32 v31, -1
    s_lshl_b32 s73, s63, 8
    s_add_u32 s73, s73, s79
    buffer_load_dwordx4 v[24:27], v12, s[40:43], s76 offen sc1
    buffer_load_dwordx4 v[28:31], v12, s[40:43], s76 offen offset:128 sc1
    v_bfe_u32 v16, v0, 2, 3
    v_lshlrev_b32 v16, 13, v16
    v_lshrrev_b32 v17, 5, v0
    v_lshl_add_u32 v16, v17, 6, v16
    v_bfe_u32 v17, v0, 4, 1
    v_lshlrev_b32 v17, 1, v17
    v_xor_b32 v17, v0, v17
    v_and_b32 v17, 3, v17
    v_lshl_add_u32 v16, v17, 4, v16
    s_lshl_b32 s90, s63, 2
    s_add_u32 s90, s90, s3
    s_lshl_b32 s90, s90, 9
    s_lshr_b32 s91, s64, 21
    s_add_u32 s90, s90, s91
    s_lshl_b32 s90, s90, 8
    s_add_u32 m0, s66, 0
    s_add_u32 s91, s90, 0
    buffer_load_dwordx4 v16, s[28:31], s91 offen  lds
    s_add_u32 m0, s66, 896
    s_nop 0
    buffer_load_dwordx4 v16, s[28:31], s91 offen offset:128  lds
    s_add_u32 m0, s66, 2048
    s_add_u32 s91, s90, 65536
    buffer_load_dwordx4 v16, s[28:31], s91 offen  lds
    s_add_u32 m0, s66, 2944
    s_nop 0
    buffer_load_dwordx4 v16, s[28:31], s91 offen offset:128  lds
    s_mov_b32 s80, 0
    v_cmp_u_f32 vcc, v27, v31
    s_cbranch_vccz L_go_75
    s_branch L_chk_76
L_spin_74:
    s_waitcnt vmcnt(16)
    buffer_load_dwordx4 v[24:27], v12, s[40:43], s76 offen sc1
    buffer_load_dwordx4 v[28:31], v12, s[40:43], s76 offen offset:128 sc1
    s_add_u32 s80, s80, 1024
    s_cbranch_scc1 L_abort
L_chk_76:
    v_cmp_u_f32 vcc, v27, v31
    s_cbranch_vccz L_go_75
    v_cmp_u_f32 vcc, v27, v31
    s_cbranch_vccz L_go_75
    v_cmp_u_f32 vcc, v27, v31
    s_cbranch_vccz L_go_75
    v_cmp_u_f32 vcc, v27, v31
    s_cbranch_vccz L_go_75
    v_cmp_u_f32 vcc, v27, v31
    s_cbranch_vccz L_go_75
    v_cmp_u_f32 vcc, v27, v31
    s_cbranch_vccz L_go_75
    v_cmp_u_f32 vcc, v27, v31
    s_cbranch_vccz L_go_75
    v_cmp_u_f32 vcc, v27, v31
    s_cbranch_vccz L_go_75
    v_cmp_u_f32 vcc, v27, v31
    s_cbranch_vccz L_go_75
    v_cmp_u_f32 vcc, v27, v31
    s_cbranch_vccnz L_spin_74
L_go_75:
    v_pk_add_f32 v[8:9], v[24:25], v[28:29]
    v_pk_add_f32 v[10:11], v[26:27], v[30:31]
    s_nop 1
    v_permlane32_swap_b32 v8, v10
    v_permlane32_swap_b32 v9, v11
    v_add_f32 v8, v8, v10
    v_add_f32 v9, v9, v11
    s_nop 1
    v_permlane16_swap_b32 v8, v9
    v_add_f32 v8, v8, v9
    s_nop 1
    v_add_f32_dpp v8, v8, v8 row_ror:8 row_mask:0xf bank_mask:0xf
    v_add_f32 v8, v8, v4
    v_cvt_pk_bf16_f32 v9, v8, v8
    ds_write_b16 v13, v9
    v_cmp_u_f32 vcc, v8, v8
    s_cbranch_vccnz L_spin_74
    v_lshlrev_b32 v4, 16, v9
    s_waitcnt lgkmcnt(0)
    s_barrier
    ds_read_b128 v[76:79], v14
    s_waitcnt lgkmcnt(0)
    v_mfma_f32_16x16x32_bf16 v[32:35], v[76:79], v[76:79], 0
    v_mfma_f32_16x16x32_bf16 v[8:11], v[76:79], v[36:39], 0
    v_lshlrev_b32 v36, 4, v0
    v_and_b32 v37, 32, v0
    v_mfma_f32_16x16x32_bf16 v[12:15], v[76:79], v[40:43], 0
    v_lshl_add_u32 v37, v37, 26, v36
    v_mov_b32 v40, -1
    v_mfma_f32_16x16x32_bf16 v[16:19], v[76:79], v[44:47], 0
    v_mov_b32 v41, -1
    v_mov_b32 v42, -1
    v_mfma_f32_16x16x32_bf16 v[20:23], v[76:79], v[48:51], 0
    v_mov_b32 v43, -1
    v_mov_b32 v44, -1
    s_waitcnt vmcnt(0)
    v_mfma_f32_16x16x32_bf16 v[24:27], v[76:79], v[52:55], 0
    v_mov_b32 v45, -1
    v_mov_b32 v46, -1
    v_mfma_f32_16x16x32_bf16 v[28:31], v[76:79], v[56:59], 0
    v_mov_b32 v47, -1
    s_mov_b64 exec, 0xffff
    v_mov_b32_dpp v10, v32 row_newbcast:0 row_mask:0xf bank_mask:0xf
    v_mov_b32_dpp v11, v35 row_newbcast:0 row_mask:0xf bank_mask:0xf
    v_add_f32 v8, v8, v17
    v_add_f32_dpp v10, v33, v10 row_newbcast:1 row_mask:0xf bank_mask:0xf
    v_add_f32_dpp v11, v35, v11 row_newbcast:1 row_mask:0xf bank_mask:0xf
    v_add_f32 v9, v12, v21
    v_add_f32_dpp v10, v34, v10 row_newbcast:2 row_mask:0xf bank_mask:0xf
    v_add_f32_dpp v11, v35, v11 row_newbcast:2 row_mask:0xf bank_mask:0xf
    v_add_f32 v8, v8, v26
    v_add_f32 v9, v9, v30
    buffer_store_dwordx4 v[8:11], v36, s[40:43], s73 offen
    s_mov_b64 exec, -1
L_qjoin_73:
    buffer_load_dwordx4 v[40:43], v36, s[40:43], s79 offen sc1
    buffer_load_dwordx4 v[44:47], v37, s[40:43], s79 offen offset:1024 sc1
    v_and_b32 v26, 7, v0
    v_lshlrev_b32 v26, 6, v26
    v_bfe_u32 v27, v0, 3, 1
    v_lshl_add_u32 v26, v27, 11, v26
    v_lshlrev_b32 v27, 3, v0
    v_and_b32 v27, 32, v27
    v_xor_b32 v27, v0, v27
    v_and_b32 v27, 48, v27
    v_add3_u32 v26, v26, v27, s66
    ds_read_b128 v[60:63], v26 offset:0
    ds_read_b128 v[64:67], v26 offset:512
    ds_read_b128 v[68:71], v26 offset:1024
    ds_read_b128 v[72:75], v26 offset:1536
    v_lshrrev_b32 v22, 4, v0
    v_and_b32 v23, 1, v22
    v_lshlrev_b32 v22, 4, v22
    v_mul_u32_u24 v23, 4080, v23
    v_add_u32 v22, v23, v22
    v_and_b32 v23, 15, v0
    v_lshl_add_u32 v22, v23, 1, v22
    s_lshl_b32 s70, s3, 6
    s_add_u32 s70, s70, 154880
    v_add_u32 v22, s70, v22
    v_lshrrev_b32 v25, 4, v0
    v_lshlrev_b32 v24, 4, v25
    v_add_u32 v24, 154880, v24
    v_lshlrev_b32 v25, 3, v25
    v_and_b32 v21, 1, v0
    v_lshl_add_u32 v21, v21, 13, v25
    s_lshl_b32 s69, s61, 2
    s_add_u32 s69, s69, s3
    s_lshl_b32 s69, s69, 5
    s_and_b32 s77, s60, 6
    s_add_u32 s77, s77, s60
    s_lshl_b32 s77, s77, 12
    s_add_u32 s77, s77, 540672
    s_add_u32 s73, s69, s77
    s_add_u32 s69, s69, s58
    s_add_u32 s69, s69, 64512
    s_sub_u32 s77, s69, s73
    s_sub_u32 s77, s77, s52
    v_bfe_u32 v58, v0, 2, 3
    v_lshlrev_b32 v58, 10, v58
    v_lshrrev_b32 v59, 5, v0
    v_lshl_add_u32 v58, v59, 6, v58
    v_bfe_u32 v59, v0, 4, 1
    v_lshlrev_b32 v59, 1, v59
    v_xor_b32 v59, v0, v59
    v_and_b32 v59, 3, v59
    v_lshl_add_u32 v58, v59, 4, v58
    s_mov_b32 s80, 0
L_spin_80:
    buffer_load_dwordx4 v[40:43], v36, s[40:43], s79 offen sc1
    buffer_load_dwordx4 v[44:47], v37, s[40:43], s79 offen offset:1024 sc1
    s_add_u32 s80, s80, 1024
    s_cbranch_scc1 L_abort
    s_waitcnt vmcnt(2)
    v_cmp_u_f32 vcc, v43, v47
    s_cbranch_vccnz L_spin_80
    v_pk_add_f32 v[12:13], v[40:41], v[44:45]
    v_pk_add_f32 v[14:15], v[42:43], v[46:47]
    s_nop 0
    v_permlane32_swap_b32 v12, v13
    v_permlane32_swap_b32 v14, v15
    v_add_f32 v12, v12, v13
    v_add_f32 v14, v14, v15
    s_nop 1
    v_permlane16_swap_b32 v12, v14
    v_add_f32 v12, v12, v14
    s_nop 0
    v_readlane_b32 s71, v12, 48
    v_readlane_b32 s72, v12, 16
    v_cmp_u_f32 vcc, v12, v12
    v_fma_f32 v13, -s71, v6, v12
    v_cvt_pk_bf16_f32 v13, v13, v13
    ds_write_b16 v22, v13
    s_cbranch_vccnz L_spin_80
    v_mov_b32 v14, 0x3ae38e39
    v_mul_f32 v15, s71, v14
    v_mul_f32 v14, s72, v14
    v_fma_f32 v14, -v15, v15, v14
    v_max_f32 v14, 0, v14
    v_add_f32 v14, 0x3727c5ac, v14
    v_rsq_f32 v14, v14
    s_waitcnt lgkmcnt(0)
    s_barrier
    ds_read_b128 v[28:31], v24 offset:0
    ds_read_b128 v[32:35], v24 offset:64
    ds_read_b128 v[48:51], v24 offset:128
    ds_read_b128 v[52:55], v24 offset:192
    v_mul_f32 v14, 0x3e0293ee, v14
    s_nop 0
    v_readfirstlane_b32 s81, v14
    s_waitcnt lgkmcnt(3)
    v_mfma_f32_16x16x32_bf16 v[8:11], v[60:63], v[28:31], 0
    s_waitcnt lgkmcnt(2)
    v_mfma_f32_16x16x32_bf16 v[8:11], v[64:67], v[32:35], v[8:11]
    s_waitcnt lgkmcnt(1)
    v_mfma_f32_16x16x32_bf16 v[8:11], v[68:71], v[48:51], v[8:11]
    s_waitcnt lgkmcnt(0)
    v_mfma_f32_16x16x32_bf16 v[8:11], v[72:75], v[52:55], v[8:11]
    s_mov_b32 exec_lo, 0x30003
    s_mov_b32 exec_hi, 0x30003
    s_nop 5
    v_mul_f32 v8, s81, v8
    v_mul_f32 v9, s81, v9
    v_mul_f32 v10, s81, v10
    v_mul_f32 v11, s81, v11
    v_cvt_pk_bf16_f32 v78, v8, v9
    v_cvt_pk_bf16_f32 v79, v10, v11
    buffer_store_dwordx2 v[78:79], v21, s[40:43], s73 offen sc1
    buffer_store_dwordx2 v[78:79], v25, s[40:43], s69 offen
    s_mov_b64 exec, -1
    s_add_u32 m0, s66, 0
    s_add_u32 s91, s93, 0
    buffer_load_dwordx4 v58, s[20:23], s91 offen  lds
    s_add_u32 m0, s66, 896
    s_nop 0
    buffer_load_dwordx4 v58, s[20:23], s91 offen offset:128  lds
    s_add_u32 m0, s66, 2048
    s_add_u32 s91, s93, 16384
    buffer_load_dwordx4 v58, s[20:23], s91 offen  lds
    s_add_u32 m0, s66, 2944
    s_nop 0
    buffer_load_dwordx4 v58, s[20:23], s91 offen offset:128  lds
    s_add_u32 m0, s66, 4096
    s_add_u32 s91, s93, 32768
    buffer_load_dwordx4 v58, s[20:23], s91 offen  lds
    s_add_u32 m0, s66, 4992
    s_nop 0
    buffer_load_dwordx4 v58, s[20:23], s91 offen offset:128  lds
    s_add_u32 m0, s66, 6144
    s_add_u32 s91, s93, 49152
    buffer_load_dwordx4 v58, s[20:23], s91 offen  lds
    s_add_u32 m0, s66, 7040
    s_nop 0
    buffer_load_dwordx4 v58, s[20:23], s91 offen offset:128  lds
    s_barrier
    v_bfe_u32 v72, v0, 2, 3
    v_lshlrev_b32 v72, 11, v72
    v_lshrrev_b32 v73, 5, v0
    v_lshl_add_u32 v72, v73, 6, v72
    v_bfe_u32 v73, v0, 4, 1
    v_lshlrev_b32 v73, 1, v73
    v_xor_b32 v73, v0, v73
    v_and_b32 v73, 3, v73
    v_lshl_add_u32 v72, v73, 4, v72
    v_and_b32 v74, 0x2000, v72
    v_add_u32 v72, v72, v74
    v_add_u32 v74, 32768, v72
    v_bfe_u32 v75, v0, 3, 2
    s_sub_u32 s70, s60, 4
    v_cmp_eq_u32 vcc, s60, v75
    v_add_u32 v73, s77, v72
    s_nop 0
    v_cndmask_b32 v72, v72, v73, vcc
    v_cmp_eq_u32 vcc, s70, v75
    v_add_u32 v73, s77, v74
    s_nop 0
    v_cndmask_b32 v74, v74, v73, vcc
    s_mov_b32 s71, 147456
    v_and_b32 v76, 7, v0
    v_lshlrev_b32 v76, 6, v76
    v_bfe_u32 v77, v0, 3, 1
    v_lshl_add_u32 v76, v77, 11, v76
    v_lshlrev_b32 v77, 3, v0
    v_and_b32 v77, 32, v77
    v_xor_b32 v77, v0, v77
    v_and_b32 v77, 48, v77
    v_add3_u32 v76, v76, v77, s71
    s_lshl_b32 s70, s3, 12
    s_sub_u32 s70, s70, 65536
    v_add_u32 v77, s70, v76
    v_lshlrev_b32 v73, 6, v0
    v_bfe_u32 v75, v0, 1, 3
    v_lshl_add_u32 v73, v75, 2, v73
    v_add_u32 v73, s88, v73
    s_lshl_b32 s76, s86, 10
    s_lshl_b32 s70, s3, 8
    s_add_u32 s76, s76, s70
    s_add_u32 s76, s76, 540672
    s_add_u32 s76, s76, s52
    s_mul_i32 s73, s87, 120
    s_sub_u32 s73, s1, s73
    s_and_b32 s69, s3, 1
    s_lshl_b32 s69, s69, 3
    s_lshr_b32 s71, s3, 1
    s_lshl_b32 s71, s71, 10
    s_add_u32 s69, s69, s71
    s_mov_b32 s80, 0
    s_waitcnt vmcnt(10)
    s_add_u32 m0, s88, 0
    s_nop 0
    buffer_load_dwordx4 v72, s[40:43], s76 offen offset:0 sc1 lds
    s_add_u32 m0, s88, 896
    s_nop 0
    buffer_load_dwordx4 v72, s[40:43], s76 offen offset:128 sc1 lds
    s_add_u32 m0, s88, 2048
    s_nop 0
    buffer_load_dwordx4 v74, s[40:43], s76 offen offset:0 sc1 lds
    s_add_u32 m0, s88, 2944
    s_nop 0
    buffer_load_dwordx4 v74, s[40:43], s76 offen offset:128 sc1 lds
    v_mov_b32 v26, -1
    v_mov_b32 v27, -1
    v_mov_b32 v28, -1
    v_mov_b32 v29, -1
    v_lshlrev_b32 v24, 4, v0
    s_mov_b32 exec_hi, 0
    v_lshrrev_b32 v25, 4, v0
    v_mul_u32_u24 v25, 24320, v25
    v_add3_u32 v24, v24, v25, s67
    s_lshl_b32 s90, s63, 8
    s_add_u32 s90, s90, s44
    s_add_u32 s90, s90, s59
    s_add_u32 s90, s90, 13312
    buffer_store_dwordx4 v[26:29], v24, s[40:43], s90 offen
    s_mov_b32 exec_hi, -1
    s_waitcnt vmcnt(5)
    s_barrier
    ds_read_b128 v[32:35], v77 offset:0
    ds_read_b128 v[36:39], v77 offset:512
    ds_read_b128 v[40:43], v77 offset:1024
    ds_read_b128 v[44:47], v77 offset:1536
    ds_read_b128 v[48:51], v77 offset:16384
    ds_read_b128 v[52:55], v77 offset:16896
    ds_read_b128 v[56:59], v77 offset:17408
    ds_read_b128 v[60:63], v77 offset:17920
    ds_read_b128 v[64:67], v77 offset:32768
    ds_read_b128 v[68:71], v77 offset:33280
    s_mov_b32 s90, s61
    s_lshl_b32 s90, s90, 2
    s_add_u32 s90, s90, s3
    s_mul_i32 s90, s90, 36
    v_min_u32 v78, 35, v0
    v_add_u32 v78, s90, v78
    v_min_u32 v78, 4607, v78
    v_lshlrev_b32 v78, 7, v78
    s_mul_i32 s91, s60, 589824
    v_subrev_u32 v79, 36, v0
    v_ashrrev_i32 v79, 31, v79
    v_bfi_b32 v78, v79, v78, 2.0
    v_mov_b32 v3, v78
    s_mov_b32 s94, s91
    s_branch L_qaa_84x
L_qaa_84:
    s_and_b32 s70, vcc_lo, 0xffff
    s_cbranch_scc0 L_qaa_84s0
    s_add_u32 m0, s88, 0
    s_nop 0
    buffer_load_dwordx4 v72, s[40:43], s76 offen offset:0 sc1 lds
L_qaa_84s0:
    s_and_b32 s70, vcc_lo, 0xffff0000
    s_cbranch_scc0 L_qaa_84s1
    s_add_u32 m0, s88, 896
    s_nop 0
    buffer_load_dwordx4 v72, s[40:43], s76 offen offset:128 sc1 lds
L_qaa_84s1:
    s_and_b32 s70, vcc_hi, 0xffff
    s_cbranch_scc0 L_qaa_84s2
    s_add_u32 m0, s88, 2048
    s_nop 0
    buffer_load_dwordx4 v74, s[40:43], s76 offen offset:0 sc1 lds
L_qaa_84s2:
    s_and_b32 s70, vcc_hi, 0xffff0000
    s_cbranch_scc0 L_qaa_84s3
    s_add_u32 m0, s88, 2944
    s_nop 0
    buffer_load_dwordx4 v74, s[40:43], s76 offen offset:128 sc1 lds
L_qaa_84s3:
L_qaa_84x:
    s_waitcnt vmcnt(0)
    ds_read2_b32 v[78:79], v73 offset0:0 offset1:8
    s_add_u32 s80, s80, 4096
    s_cbranch_scc1 L_abort
    s_waitcnt lgkmcnt(0)
    v_cmp_u_f32 vcc, v78, v79
    s_cbranch_vccnz L_qaa_84
    s_barrier
    ds_read_b128 v[8:11], v76 offset:0
    ds_read_b128 v[12:15], v76 offset:512
    ds_read_b128 v[16:19], v76 offset:1024
    ds_read_b128 v[20:23], v76 offset:1536
    ds_read_b128 v[24:27], v76 offset:4096
    buffer_load_dword v3, v3, s[36:39], s94 offen
    s_waitcnt lgkmcnt(4)
    v_mfma_f32_16x16x32_bf16 v[72:75], v[32:35], v[8:11], 0
    ds_read_b128 v[28:31], v76 offset:4608
    s_waitcnt lgkmcnt(4)
    v_mfma_f32_16x16x32_bf16 v[72:75], v[36:39], v[12:15], v[72:75]
    ds_read_b128 v[8:11], v76 offset:5120
    s_waitcnt lgkmcnt(4)
    v_mfma_f32_16x16x32_bf16 v[72:75], v[40:43], v[16:19], v[72:75]
    ds_read_b128 v[12:15], v76 offset:5632
    ds_read_b128 v[32:35], v77 offset:33792
    s_waitcnt lgkmcnt(5)
    v_mfma_f32_16x16x32_bf16 v[72:75], v[44:47], v[20:23], v[72:75]
    ds_read_b128 v[16:19], v76 offset:8192
    ds_read_b128 v[36:39], v77 offset:34304
    s_waitcnt lgkmcnt(6)
    v_mfma_f32_16x16x32_bf16 v[72:75], v[48:51], v[24:27], v[72:75]
    ds_read_b128 v[20:23], v76 offset:8704
    ds_read_b128 v[40:43], v77 offset:49152
    s_waitcnt lgkmcnt(7)
    v_mfma_f32_16x16x32_bf16 v[72:75], v[52:55], v[28:31], v[72:75]
    ds_read_b128 v[24:27], v76 offset:9216
    ds_read_b128 v[44:47], v77 offset:49664
    s_waitcnt lgkmcnt(8)
    v_mfma_f32_16x16x32_bf16 v[72:75], v[56:59], v[8:11], v[72:75]
    ds_read_b128 v[28:31], v76 offset:9728
    ds_read_b128 v[48:51], v77 offset:50176
    s_waitcnt lgkmcnt(9)
    v_mfma_f32_16x16x32_bf16 v[72:75], v[60:63], v[12:15], v[72:75]
    ds_read_b128 v[8:11], v76 offset:12288
    ds_read_b128 v[52:55], v77 offset:50688
    s_waitcnt lgkmcnt(9)
    v_mfma_f32_16x16x32_bf16 v[72:75], v[64:67], v[16:19], v[72:75]
    ds_read_b128 v[12:15], v76 offset:12800
    v_and_b32 v79, 15, v0
    s_waitcnt lgkmcnt(8)
    v_mfma_f32_16x16x32_bf16 v[72:75], v[68:71], v[20:23], v[72:75]
    ds_read_b128 v[16:19], v76 offset:13312
    v_lshlrev_b32 v79, 4, v79
    s_waitcnt lgkmcnt(7)
    v_mfma_f32_16x16x32_bf16 v[72:75], v[32:35], v[24:27], v[72:75]
    ds_read_b128 v[20:23], v76 offset:13824
    v_add_u32 v79, 147456, v79
    s_waitcnt lgkmcnt(6)
    v_mfma_f32_16x16x32_bf16 v[72:75], v[36:39], v[28:31], v[72:75]
    v_lshrrev_b32 v76, 5, v0
    v_lshlrev_b32 v76, 11, v76
    s_waitcnt lgkmcnt(4)
    v_mfma_f32_16x16x32_bf16 v[72:75], v[40:43], v[8:11], v[72:75]
    v_bfe_u32 v77, v0, 2, 3
    v_lshl_add_u32 v76, v77, 6, v76
    s_waitcnt lgkmcnt(2)
    v_mfma_f32_16x16x32_bf16 v[72:75], v[44:47], v[12:15], v[72:75]
    v_bfe_u32 v77, v0, 4, 1
    v_lshl_add_u32 v76, v77, 5, v76
    s_waitcnt lgkmcnt(1)
    v_mfma_f32_16x16x32_bf16 v[72:75], v[48:51], v[16:19], v[72:75]
    v_and_b32 v77, 3, v0
    v_lshl_add_u32 v76, v77, 3, v76
    s_waitcnt lgkmcnt(0)
    s_waitcnt vmcnt(1)
    s_barrier
    v_mfma_f32_16x16x32_bf16 v[72:75], v[52:55], v[20:23], v[72:75]
    v_add_u32 v76, s66, v76
    v_xor_b32 v77, 32, v76
    v_lshl_add_u32 v40, s3, 2, v79
    v_lshlrev_b32 v43, 4, v0
    v_add_u32 v43, 147456, v43
    v_add_u32 v42, s69, v43
    ds_read_b64_tr_b16 v[56:57], v76 offset:8192
    ds_read_b64_tr_b16 v[58:59], v76 offset:12288
    v_max3_f32 v78, v72, v73, v74
    v_max_f32 v78, v78, v75
    v_mov_b32 v41, v78
    ds_read_b64_tr_b16 v[60:61], v77 offset:8192
    ds_read_b64_tr_b16 v[62:63], v77 offset:12288
    v_permlane16_swap_b32 v78, v41
    v_max_f32 v78, v78, v41
    v_mov_b32 v41, v78
    ds_read_b64_tr_b16 v[64:65], v76 offset:512
    s_nop 0
    v_permlane32_swap_b32 v78, v41
    v_max_f32 v78, v78, v41
    ds_write_b32 v40, v78
    v_lshl_add_u32 v40, s3, 2, v43
    ds_read_b64_tr_b16 v[66:67], v76 offset:4608
    ds_read_b64_tr_b16 v[68:69], v77 offset:512
    ds_read_b64_tr_b16 v[70:71], v77 offset:4608
    ds_read_b64_tr_b16 v[16:17], v76 offset:8704
    s_waitcnt lgkmcnt(4)
    s_barrier
    ds_read_b128 v[44:47], v79
    ds_read_b64_tr_b16 v[18:19], v76 offset:12800
    ds_read_b64_tr_b16 v[20:21], v77 offset:8704
    ds_read_b64_tr_b16 v[22:23], v77 offset:12800
    ds_read_b64_tr_b16 v[48:49], v76 offset:0
    ds_read_b64_tr_b16 v[50:51], v76 offset:4096
    ds_read_b64_tr_b16 v[52:53], v77 offset:0
    s_waitcnt lgkmcnt(6)
    v_max3_f32 v78, v44, v45, v46
    v_max_f32 v78, v78, v47
    v_ceil_f32 v78, v78
    v_sub_f32 v72, v72, v78
    v_sub_f32 v73, v73, v78
    v_exp_f32 v72, v72
    v_pk_add_f32 v[46:47], v[44:45], v[46:47]
    v_exp_f32 v73, v73
    v_cmp_u_f32 vcc, v46, v47
    v_sub_f32 v74, v74, v78
    v_sub_f32 v75, v75, v78
    v_exp_f32 v74, v74
    v_exp_f32 v75, v75
    s_cbranch_vccnz L_redo_85
    v_cvt_pk_bf16_f32 v44, v72, v73
    v_cvt_pk_bf16_f32 v45, v74, v75
    ds_write_b64 v42, v[44:45] offset:1024
    v_pk_add_f32 v[72:73], v[72:73], v[74:75]
    v_add_f32 v72, v72, v73
    ds_write_b32 v40, v72 offset:3072
    ds_read_b64_tr_b16 v[54:55], v77 offset:4096
    ds_read_b64_tr_b16 v[24:25], v76 offset:1024
    ds_read_b64_tr_b16 v[26:27], v76 offset:5120
    s_waitcnt lgkmcnt(3)
    s_barrier
    ds_read_b128 v[8:11], v43 offset:1024
    ds_read_b128 v[12:15], v43 offset:2048
    ds_read_b128 v[72:75], v43 offset:3072
    ds_read_b64_tr_b16 v[28:29], v77 offset:1024
    ds_read_b64_tr_b16 v[30:31], v77 offset:5120
    ds_read_b64_tr_b16 v[32:33], v76 offset:9216
    ds_read_b64_tr_b16 v[34:35], v76 offset:13312
    ds_read_b64_tr_b16 v[36:37], v77 offset:9216
    ds_read_b64_tr_b16 v[38:39], v77 offset:13312
    s_waitcnt lgkmcnt(8)
    v_mfma_f32_16x16x32_bf16 v[40:43], v[8:11], v[48:51], 0
    v_mfma_f32_16x16x32_bf16 v[44:47], v[8:11], v[52:55], 0
    s_waitcnt lgkmcnt(6)
    v_mfma_f32_16x16x32_bf16 v[40:43], v[12:15], v[56:59], v[40:43]
    v_pk_add_f32 v[72:73], v[72:73], v[74:75]
    v_and_b32 v74, 15, v0
    v_add_f32 v79, v72, v73
    v_mfma_f32_16x16x32_bf16 v[44:47], v[12:15], v[60:63], v[44:47]
    v_lshlrev_b32 v75, 7, v74
    v_mov_b32 v72, v79
    v_lshlrev_b32 v74, 3, v74
    v_mfma_f32_16x16x32_bf16 v[48:51], v[8:11], v[64:67], 0
    v_lshrrev_b32 v73, 4, v0
    v_permlane16_swap_b32 v79, v72
    v_add_f32 v79, v79, v72
    v_mfma_f32_16x16x32_bf16 v[52:55], v[8:11], v[68:71], 0
    v_lshl_add_u32 v74, v73, 12, v74
    v_mov_b32 v72, v79
    v_lshl_add_u32 v75, v73, 28, v75
    v_mfma_f32_16x16x32_bf16 v[48:51], v[12:15], v[16:19], v[48:51]
    ds_read_b64_tr_b16 v[16:17], v76 offset:1536
    ds_read_b64_tr_b16 v[18:19], v76 offset:5632
    v_add_u32 v75, s89, v75
    v_mfma_f32_16x16x32_bf16 v[52:55], v[12:15], v[20:23], v[52:55]
    ds_read_b64_tr_b16 v[20:21], v77 offset:1536
    ds_read_b64_tr_b16 v[22:23], v77 offset:5632
    v_permlane32_swap_b32 v79, v72
    v_mfma_f32_16x16x32_bf16 v[56:59], v[8:11], v[24:27], 0
    ds_read_b64_tr_b16 v[24:25], v76 offset:9728
    ds_read_b64_tr_b16 v[26:27], v76 offset:13824
    v_add_f32 v79, v79, v72
    s_waitcnt lgkmcnt(6)
    v_mfma_f32_16x16x32_bf16 v[60:63], v[8:11], v[28:31], 0
    ds_read_b64_tr_b16 v[28:29], v77 offset:9728
    ds_read_b64_tr_b16 v[30:31], v77 offset:13824
    v_and_b32 v72, 32, v0
    v_lshl_add_u32 v74, v72, 8, v74
    v_mfma_f32_16x16x32_bf16 v[56:59], v[12:15], v[32:35], v[56:59]
    v_cvt_pk_bf16_f32 v44, v40, v44
    v_cvt_pk_bf16_f32 v40, v41, v45
    v_mfma_f32_16x16x32_bf16 v[60:63], v[12:15], v[36:39], v[60:63]
    v_cvt_pk_bf16_f32 v45, v48, v52
    buffer_store_dwordx2 v[44:45], v74, s[40:43], s47 offen offset:0
    s_waitcnt lgkmcnt(6)
    v_mfma_f32_16x16x32_bf16 v[64:67], v[8:11], v[16:19], 0
    buffer_store_dwordx2 v[78:79], v75, s[40:43], s73 offen
    v_cvt_pk_bf16_f32 v41, v49, v53
    buffer_store_dwordx2 v[40:41], v74, s[40:43], s47 offen offset:1024
    s_waitcnt lgkmcnt(4)
    v_mfma_f32_16x16x32_bf16 v[68:71], v[8:11], v[20:23], 0
    v_cvt_pk_bf16_f32 v46, v42, v46
    v_cvt_pk_bf16_f32 v42, v43, v47
    s_waitcnt lgkmcnt(2)
    v_mfma_f32_16x16x32_bf16 v[64:67], v[12:15], v[24:27], v[64:67]
    v_cvt_pk_bf16_f32 v47, v50, v54
    buffer_store_dwordx2 v[46:47], v74, s[40:43], s47 offen offset:2048
    s_waitcnt lgkmcnt(0)
    v_mfma_f32_16x16x32_bf16 v[68:71], v[12:15], v[28:31], v[68:71]
    v_cvt_pk_bf16_f32 v43, v51, v55
    buffer_store_dwordx2 v[42:43], v74, s[40:43], s47 offen offset:3072
    v_cvt_pk_bf16_f32 v60, v56, v60
    v_cvt_pk_bf16_f32 v56, v57, v61
    v_cvt_pk_bf16_f32 v62, v58, v62
    v_cvt_pk_bf16_f32 v58, v59, v63
    v_and_b32 v72, 3, v0
    v_lshlrev_b32 v72, 3, v72
    v_cvt_pk_bf16_f32 v61, v64, v68
    buffer_store_dwordx2 v[60:61], v74, s[40:43], s47 offen offset:128
    v_cvt_pk_bf16_f32 v57, v65, v69
    buffer_store_dwordx2 v[56:57], v74, s[40:43], s47 offen offset:1152
    v_cvt_pk_bf16_f32 v63, v66, v70
    buffer_store_dwordx2 v[62:63], v74, s[40:43], s47 offen offset:2176
    v_cvt_pk_bf16_f32 v59, v67, v71
    buffer_store_dwordx2 v[58:59], v74, s[40:43], s47 offen offset:3200
    v_lshl_add_u32 v73, v73, 5, v72
    v_mov_b32 v32, -1
    v_mov_b32 v33, -1
    buffer_load_dwordx2 v[32:33], v73, s[40:43], s1 offen sc1
    v_lshrrev_b32 v77, 4, v0
    v_and_b32 v76, 15, v0
    v_lshlrev_b32 v72, 4, v76
    v_lshl_add_u32 v72, v77, 17, v72
    s_add_u32 s95, s0, 32768
    s_add_u32 s96, s0, 65536
    s_add_u32 s97, s0, 98304
    v_and_b32 v78, 1, v76
    v_lshlrev_b32 v78, 4, v78
    v_mov_b32 v79, 0xffff
    v_lshlrev_b32 v78, v78, v79
    v_lshrrev_b32 v79, 1, v76
    v_cmp_eq_u32 vcc, 0, v79
    s_nop 1
    v_cndmask_b32 v64, 0, v78, vcc
    v_cmp_eq_u32 vcc, 1, v79
    s_nop 1
    v_cndmask_b32 v65, 0, v78, vcc
    v_cmp_eq_u32 vcc, 2, v79
    s_nop 1
    v_cndmask_b32 v66, 0, v78, vcc
    v_cmp_eq_u32 vcc, 3, v79
    s_nop 1
    v_cndmask_b32 v67, 0, v78, vcc
    s_lshl_b32 s71, s87, 1
    s_add_u32 s71, s71, s86
    s_and_b32 s72, s71, 15
    s_lshl_b32 s73, s72, 14
    s_lshl_b32 s70, s3, 11
    s_add_u32 s73, s73, s70
    s_and_b32 s70, s71, 8
    s_add_u32 s72, s72, s70
    s_lshl_b32 s72, s72, 10
    s_lshl_b32 s70, s55, 7
    s_add_u32 s70, s70, s54
    s_add_u32 s73, s73, s70
    s_add_u32 s73, s73, 606208
    s_add_u32 s72, s72, s70
    s_add_u32 s72, s72, 868352
    s_mov_b32 s74, 10
    s_and_b32 s70, s71, 3
    s_lshl_b32 s76, s70, 2
    s_add_u32 s76, s76, s3
    s_lshl_b32 s76, s76, 8
    s_add_u32 s76, s76, s58
    s_add_u32 s76, s76, 72704
    s_lshl_b32 s77, s70, 7
    s_add_u32 s77, s77, s58
    s_add_u32 s77, s77, 80896
    s_lshr_b32 s69, s71, 2
    s_cmp_eq_u32 s69, s60
    s_cselect_b32 s73, s76, s73
    s_cselect_b32 s72, s77, s72
    s_cselect_b32 s74, 7, s74
    v_and_b32 v74, 7, v0
    v_lshlrev_b32 v74, 4, v74
    v_lshl_add_u32 v74, v77, 3, v74
    v_bfe_u32 v75, v0, 3, 1
    v_lshl_add_u32 v74, v75, s74, v74
    v_and_b32 v75, 32, v0
    v_lshl_add_u32 v74, v75, 26, v74
    v_mov_b32 v75, 1073741824
    v_writelane_b32 v75, s89, 0
    s_mov_b32 s80, 0
L_spin_86:
    buffer_load_dwordx2 v[32:33], v73, s[40:43], s1 offen sc1
    s_add_u32 s80, s80, 1024
    s_cbranch_scc1 L_abort
    s_waitcnt vmcnt(1)
    v_cmp_u_f32 vcc, v32, v33
    s_cbranch_vccnz L_spin_86
    buffer_load_dwordx4 v[8:11], v72, s[40:43], s0 offen sc1
    buffer_load_dwordx4 v[12:15], v72, s[40:43], s95 offen sc1
    buffer_load_dwordx4 v[16:19], v72, s[40:43], s96 offen sc1
    buffer_load_dwordx4 v[20:23], v72, s[40:43], s97 offen sc1
    v_max_f32_dpp v44, v32, v32 quad_perm:[1,0,3,2] row_mask:0xf bank_mask:0xf
    s_nop 1
    v_max_f32_dpp v44, v44, v44 quad_perm:[2,3,0,1] row_mask:0xf bank_mask:0xf
    v_mov_b32 v45, v44
    s_nop 1
    v_permlane16_swap_b32 v44, v45
    v_max_f32 v44, v44, v45
    v_mov_b32 v45, v44
    s_nop 1
    v_permlane32_swap_b32 v44, v45
    v_max_f32 v44, v44, v45
    v_sub_f32 v40, v32, v44
    v_exp_f32 v40, v40
    s_nop 0
    v_cvt_pk_bf16_f32 v42, v40, v40
    v_mul_f32 v45, v40, v33
    s_nop 0
    v_and_b32_dpp v48, v42, v64 quad_perm:[0,0,0,0] row_mask:0xf bank_mask:0xf
    v_and_b32_dpp v49, v42, v65 quad_perm:[0,0,0,0] row_mask:0xf bank_mask:0xf
    v_and_b32_dpp v50, v42, v66 quad_perm:[0,0,0,0] row_mask:0xf bank_mask:0xf
    v_add_f32_dpp v45, v45, v45 quad_perm:[1,0,3,2] row_mask:0xf bank_mask:0xf
    v_and_b32_dpp v51, v42, v67 quad_perm:[0,0,0,0] row_mask:0xf bank_mask:0xf
    s_nop 0
    v_add_f32_dpp v45, v45, v45 quad_perm:[2,3,0,1] row_mask:0xf bank_mask:0xf
    v_and_b32_dpp v52, v42, v64 quad_perm:[1,1,1,1] row_mask:0xf bank_mask:0xf
    v_mov_b32 v46, v45
    v_and_b32_dpp v53, v42, v65 quad_perm:[1,1,1,1] row_mask:0xf bank_mask:0xf
    s_nop 0
    v_permlane16_swap_b32 v45, v46
    v_and_b32_dpp v54, v42, v66 quad_perm:[1,1,1,1] row_mask:0xf bank_mask:0xf
    v_add_f32 v45, v45, v46
    v_and_b32_dpp v55, v42, v67 quad_perm:[1,1,1,1] row_mask:0xf bank_mask:0xf
    v_mov_b32 v46, v45
    v_and_b32_dpp v56, v42, v64 quad_perm:[2,2,2,2] row_mask:0xf bank_mask:0xf
    s_nop 0
    v_permlane32_swap_b32 v45, v46
    v_and_b32_dpp v57, v42, v65 quad_perm:[2,2,2,2] row_mask:0xf bank_mask:0xf
    v_add_f32 v45, v45, v46
    v_and_b32_dpp v58, v42, v66 quad_perm:[2,2,2,2] row_mask:0xf bank_mask:0xf
    v_and_b32_dpp v59, v42, v67 quad_perm:[2,2,2,2] row_mask:0xf bank_mask:0xf
    s_cmp_eq_u32 s69, s60
    s_cbranch_scc1 L_loc_89
    buffer_store_dwordx2 v[44:45], v75, s[40:43], s72 offen sc1
    s_branch L_loc_89x
L_loc_89:
    buffer_store_dwordx2 v[44:45], v75, s[40:43], s72 offen
L_loc_89x:
    v_and_b32_dpp v60, v42, v64 quad_perm:[3,3,3,3] row_mask:0xf bank_mask:0xf
    v_and_b32_dpp v61, v42, v65 quad_perm:[3,3,3,3] row_mask:0xf bank_mask:0xf
    v_and_b32_dpp v62, v42, v66 quad_perm:[3,3,3,3] row_mask:0xf bank_mask:0xf
    v_and_b32_dpp v63, v42, v67 quad_perm:[3,3,3,3] row_mask:0xf bank_mask:0xf
    s_mov_b32 s80, 0
L_paw_90:
    s_waitcnt vmcnt(4)
    v_mfma_f32_16x16x32_bf16 v[68:71], v[48:51], v[8:11], 0
    s_waitcnt vmcnt(3)
    v_mfma_f32_16x16x32_bf16 v[68:71], v[52:55], v[12:15], v[68:71]
    s_waitcnt vmcnt(2)
    v_mfma_f32_16x16x32_bf16 v[68:71], v[56:59], v[16:19], v[68:71]
    s_waitcnt vmcnt(1)
    v_mfma_f32_16x16x32_bf16 v[68:71], v[60:63], v[20:23], v[68:71]
    s_nop 7
    v_cmp_u_f32 vcc, v68, v68
    v_cvt_pk_bf16_f32 v46, v68, v69
    v_cvt_pk_bf16_f32 v47, v70, v71
    s_cbranch_vccnz L_retry_91
    s_cmp_eq_u32 s69, s60
    s_cbranch_scc1 L_loc_92
    buffer_store_dwordx2 v[46:47], v74, s[40:43], s73 offen sc1
    s_branch L_loc_92x
L_loc_92:
    buffer_store_dwordx2 v[46:47], v74, s[40:43], s73 offen
L_loc_92x:
    v_bfe_u32 v76, v0, 2, 3
    v_lshlrev_b32 v76, 7, v76
    v_lshrrev_b32 v77, 5, v0
    v_lshl_add_u32 v76, v77, 6, v76
    v_bfe_u32 v77, v0, 4, 1
    v_lshlrev_b32 v77, 1, v77
    v_xor_b32 v77, v0, v77
    v_and_b32 v77, 3, v77
    v_lshl_add_u32 v76, v77, 4, v76
    v_bfe_u32 v78, v0, 2, 3
    v_lshlrev_b32 v77, 7, v78
    s_and_b32 s77, s62, 15
    s_lshl_b32 s76, s77, 4
    s_add_u32 s76, s76, s63
    s_lshl_b32 s76, s76, 10
    s_add_u32 s76, s76, s53
    s_add_u32 s76, s76, 606208
    s_and_b32 s70, s62, 8
    s_add_u32 s77, s77, s70
    s_lshl_b32 s77, s77, 10
    s_add_u32 s77, s77, s53
    s_add_u32 s77, s77, 868352
    s_sub_u32 s70, s61, s55
    s_lshl_b32 s70, s70, 7
    s_add_u32 s70, s70, s58
    s_add_u32 s70, s70, 72704
    s_sub_u32 s70, s70, s76
    s_lshr_b32 s71, s61, 3
    s_sub_u32 s71, s71, s55
    s_lshl_b32 s71, s71, 7
    s_add_u32 s71, s71, s58
    s_add_u32 s71, s71, 80896
    s_sub_u32 s71, s71, s77
    v_cmp_eq_u32 vcc, s55, v78
    v_add_u32 v79, s70, v76
    s_nop 0
    v_cndmask_b32 v76, v76, v79, vcc
    v_cmp_eq_u32 vcc, s55, v78
    v_add_u32 v79, s71, v77
    s_nop 0
    v_cndmask_b32 v77, v77, v79, vcc
    v_mov_b32 v64, -1
    v_mov_b32 v65, -1
    v_mov_b32 v66, -1
    v_mov_b32 v67, -1
    v_mov_b32 v68, -1
    v_mov_b32 v69, -1
    s_barrier
    v_lshrrev_b32 v8, 4, v0
    v_bfe_u32 v9, v0, 2, 2
    v_lshlrev_b32 v8, 1, v8
    v_lshl_add_u32 v8, v9, 4, v8
    v_mul_u32_u24 v8, 8192, v8
    v_bfe_u32 v9, v0, 4, 1
    v_lshlrev_b32 v9, 1, v9
    v_xor_b32 v9, v0, v9
    v_and_b32 v9, 3, v9
    v_lshl_add_u32 v8, v9, 4, v8
    s_lshl_b32 s90, s63, 18
    s_sub_u32 s90, s98, s90
    s_add_u32 m0, s88, 0
    s_add_u32 s91, s90, 0
    buffer_load_dwordx4 v8, s[32:35], s91 offen  lds
    s_add_u32 m0, s88, 1024
    s_add_u32 s91, s90, 8192
    buffer_load_dwordx4 v8, s[32:35], s91 offen  lds
    s_add_u32 m0, s88, 2048
    s_add_u32 s91, s90, 65536
    buffer_load_dwordx4 v8, s[32:35], s91 offen  lds
    s_add_u32 m0, s88, 3072
    s_add_u32 s91, s90, 73728
    buffer_load_dwordx4 v8, s[32:35], s91 offen  lds
    v_lshrrev_b32 v8, 4, v0
    v_bfe_u32 v9, v0, 2, 2
    v_lshl_add_u32 v8, v8, 3, v9
    v_mul_u32_u24 v8, 1152, v8
    v_bfe_u32 v9, v0, 4, 1
    v_lshlrev_b32 v9, 1, v9
    v_xor_b32 v9, v0, v9
    v_and_b32 v9, 3, v9
    v_lshl_add_u32 v8, v9, 4, v8
    v_add_u32 v8, s68, v8
    s_add_u32 m0, s66, 0
    s_add_u32 s91, s99, 0
    buffer_load_dwordx4 v8, s[36:39], s91 offen  lds
    s_add_u32 m0, s66, 1024
    s_add_u32 s91, s99, 4608
    buffer_load_dwordx4 v8, s[36:39], s91 offen  lds
    s_add_u32 m0, s66, 2048
    s_add_u32 s91, s99, 36864
    buffer_load_dwordx4 v8, s[36:39], s91 offen  lds
    s_add_u32 m0, s66, 3072
    s_add_u32 s91, s99, 41472
    buffer_load_dwordx4 v8, s[36:39], s91 offen  lds
    buffer_load_dwordx2 v[68:69], v77, s[40:43], s77 offen sc1
    buffer_load_dwordx4 v[64:67], v76, s[40:43], s76 offen sc1
    v_lshrrev_b32 v16, 4, v0
    v_bfe_u32 v17, v0, 2, 2
    v_lshl_add_u32 v16, v16, 3, v17
    v_mul_u32_u24 v16, 1152, v16
    v_bfe_u32 v17, v0, 4, 1
    v_lshlrev_b32 v17, 1, v17
    v_xor_b32 v17, v0, v17
    v_and_b32 v17, 3, v17
    v_lshl_add_u32 v16, v17, 4, v16
    v_add_u32 v16, s68, v16
    s_add_u32 m0, s66, 4096
    s_add_u32 s91, s99, 73728
    buffer_load_dwordx4 v16, s[36:39], s91 offen  lds
    s_add_u32 m0, s66, 5120
    s_add_u32 s91, s99, 78336
    buffer_load_dwordx4 v16, s[36:39], s91 offen  lds
    s_add_u32 m0, s66, 6144
    s_add_u32 s91, s99, 110592
    buffer_load_dwordx4 v16, s[36:39], s91 offen  lds
    s_add_u32 m0, s66, 7168
    s_add_u32 s91, s99, 115200
    buffer_load_dwordx4 v16, s[36:39], s91 offen  lds
    v_and_b32 v74, 7, v0
    v_lshlrev_b32 v74, 6, v74
    v_lshlrev_b32 v75, 3, v0
    v_and_b32 v75, 32, v75
    v_xor_b32 v75, v0, v75
    v_and_b32 v75, 48, v75
    v_add3_u32 v74, v74, v75, s88
    v_lshrrev_b32 v78, 3, v0
    v_and_b32 v79, 7, v0
    v_lshlrev_b32 v79, 1, v79
    v_lshl_add_u32 v78, v78, 7, v79
    s_lshl_b32 s70, s3, 9
    s_add_u32 s73, s45, s70
    s_add_u32 s73, s73, 24576
    s_sub_u32 s70, s88, s66
    v_add_u32 v70, s70, v2
    v_add_u32 v71, s70, v7
    v_lshl_add_u32 v75, v0, 4, s88
    v_and_b32 v32, 7, v0
    v_lshlrev_b32 v32, 4, v32
    v_bfe_u32 v33, v0, 3, 1
    v_lshl_add_u32 v32, v33, 9, v32
    v_lshrrev_b32 v33, 4, v0
    v_lshl_add_u32 v32, v33, 7, v32
    s_add_u32 s79, s46, 24576
    v_mov_b32 v24, -1
    v_mov_b32 v25, -1
    v_mov_b32 v26, -1
    v_mov_b32 v27, -1
    v_mov_b32 v28, -1
    v_mov_b32 v29, -1
    v_mov_b32 v30, -1
    v_mov_b32 v31, -1
    s_waitcnt vmcnt(10)
    ds_read_b64_tr_b16 v[40:41], v70 offset:0
    ds_read_b64_tr_b16 v[42:43], v70 offset:1024
    ds_read_b64_tr_b16 v[44:45], v71 offset:0
    ds_read_b64_tr_b16 v[46:47], v71 offset:1024
    ds_read_b64_tr_b16 v[48:49], v70 offset:2048
    ds_read_b64_tr_b16 v[50:51], v70 offset:3072
    ds_read_b64_tr_b16 v[52:53], v71 offset:2048
    ds_read_b64_tr_b16 v[54:55], v71 offset:3072
    s_mov_b32 s80, 0
    v_cmp_u_f32 vcc, v68, v69
    s_cbranch_vccz L_go_94
    s_branch L_chk_95
L_spin_93:
    s_waitcnt vmcnt(16)
    buffer_load_dwordx2 v[68:69], v77, s[40:43], s77 offen sc1
    buffer_load_dwordx4 v[64:67], v76, s[40:43], s76 offen sc1
    s_add_u32 s80, s80, 1024
    s_cbranch_scc1 L_abort
L_chk_95:
    v_cmp_u_f32 vcc, v68, v69
    s_cbranch_vccz L_go_94
    v_cmp_u_f32 vcc, v68, v69
    s_cbranch_vccz L_go_94
    v_cmp_u_f32 vcc, v68, v69
    s_cbranch_vccz L_go_94
    v_cmp_u_f32 vcc, v68, v69
    s_cbranch_vccz L_go_94
    v_cmp_u_f32 vcc, v68, v69
    s_cbranch_vccz L_go_94
    v_cmp_u_f32 vcc, v68, v69
    s_cbranch_vccz L_go_94
    v_cmp_u_f32 vcc, v68, v69
    s_cbranch_vccz L_go_94
    v_cmp_u_f32 vcc, v68, v69
    s_cbranch_vccz L_go_94
    v_cmp_u_f32 vcc, v68, v69
    s_cbranch_vccz L_go_94
    v_cmp_u_f32 vcc, v68, v69
    s_cbranch_vccnz L_spin_93
L_go_94:
    s_mov_b32 s80, 0
    v_cmp_u_f32 vcc, v64, v67
    s_cbranch_vccz L_go_97
    s_branch L_chk_98
L_spin_96:
    s_waitcnt vmcnt(8)
    buffer_load_dwordx4 v[64:67], v76, s[40:43], s76 offen sc1
    s_add_u32 s80, s80, 1024
    s_cbranch_scc1 L_abort
L_chk_98:
    v_cmp_u_f32 vcc, v64, v67
    s_cbranch_vccz L_go_97
    v_cmp_u_f32 vcc, v64, v67
    s_cbranch_vccz L_go_97
    v_cmp_u_f32 vcc, v64, v67
    s_cbranch_vccz L_go_97
    v_cmp_u_f32 vcc, v64, v67
    s_cbranch_vccz L_go_97
    v_cmp_u_f32 vcc, v64, v67
    s_cbranch_vccz L_go_97
    v_cmp_u_f32 vcc, v64, v67
    s_cbranch_vccz L_go_97
    v_cmp_u_f32 vcc, v64, v67
    s_cbranch_vccz L_go_97
    v_cmp_u_f32 vcc, v64, v67
    s_cbranch_vccz L_go_97
    v_cmp_u_f32 vcc, v64, v67
    s_cbranch_vccz L_go_97
    v_cmp_u_f32 vcc, v64, v67
    s_cbranch_vccnz L_spin_96
L_go_97:
    ds_write_b128 v75, v[64:67]
    ds_read_b128 v[16:19], v74
    ds_read_b128 v[20:23], v74 offset:512
    v_max_f32_dpp v12, v68, v68 row_ror:4 row_mask:0xf bank_mask:0xf
    s_nop 1
    v_max_f32_dpp v12, v12, v12 row_ror:8 row_mask:0xf bank_mask:0xf
    v_mov_b32 v13, v12
    s_nop 1
    v_permlane16_swap_b32 v12, v13
    v_max_f32 v12, v12, v13
    v_sub_f32 v12, v68, v12
    v_exp_f32 v12, v12
    s_nop 0
    v_mul_f32 v13, v12, v69
    v_mov_b32_dpp v8, v12 row_newbcast:0 row_mask:0xf bank_mask:0xf
    v_mov_b32_dpp v9, v12 row_newbcast:4 row_mask:0xf bank_mask:0xf
    v_mov_b32_dpp v10, v12 row_newbcast:8 row_mask:0xf bank_mask:0xf
    v_mov_b32_dpp v11, v12 row_newbcast:12 row_mask:0xf bank_mask:0xf
    s_waitcnt lgkmcnt(0)
    v_mfma_f32_16x16x32_bf16 v[56:59], v[16:19], v[40:43], 0
    v_add_f32_dpp v13, v13, v13 row_ror:4 row_mask:0xf bank_mask:0xf
    v_mfma_f32_16x16x32_bf16 v[60:63], v[16:19], v[44:47], 0
    s_nop 0
    v_add_f32_dpp v13, v13, v13 row_ror:8 row_mask:0xf bank_mask:0xf
    v_mfma_f32_16x16x32_bf16 v[56:59], v[20:23], v[48:51], v[56:59]
    v_mov_b32 v12, v13
    v_mfma_f32_16x16x32_bf16 v[60:63], v[20:23], v[52:55], v[60:63]
    s_nop 0
    v_permlane16_swap_b32 v13, v12
    v_add_f32 v13, v13, v12
    v_rcp_f32 v13, v13
    s_nop 0
    v_pk_mul_f32 v[36:37], v[8:9], v[12:13] op_sel:[0,1]
    v_pk_mul_f32 v[38:39], v[10:11], v[12:13] op_sel:[0,1]
    v_pk_mul_f32 v[56:57], v[56:57], v[36:37]
    v_pk_mul_f32 v[60:61], v[60:61], v[36:37]
    v_pk_fma_f32 v[56:57], v[58:59], v[38:39], v[56:57]
    v_pk_fma_f32 v[60:61], v[62:63], v[38:39], v[60:61]
    v_add_f32 v14, v56, v57
    v_add_f32 v15, v60, v61
    s_nop 1
    v_permlane16_swap_b32 v14, v15
    v_add_f32 v14, v14, v15
    v_cmp_u_f32 vcc, v14, v14
    s_cbranch_vccnz L_spin_96
    v_mov_b32_dpp v15, v14 quad_perm:[1,1,3,3] row_mask:0xf bank_mask:0xf
    s_mov_b64 exec, 0x55555555
    v_cvt_pk_bf16_f32 v15, v14, v15
    buffer_store_dword v15, v78, s[40:43], s73 offen
    s_mov_b64 exec, -1
    s_cmp_ge_u32 s61, 18
    s_cbranch_scc1 L_idle_99
    buffer_load_dwordx4 v[24:27], v32, s[40:43], s79 offen offset:0 sc1
    buffer_load_dwordx4 v[28:31], v32, s[40:43], s79 offen offset:1024 sc1
    s_waitcnt vmcnt(3)
    ds_read_b64_tr_b16 v[40:41], v2 offset:0
    s_add_u32 s70, s88, 3584
    v_lshl_add_u32 v78, v0, 2, s70
    ds_read_b64_tr_b16 v[42:43], v2 offset:1024
    s_mov_b32 s71, 151040
    v_and_b32 v74, 7, v0
    ds_read_b64_tr_b16 v[44:45], v7 offset:0
    v_lshlrev_b32 v74, 4, v74
    v_bfe_u32 v79, v0, 2, 1
    ds_read_b64_tr_b16 v[46:47], v7 offset:1024
    v_lshl_add_u32 v79, v79, 7, v74
    v_bfe_u32 v75, v0, 4, 1
    ds_read_b64_tr_b16 v[48:49], v2 offset:2048
    v_lshl_add_u32 v75, v75, 13, v74
    v_bfe_u32 v8, v0, 3, 1
    ds_read_b64_tr_b16 v[50:51], v2 offset:3072
    v_lshl_add_u32 v75, v8, 11, v75
    v_lshl_add_u32 v74, v8, 8, v74
    ds_read_b64_tr_b16 v[52:53], v7 offset:2048
    v_lshlrev_b32 v8, 12, v8
    v_add3_u32 v79, v79, v8, s71
    ds_read_b64_tr_b16 v[54:55], v7 offset:3072
    s_and_b32 s70, s61, 30
    buffer_load_dwordx4 v[24:27], v32, s[40:43], s79 offen offset:0 sc1
    buffer_load_dwordx4 v[28:31], v32, s[40:43], s79 offen offset:1024 sc1
    s_add_u32 s73, s70, 18
    ds_read_b64_tr_b16 v[56:57], v2 offset:4096
    s_and_b32 s71, s73, -4
    s_add_u32 s73, s73, s71
    ds_read_b64_tr_b16 v[58:59], v2 offset:5120
    s_lshl_b32 s73, s73, 11
    s_add_u32 s73, s73, 901120
    ds_read_b64_tr_b16 v[60:61], v7 offset:4096
    s_and_b32 s71, s61, 1
    s_lshl_b32 s69, s60, 1
    ds_read_b64_tr_b16 v[62:63], v7 offset:5120
    s_add_u32 s69, s69, s71
    s_lshl_b32 s69, s69, 7
    ds_read_b64_tr_b16 v[64:65], v2 offset:6144
    s_add_u32 s73, s73, s69
    s_add_u32 s70, s70, s61
    ds_read_b64_tr_b16 v[66:67], v2 offset:7168
    s_lshl_b32 s70, s70, 7
    s_add_u32 s69, s58, s70
    ds_read_b64_tr_b16 v[68:69], v7 offset:6144
    s_add_u32 s69, s69, 50688
    ds_read_b64_tr_b16 v[70:71], v7 offset:7168
    v_bfe_u32 v76, v0, 4, 1
    v_bfe_u32 v77, v0, 2, 2
    v_lshl_add_u32 v76, v76, 3, v77
    v_mul_u32_u24 v76, 8192, v76
    v_lshrrev_b32 v77, 5, v0
    v_lshl_add_u32 v76, v77, 6, v76
    v_bfe_u32 v77, v0, 4, 1
    v_lshlrev_b32 v77, 1, v77
    v_xor_b32 v77, v0, v77
    v_and_b32 v77, 3, v77
    v_lshl_add_u32 v76, v77, 4, v76
    s_and_b32 s90, s3, 1
    s_mul_i32 s90, s90, 131008
    s_add_u32 s90, s90, s67
    v_add_u32 v76, s90, v76
    s_mov_b32 s80, 0
L_spin_101:
    buffer_load_dwordx4 v[24:27], v32, s[40:43], s79 offen offset:0 sc1
    buffer_load_dwordx4 v[28:31], v32, s[40:43], s79 offen offset:1024 sc1
    s_add_u32 s80, s80, 1024
    s_cbranch_scc1 L_abort
    s_waitcnt vmcnt(2)
    v_cmp_u_f32 vcc, v27, v31
    s_cbranch_vccnz L_spin_101
    s_waitcnt lgkmcnt(0)
    v_mfma_f32_16x16x32_bf16 v[16:19], v[24:27], v[48:51], 0
    v_mfma_f32_16x16x32_bf16 v[16:19], v[28:31], v[64:67], v[16:19]
    v_mfma_f32_16x16x32_bf16 v[12:15], v[24:27], v[44:47], 0
    v_mfma_f32_16x16x32_bf16 v[12:15], v[28:31], v[60:63], v[12:15]
    v_mfma_f32_16x16x32_bf16 v[8:11], v[24:27], v[40:43], 0
    v_mfma_f32_16x16x32_bf16 v[8:11], v[28:31], v[56:59], v[8:11]
    v_mfma_f32_16x16x32_bf16 v[20:23], v[24:27], v[52:55], 0
    v_mfma_f32_16x16x32_bf16 v[20:23], v[28:31], v[68:71], v[20:23]
    s_nop 1
    v_pk_add_f32 v[16:17], v[16:17], v[18:19]
    v_add_f32 v16, v16, v17
    v_pk_add_f32 v[12:13], v[12:13], v[14:15]
    v_add_f32 v12, v12, v13
    v_pk_add_f32 v[8:9], v[8:9], v[10:11]
    v_add_f32 v8, v8, v9
    v_permlane32_swap_b32 v16, v12
    v_add_f32 v8, v8, v12
    v_pk_add_f32 v[20:21], v[20:21], v[22:23]
    v_add_f32 v20, v20, v21
    v_add_f32 v20, v20, v16
    s_nop 1
    v_permlane16_swap_b32 v8, v20
    v_add_f32 v34, v8, v20
    ds_write_b32 v78, v34
    v_cmp_u_f32 vcc, v34, v34
    s_cbranch_vccnz L_spin_101
    s_cmp_lg_u32 s3, 0
    s_waitcnt lgkmcnt(0)
    s_barrier
    s_cbranch_scc1 L_skip_104
    s_mov_b32 exec_hi, 0
    ds_read_b128 v[8:11], v79
    ds_read_b128 v[12:15], v79 offset:8192
    s_waitcnt vmcnt(0) lgkmcnt(0)
    v_pk_add_f32 v[32:33], v[8:9], v[12:13]
    v_pk_add_f32 v[34:35], v[10:11], v[14:15]
    buffer_store_dwordx4 v[32:35], v75, s[40:43], s73 offen sc1
    buffer_store_dwordx4 v[32:35], v74, s[40:43], s69 offen
    s_mov_b64 exec, -1
    s_branch L_skip_104x
L_skip_104:
    s_waitcnt vmcnt(0)
L_skip_104x:
L_join_100:
    s_add_u32 m0, s66, 0
    s_add_u32 s91, s98, 0
    buffer_load_dwordx4 v76, s[12:15], s91 offen nt lds
    s_add_u32 m0, s66, 1024
    s_add_u32 s91, s98, 32768
    buffer_load_dwordx4 v76, s[12:15], s91 offen nt lds
    s_add_u32 m0, s66, 2048
    s_add_u32 s91, s98, 262144
    buffer_load_dwordx4 v76, s[12:15], s91 offen nt lds
    s_add_u32 m0, s66, 3072
    s_add_u32 s91, s98, 294912
    buffer_load_dwordx4 v76, s[12:15], s91 offen nt lds
    s_add_u32 m0, s66, 4096
    s_add_u32 s91, s98, 524288
    buffer_load_dwordx4 v76, s[12:15], s91 offen nt lds
    s_add_u32 m0, s66, 5120
    s_add_u32 s91, s98, 557056
    buffer_load_dwordx4 v76, s[12:15], s91 offen nt lds
    v_mov_b32 v18, -1
    v_mov_b32 v19, -1
    v_mov_b32 v20, -1
    v_mov_b32 v21, -1
    v_and_b32 v16, 15, v0
    v_lshlrev_b32 v16, 4, v16
    v_lshrrev_b32 v17, 4, v0
    v_lshl_add_u32 v16, v17, 17, v16
    s_add_u32 s91, s0, 0
    buffer_store_dwordx4 v[18:21], v16, s[40:43], s91 offen
    s_add_u32 s91, s0, 32768
    buffer_store_dwordx4 v[18:21], v16, s[40:43], s91 offen
    s_add_u32 s91, s0, 65536
    buffer_store_dwordx4 v[18:21], v16, s[40:43], s91 offen
    s_add_u32 s91, s0, 98304
    buffer_store_dwordx4 v[18:21], v16, s[40:43], s91 offen
    v_and_b32 v16, 31, v0
    v_lshl_add_u32 v16, v16, 2, s89
    buffer_store_dword v18, v16, s[40:43], s1 offen
    s_add_u32 s79, s44, s59
    s_add_u32 s79, s79, 37888
    s_cmp_ge_u32 s63, 6
    s_cbranch_scc1 L_qidle_105
    v_lshrrev_b32 v14, 3, v0
    v_lshlrev_b32 v12, 8, v14
    v_and_b32 v13, 7, v0
    v_lshl_add_u32 v12, v13, 4, v12
    s_mul_i32 s70, s63, 3
    s_add_u32 s70, s70, s3
    s_add_u32 s76, s70, 18
    s_and_b32 s71, s76, -4
    s_add_u32 s76, s76, s71
    s_lshl_b32 s76, s76, 11
    s_add_u32 s76, s76, 901120
    s_add_u32 s76, s76, s52
    s_sub_u32 s70, s70, s60
    s_lshl_b32 s70, s70, 8
    s_add_u32 s70, s70, s58
    s_add_u32 s70, s70, 50688
    s_sub_u32 s70, s70, s76
    v_cmp_eq_u32 vcc, s60, v14
    v_add_u32 v15, s70, v12
    s_nop 0
    v_cndmask_b32 v12, v12, v15, vcc
    s_cmp_eq_u32 s3, 3
    s_cselect_b32 s70, 1073741824, 0
    v_add_u32 v12, s70, v12
    v_lshrrev_b32 v14, 4, v0
    v_lshlrev_b32 v13, 3, v13
    v_lshl_add_u32 v13, v14, 1, v13
    s_lshl_b32 s70, s3, 6
    s_add_u32 s70, s70, 150784
    v_add_u32 v13, s70, v13
    v_lshlrev_b32 v14, 4, v14
    v_and_b32 v15, 3, v0
    v_lshl_add_u32 v14, v15, 6, v14
    v_add_u32 v14, 150784, v14
    v_mov_b32 v24, -1
    v_mov_b32 v25, -1
    v_mov_b32 v26, -1
    v_mov_b32 v27, -1
    v_mov_b32 v28, -1
    v_mov_b32 v29, -1
    v_mov_b32 v30, -1
    v_mov_b32 v31, -1
    s_lshl_b32 s73, s63, 8
    s_add_u32 s73, s73, s79
    buffer_load_dwordx4 v[24:27], v12, s[40:43], s76 offen sc1
    buffer_load_dwordx4 v[28:31], v12, s[40:43], s76 offen offset:128 sc1
    v_bfe_u32 v72, v0, 2, 3
    v_lshlrev_b32 v72, 10, v72
    v_lshrrev_b32 v60, 5, v0
    v_lshl_add_u32 v72, v60, 6, v72
    v_bfe_u32 v60, v0, 4, 1
    v_lshlrev_b32 v60, 1, v60
    v_xor_b32 v60, v0, v60
    v_and_b32 v60, 3, v60
    v_lshl_add_u32 v72, v60, 4, v72
    v_bfe_u32 v73, v0, 4, 1
    v_bfe_u32 v60, v0, 2, 2
    v_lshl_add_u32 v73, v73, 3, v60
    v_mul_u32_u24 v73, 1152, v73
    v_lshrrev_b32 v60, 5, v0
    v_lshl_add_u32 v73, v60, 6, v73
    v_bfe_u32 v60, v0, 4, 1
    v_lshlrev_b32 v60, 1, v60
    v_xor_b32 v60, v0, v60
    v_and_b32 v60, 3, v60
    v_lshl_add_u32 v73, v60, 4, v73
    s_and_b32 s90, s3, 1
    s_mul_i32 s90, s90, 18368
    s_add_u32 s90, s90, s68
    v_add_u32 v73, s90, v73
    v_lshrrev_b32 v74, 5, v0
    v_lshlrev_b32 v74, 11, v74
    v_bfe_u32 v75, v0, 2, 3
    v_lshl_add_u32 v74, v75, 6, v74
    v_bfe_u32 v75, v0, 4, 1
    v_lshl_add_u32 v74, v75, 5, v74
    v_and_b32 v75, 3, v0
    v_lshl_add_u32 v74, v75, 3, v74
    v_add_u32 v74, s65, v74
    v_xor_b32 v75, 32, v74
    v_mov_b64 v[60:61], 0
    v_mov_b64 v[62:63], 0
    v_mov_b64 v[64:65], 0
    v_mov_b64 v[66:67], 0
    v_mov_b64 v[68:69], 0
    v_mov_b64 v[70:71], 0
    s_waitcnt vmcnt(7)
    s_barrier
    v_lshrrev_b32 v22, 5, v0
    s_and_b32 s90, s3, 1
    v_subrev_u32 v22, s90, v22
    v_mul_i32_i24 v22, 15872, v22
    v_add_u32 v22, v22, v2
    v_xor_b32 v23, 32, v22
    ds_read_b64_tr_b16 v[36:37], v22 offset:0
    ds_read_b64_tr_b16 v[38:39], v22 offset:1024
    ds_read_b64_tr_b16 v[40:41], v23 offset:0
    ds_read_b64_tr_b16 v[42:43], v23 offset:1024
    ds_read_b64_tr_b16 v[44:45], v22 offset:2048
    ds_read_b64_tr_b16 v[46:47], v22 offset:3072
    ds_read_b64_tr_b16 v[48:49], v23 offset:2048
    ds_read_b64_tr_b16 v[50:51], v23 offset:3072
    ds_read_b64_tr_b16 v[52:53], v22 offset:4096
    ds_read_b64_tr_b16 v[54:55], v22 offset:5120
    ds_read_b64_tr_b16 v[56:57], v23 offset:4096
    ds_read_b64_tr_b16 v[58:59], v23 offset:5120
    s_mov_b32 s80, 0
    v_cmp_u_f32 vcc, v27, v31
    s_cbranch_vccz L_go_108
    s_branch L_chk_109
L_spin_107:
    s_waitcnt vmcnt(16)
    buffer_load_dwordx4 v[24:27], v12, s[40:43], s76 offen sc1
    buffer_load_dwordx4 v[28:31], v12, s[40:43], s76 offen offset:128 sc1
    s_add_u32 s80, s80, 1024
    s_cbranch_scc1 L_abort
L_chk_109:
    v_cmp_u_f32 vcc, v27, v31
    s_cbranch_vccz L_go_108
    v_cmp_u_f32 vcc, v27, v31
    s_cbranch_vccz L_go_108
    v_cmp_u_f32 vcc, v27, v31
    s_cbranch_vccz L_go_108
    v_cmp_u_f32 vcc, v27, v31
    s_cbranch_vccz L_go_108
    v_cmp_u_f32 vcc, v27, v31
    s_cbranch_vccz L_go_108
    v_cmp_u_f32 vcc, v27, v31
    s_cbranch_vccz L_go_108
    v_cmp_u_f32 vcc, v27, v31
    s_cbranch_vccz L_go_108
    v_cmp_u_f32 vcc, v27, v31
    s_cbranch_vccz L_go_108
    v_cmp_u_f32 vcc, v27, v31
    s_cbranch_vccz L_go_108
    v_cmp_u_f32 vcc, v27, v31
    s_cbranch_vccnz L_spin_107
L_go_108:
    v_pk_add_f32 v[8:9], v[24:25], v[28:29]
    v_pk_add_f32 v[10:11], v[26:27], v[30:31]
    s_nop 1
    v_permlane32_swap_b32 v8, v10
    v_permlane32_swap_b32 v9, v11
    v_add_f32 v8, v8, v10
    v_add_f32 v9, v9, v11
    s_nop 1
    v_permlane16_swap_b32 v8, v9
    v_add_f32 v8, v8, v9
    s_nop 1
    v_add_f32_dpp v8, v8, v8 row_ror:8 row_mask:0xf bank_mask:0xf
    v_add_f32 v8, v8, v4
    v_cvt_pk_bf16_f32 v9, v8, v8
    ds_write_b16 v13, v9
    v_cmp_u_f32 vcc, v8, v8
    s_cbranch_vccnz L_spin_107
    v_lshlrev_b32 v4, 16, v9
    s_waitcnt lgkmcnt(0)
    s_barrier
    ds_read_b128 v[76:79], v14
    s_waitcnt lgkmcnt(0)
    v_mfma_f32_16x16x32_bf16 v[32:35], v[76:79], v[76:79], 0
    v_mfma_f32_16x16x32_bf16 v[8:11], v[76:79], v[36:39], 0
    v_lshlrev_b32 v36, 4, v0
    v_and_b32 v37, 32, v0
    v_mfma_f32_16x16x32_bf16 v[12:15], v[76:79], v[40:43], 0
    v_lshl_add_u32 v37, v37, 26, v36
    v_mov_b32 v40, -1
    v_mfma_f32_16x16x32_bf16 v[16:19], v[76:79], v[44:47], 0
    v_mov_b32 v41, -1
    v_mov_b32 v42, -1
    v_mfma_f32_16x16x32_bf16 v[20:23], v[76:79], v[48:51], 0
    v_mov_b32 v43, -1
    v_mov_b32 v44, -1
    s_waitcnt vmcnt(0)
    v_mfma_f32_16x16x32_bf16 v[24:27], v[76:79], v[52:55], 0
    v_mov_b32 v45, -1
    v_mov_b32 v46, -1
    v_mfma_f32_16x16x32_bf16 v[28:31], v[76:79], v[56:59], 0
    v_mov_b32 v47, -1
    s_mov_b64 exec, 0xffff
    v_mov_b32_dpp v10, v32 row_newbcast:0 row_mask:0xf bank_mask:0xf
    v_mov_b32_dpp v11, v35 row_newbcast:0 row_mask:0xf bank_mask:0xf
    v_add_f32 v8, v8, v17
    v_add_f32_dpp v10, v33, v10 row_newbcast:1 row_mask:0xf bank_mask:0xf
    v_add_f32_dpp v11, v35, v11 row_newbcast:1 row_mask:0xf bank_mask:0xf
    v_add_f32 v9, v12, v21
    v_add_f32_dpp v10, v34, v10 row_newbcast:2 row_mask:0xf bank_mask:0xf
    v_add_f32_dpp v11, v35, v11 row_newbcast:2 row_mask:0xf bank_mask:0xf
    v_add_f32 v8, v8, v26
    v_add_f32 v9, v9, v30
    buffer_store_dwordx4 v[8:11], v36, s[40:43], s73 offen
    s_mov_b64 exec, -1
L_qjoin_106:
    buffer_load_dwordx4 v[40:43], v36, s[40:43], s79 offen sc1
    buffer_load_dwordx4 v[44:47], v37, s[40:43], s79 offen offset:1024 sc1
    v_lshrrev_b32 v12, 4, v0
    v_and_b32 v13, 1, v12
    v_lshlrev_b32 v12, 4, v12
    v_mul_u32_u24 v13, 4080, v13
    v_bfe_u32 v14, v0, 1, 1
    v_lshl_add_u32 v12, v14, 4, v12
    v_and_b32 v15, 12, v0
    v_add3_u32 v12, v12, v13, v15
    v_and_b32 v13, 1, v0
    s_lshl_b32 s70, s3, 6
    s_add_u32 s70, s70, 154880
    v_lshl_add_u32 v12, v13, 1, v12
    v_add_u32 v8, s70, v12
    v_lshlrev_b32 v9, 4, v13
    v_lshl_add_u32 v9, v14, 6, v9
    v_bfe_u32 v14, v0, 4, 1
    v_lshl_add_u32 v9, v14, 5, v9
    v_lshrrev_b32 v14, 5, v0
    v_lshl_add_u32 v9, v14, 7, v9
    v_add_u32 v9, 154880, v9
    v_mul_u32_u24 v76, 0xaaaa, v13
    v_add_u32 v76, 0x4444, v76
    s_sub_u32 s70, s65, s66
    v_add_u32 v2, s70, v2
    v_add_u32 v7, s70, v7
    v_mov_b64 v[16:17], 0
    v_mov_b64 v[18:19], 0
    v_mov_b64 v[20:21], 0
    v_mov_b64 v[22:23], 0
    v_mov_b64 v[24:25], 0
    v_mov_b64 v[26:27], 0
    v_mov_b64 v[28:29], 0
    v_mov_b64 v[30:31], 0
    v_mov_b64 v[56:57], 0
    v_mov_b64 v[58:59], 0
    s_mov_b32 s80, 0
L_spin_113:
    buffer_load_dwordx4 v[40:43], v36, s[40:43], s79 offen sc1
    buffer_load_dwordx4 v[44:47], v37, s[40:43], s79 offen offset:1024 sc1
    s_add_u32 s80, s80, 1024
    s_cbranch_scc1 L_abort
    s_waitcnt vmcnt(2)
    v_cmp_u_f32 vcc, v43, v47
    s_cbranch_vccnz L_spin_113
    v_pk_add_f32 v[12:13], v[40:41], v[44:45]
    v_pk_add_f32 v[14:15], v[42:43], v[46:47]
    s_nop 0
    v_permlane32_swap_b32 v12, v13
    v_permlane32_swap_b32 v14, v15
    v_add_f32 v12, v12, v13
    v_add_f32 v14, v14, v15
    s_nop 1
    v_permlane16_swap_b32 v12, v14
    v_add_f32 v12, v12, v14
    s_nop 0
    v_readlane_b32 s71, v12, 48
    v_readlane_b32 s72, v12, 16
    v_cmp_u_f32 vcc, v12, v12
    v_fma_f32 v13, -s71, v5, v12
    v_cvt_pk_bf16_f32 v13, v13, v13
    ds_write_b16 v8, v13
    s_cbranch_vccnz L_spin_113
    v_mov_b32 v14, 0x3ae38e39
    v_mul_f32 v15, s71, v14
    v_mul_f32 v14, s72, v14
    v_fma_f32 v14, -v15, v15, v14
    v_max_f32 v14, 0, v14
    v_add_f32 v14, 0x3727c5ac, v14
    v_rsq_f32 v14, v14
    s_waitcnt lgkmcnt(0)
    s_barrier
    s_mov_b32 exec_lo, 0x000f000f
    s_mov_b32 exec_hi, 0x000f000f
    ds_read_b128 v[56:59], v9
    s_lshl_b64 exec, exec, 4
    ds_read_b128 v[60:63], v9
    s_lshl_b64 exec, exec, 4
    ds_read_b128 v[64:67], v9
    s_lshl_b64 exec, exec, 4
    ds_read_b128 v[68:71], v9
    s_mov_b64 exec, -1
    v_mul_f32 v14, 0x3e0293ee, v14
    s_nop 0
    v_readfirstlane_b32 s81, v14
    s_waitcnt lgkmcnt(3)
    v_smfmac_f32_16x16x64_bf16 v[16:19], v[56:59], a[0:7], v76
    s_add_u32 m0, s66, 0
    s_waitcnt lgkmcnt(2)
    v_smfmac_f32_16x16x64_bf16 v[16:19], v[60:63], a[64:71], v76
    s_add_u32 s91, s93, 0
    s_waitcnt lgkmcnt(1)
    v_smfmac_f32_16x16x64_bf16 v[16:19], v[64:67], a[128:135], v76
    buffer_load_dwordx4 v72, s[20:23], s91 offen nt lds
    ds_read_b64_tr_b16 a[0:1], v74 offset:0
    s_waitcnt lgkmcnt(1)
    v_smfmac_f32_16x16x64_bf16 v[16:19], v[68:71], a[192:199], v76
    s_add_u32 m0, s66, 896
    ds_read_b64_tr_b16 a[2:3], v74 offset:1024
    v_smfmac_f32_16x16x64_bf16 v[20:23], v[56:59], a[32:39], v76
    ds_read_b64_tr_b16 a[4:5], v75 offset:0
    v_smfmac_f32_16x16x64_bf16 v[20:23], v[60:63], a[96:103], v76
    buffer_load_dwordx4 v72, s[20:23], s91 offen offset:128 nt lds
    ds_read_b64_tr_b16 a[6:7], v75 offset:1024
    v_smfmac_f32_16x16x64_bf16 v[20:23], v[64:67], a[160:167], v76
    s_add_u32 m0, s66, 2048
    ds_read_b64_tr_b16 a[64:65], v74 offset:512
    v_add_f32 v16, v16, v17
    v_add_f32 v18, v18, v19
    v_smfmac_f32_16x16x64_bf16 v[20:23], v[68:71], a[224:231], v76
    s_add_u32 s91, s93, 16384
    ds_read_b64_tr_b16 a[66:67], v74 offset:1536
    v_add_f32_dpp v32, v18, v16 row_ror:8 row_mask:0xf bank_mask:0x3
    v_smfmac_f32_16x16x64_bf16 v[24:27], v[56:59], a[8:15], v76
    buffer_load_dwordx4 v72, s[20:23], s91 offen nt lds
    ds_read_b64_tr_b16 a[68:69], v75 offset:512
    v_mov_b64 v[16:17], 0
    v_smfmac_f32_16x16x64_bf16 v[24:27], v[60:63], a[72:79], v76
    s_add_u32 m0, s66, 2944
    ds_read_b64_tr_b16 a[70:71], v75 offset:1536
    v_mov_b64 v[18:19], 0
    v_smfmac_f32_16x16x64_bf16 v[24:27], v[64:67], a[136:143], v76
    ds_read_b64_tr_b16 a[128:129], v74 offset:4096
    v_add_f32 v20, v20, v21
    v_add_f32 v22, v22, v23
    v_smfmac_f32_16x16x64_bf16 v[24:27], v[68:71], a[200:207], v76
    buffer_load_dwordx4 v72, s[20:23], s91 offen offset:128 nt lds
    ds_read_b64_tr_b16 a[130:131], v74 offset:5120
    v_add_f32_dpp v32, v20, v22 row_ror:8 row_mask:0xf bank_mask:0xc
    v_smfmac_f32_16x16x64_bf16 v[28:31], v[56:59], a[40:47], v76
    ds_read_b64_tr_b16 a[192:193], v75 offset:4096
    v_mov_b64 v[20:21], 0
    v_smfmac_f32_16x16x64_bf16 v[28:31], v[60:63], a[104:111], v76
    ds_read_b64_tr_b16 a[194:195], v75 offset:5120
    v_mov_b64 v[22:23], 0
    v_smfmac_f32_16x16x64_bf16 v[28:31], v[64:67], a[168:175], v76
    s_waitcnt lgkmcnt(4)
    ds_read_b64_tr_b16 a[32:33], v74 offset:4608
    v_add_f32 v24, v24, v25
    v_add_f32 v26, v26, v27
    v_smfmac_f32_16x16x64_bf16 v[28:31], v[68:71], a[232:239], v76
    s_add_u32 m0, s65, 0
    ds_read_b64_tr_b16 a[34:35], v74 offset:5632
    v_add_f32_dpp v33, v26, v24 row_ror:8 row_mask:0xf bank_mask:0x3
    v_smfmac_f32_16x16x64_bf16 v[16:19], v[56:59], a[16:23], v76
    s_add_u32 s91, s99, 0
    ds_read_b64_tr_b16 a[96:97], v75 offset:4608
    v_mov_b64 v[24:25], 0
    v_smfmac_f32_16x16x64_bf16 v[16:19], v[60:63], a[80:87], v76
    buffer_load_dwordx4 v73, s[16:19], s91 offen nt lds
    ds_read_b64_tr_b16 a[98:99], v75 offset:5632
    v_mov_b64 v[26:27], 0
    v_smfmac_f32_16x16x64_bf16 v[16:19], v[64:67], a[144:151], v76
    s_add_u32 m0, s65, 1024
    ds_read_b64_tr_b16 a[160:161], v74 offset:8192
    v_add_f32 v28, v28, v29
    v_add_f32 v30, v30, v31
    v_smfmac_f32_16x16x64_bf16 v[16:19], v[68:71], a[208:215], v76
    s_add_u32 s91, s99, 4608
    ds_read_b64_tr_b16 a[162:163], v74 offset:9216
    v_add_f32_dpp v33, v28, v30 row_ror:8 row_mask:0xf bank_mask:0xc
    v_smfmac_f32_16x16x64_bf16 v[20:23], v[56:59], a[48:55], v76
    buffer_load_dwordx4 v73, s[16:19], s91 offen nt lds
    ds_read_b64_tr_b16 a[224:225], v75 offset:8192
    v_mov_b64 v[28:29], 0
    v_smfmac_f32_16x16x64_bf16 v[20:23], v[60:63], a[112:119], v76
    s_add_u32 m0, s65, 2048
    ds_read_b64_tr_b16 a[226:227], v75 offset:9216
    v_mov_b64 v[30:31], 0
    v_smfmac_f32_16x16x64_bf16 v[20:23], v[64:67], a[176:183], v76
    s_add_u32 s91, s99, 36864
    ds_read_b64_tr_b16 a[8:9], v74 offset:8704
    v_add_f32 v16, v16, v17
    v_smfmac_f32_16x16x64_bf16 v[20:23], v[68:71], a[240:247], v76
    buffer_load_dwordx4 v73, s[16:19], s91 offen nt lds
    ds_read_b64_tr_b16 a[10:11], v74 offset:9728
    v_add_f32 v18, v18, v19
    v_smfmac_f32_16x16x64_bf16 v[24:27], v[56:59], a[24:31], v76
    s_add_u32 m0, s65, 3072
    ds_read_b64_tr_b16 a[72:73], v75 offset:8704
    v_add_f32_dpp v34, v18, v16 row_ror:8 row_mask:0xf bank_mask:0x3
    v_smfmac_f32_16x16x64_bf16 v[24:27], v[60:63], a[88:95], v76
    s_add_u32 s91, s99, 41472
    ds_read_b64_tr_b16 a[74:75], v75 offset:9728
    v_smfmac_f32_16x16x64_bf16 v[24:27], v[64:67], a[152:159], v76
    buffer_load_dwordx4 v73, s[16:19], s91 offen nt lds
    ds_read_b64_tr_b16 a[132:133], v74 offset:12288
    v_add_f32 v20, v20, v21
    v_smfmac_f32_16x16x64_bf16 v[24:27], v[68:71], a[216:223], v76
    s_waitcnt lgkmcnt(9)
    ds_read_b64_tr_b16 a[134:135], v74 offset:13312
    v_add_f32 v22, v22, v23
    v_smfmac_f32_16x16x64_bf16 v[28:31], v[56:59], a[56:63], v76
    s_add_u32 m0, s65, 4096
    ds_read_b64_tr_b16 a[196:197], v75 offset:12288
    v_add_f32_dpp v34, v20, v22 row_ror:8 row_mask:0xf bank_mask:0xc
    v_smfmac_f32_16x16x64_bf16 v[28:31], v[60:63], a[120:127], v76
    s_add_u32 s91, s99, 73728
    ds_read_b64_tr_b16 a[198:199], v75 offset:13312
    v_smfmac_f32_16x16x64_bf16 v[28:31], v[64:67], a[184:191], v76
    buffer_load_dwordx4 v73, s[16:19], s91 offen nt lds
    ds_read_b64_tr_b16 a[36:37], v74 offset:12800
    v_add_f32 v24, v24, v25
    v_smfmac_f32_16x16x64_bf16 v[28:31], v[68:71], a[248:255], v76
    s_add_u32 m0, s65, 5120
    ds_read_b64_tr_b16 a[38:39], v74 offset:13824
    v_add_f32 v26, v26, v27
    s_nop 1
    v_add_f32_dpp v35, v26, v24 row_ror:8 row_mask:0xf bank_mask:0x3
    s_waitcnt vmcnt(9)
    v_mov_b64 v[40:41], 0
    v_mov_b64 v[42:43], 0
    v_mov_b64 v[44:45], 0
    v_mov_b64 v[46:47], 0
    v_mov_b64 v[48:49], 0
    v_mov_b64 v[50:51], 0
    v_add_f32 v28, v28, v29
    v_add_f32 v30, v30, v31
    s_nop 1
    v_add_f32_dpp v35, v28, v30 row_ror:8 row_mask:0xf bank_mask:0xc
    v_max3_f32 v36, v32, v33, v34
    v_max_f32 v36, v36, v35
    v_mul_f32 v32, s81, v32
    v_mul_f32 v33, s81, v33
    v_max_f32_dpp v36, v36, v36 quad_perm:[1,0,3,2] row_mask:0xf bank_mask:0xf
    v_mul_f32 v34, s81, v34
    v_mul_f32 v35, s81, v35
    v_max_f32_dpp v36, v36, v36 quad_perm:[2,3,0,1] row_mask:0xf bank_mask:0xf
    v_lshl_add_u32 v38, v0, 2, s88
    v_and_b32 v79, 1, v0
    v_max_f32_dpp v36, v36, v36 row_half_mirror row_mask:0xf bank_mask:0xf
    v_mul_u32_u24 v79, 288, v79
    v_lshrrev_b32 v77, 4, v0
    v_max_f32_dpp v36, v36, v36 row_mirror row_mask:0xf bank_mask:0xf
    v_add_u32 v79, s88, v79
    v_lshl_add_u32 v78, v77, 4, v79
    v_max_f32_dpp v36, v36, v36 row_bcast:15 row_mask:0xa bank_mask:0xf
    v_mov_b64 v[52:53], 0
    v_mov_b64 v[54:55], 0
    v_max_f32_dpp v36, v36, v36 row_bcast:31 row_mask:0xc bank_mask:0xf
    v_mul_f32 v36, s81, v36
    v_lshl_add_u32 v79, v77, 3, v79
    v_readlane_b32 s75, v36, 63
    v_mov_b64 v[56:57], 0
    v_mov_b64 v[58:59], 0
    v_subrev_f32 v32, s75, v32
    v_subrev_f32 v33, s75, v33
    v_exp_f32 v32, v32
    v_exp_f32 v33, v33
    v_subrev_f32 v34, s75, v34
    v_subrev_f32 v35, s75, v35
    v_exp_f32 v34, v34
    v_exp_f32 v35, v35
    v_cvt_pk_bf16_f32 v36, v32, v33
    v_cvt_pk_bf16_f32 v37, v34, v35
    ds_write2_b32 v38, v36, v37 offset0:112 offset1:184
    ds_read_b128 v[16:19], v78 offset:448
    ds_read_b128 v[20:23], v78 offset:512
    ds_read_b128 v[24:27], v78 offset:576
    ds_read_b128 v[28:31], v78 offset:640
    v_add_f32 v32, v32, v33
    v_add_f32 v34, v34, v35
    v_add_f32 v33, v32, v34
    v_mov_b32 v32, s75
    s_lshl_b32 s70, s3, 3
    v_add_f32_dpp v33, v33, v33 quad_perm:[1,0,3,2] row_mask:0xf bank_mask:0xf
    s_add_u32 s70, s70, 151296
    v_mov_b32 v34, s70
    v_add_f32_dpp v33, v33, v33 quad_perm:[2,3,0,1] row_mask:0xf bank_mask:0xf
    v_mov_b64 v[60:61], 0
    v_mov_b64 v[62:63], 0
    v_mov_b64 v[64:65], 0
    v_mov_b64 v[66:67], 0
    v_mov_b64 v[68:69], 0
    v_mov_b64 v[70:71], 0
    s_waitcnt lgkmcnt(3)
    v_smfmac_f32_16x16x64_bf16 v[40:43], v[16:19], v[80:87], v76
    s_add_u32 s91, s99, 78336
    ds_read_b64_tr_b16 a[100:101], v75 offset:12800
    v_add_f32_dpp v33, v33, v33 row_half_mirror row_mask:0xf bank_mask:0xf
    v_lshrrev_b32 v38, 2, v0
    v_smfmac_f32_16x16x64_bf16 v[44:47], v[16:19], v[88:95], v76
    buffer_load_dwordx4 v73, s[16:19], s91 offen nt lds
    ds_read_b64_tr_b16 a[102:103], v75 offset:13824
    v_add_f32_dpp v33, v33, v33 row_mirror row_mask:0xf bank_mask:0xf
    v_and_b32 v39, 3, v0
    v_smfmac_f32_16x16x64_bf16 v[48:51], v[16:19], v[96:103], v76
    s_add_u32 m0, s65, 6144
    ds_read_b64_tr_b16 a[164:165], v74 offset:16384
    v_add_f32_dpp v33, v33, v33 row_bcast:15 row_mask:0xa bank_mask:0xf
    v_lshlrev_b32 v39, 2, v39
    v_smfmac_f32_16x16x64_bf16 v[52:55], v[16:19], v[104:111], v76
    s_add_u32 s91, s99, 110592
    ds_read_b64_tr_b16 a[166:167], v74 offset:17408
    v_add_f32_dpp v33, v33, v33 row_bcast:31 row_mask:0xc bank_mask:0xf
    v_lshl_add_u32 v38, v38, 7, v39
    v_smfmac_f32_16x16x64_bf16 v[56:59], v[16:19], v[112:119], v76
    buffer_load_dwordx4 v73, s[16:19], s91 offen nt lds
    ds_read_b64_tr_b16 a[228:229], v75 offset:16384
    s_lshl_b32 s70, s63, 3
    s_sub_u32 s70, 2048, s70
    s_add_u32 s70, s70, s89
    v_mov_b32 v39, 1073741824
    v_readlane_b32 s71, v33, 63
    v_smfmac_f32_16x16x64_bf16 v[60:63], v[16:19], v[120:127], v76
    s_add_u32 m0, s65, 7168
    ds_read_b64_tr_b16 a[230:231], v75 offset:17408
    v_writelane_b32 v39, s70, 0
    s_add_u32 s73, s45, 33280
    v_mov_b32 v33, s71
    v_smfmac_f32_16x16x64_bf16 v[64:67], v[16:19], v[128:135], v76
    s_add_u32 s91, s99, 115200
    ds_read_b64_tr_b16 a[12:13], v74 offset:16896
    ds_write_b64 v34, v[32:33]
    v_mov_b32 v34, 151296
    v_smfmac_f32_16x16x64_bf16 v[68:71], v[16:19], v[136:143], v76
    buffer_load_dwordx4 v73, s[16:19], s91 offen nt lds
    ds_read_b64_tr_b16 a[14:15], v74 offset:17920
    v_and_b32 v32, 7, v0
    s_waitcnt lgkmcnt(11)
    v_smfmac_f32_16x16x64_bf16 v[40:43], v[20:23], v[144:151], v76
    s_add_u32 m0, s66, 4096
    ds_read_b64_tr_b16 a[76:77], v75 offset:16896
    v_lshlrev_b32 v32, 4, v32
    v_smfmac_f32_16x16x64_bf16 v[44:47], v[20:23], v[152:159], v76
    s_add_u32 s91, s93, 32768
    ds_read_b64_tr_b16 a[78:79], v75 offset:17920
    v_bfe_u32 v33, v0, 3, 1
    v_smfmac_f32_16x16x64_bf16 v[48:51], v[20:23], v[160:167], v76
    s_waitcnt lgkmcnt(3)
    s_barrier
    ds_read_b128 v[8:11], v34
    ds_read_b128 v[12:15], v34 offset:16
    v_smfmac_f32_16x16x64_bf16 v[52:55], v[20:23], v[168:175], v76
    buffer_load_dwordx4 v72, s[20:23], s91 offen nt lds
    ds_read_b64 v[16:17], v79 offset:576
    v_lshl_add_u32 v32, v33, 9, v32
    v_smfmac_f32_16x16x64_bf16 v[56:59], v[20:23], v[176:183], v76
    s_add_u32 m0, s66, 4992
    ds_read_b64 v[18:19], v79 offset:608
    v_lshrrev_b32 v33, 4, v0
    v_smfmac_f32_16x16x64_bf16 v[60:63], v[20:23], v[184:191], v76
    v_lshl_add_u32 v32, v33, 7, v32
    v_smfmac_f32_16x16x64_bf16 v[64:67], v[20:23], v[192:199], v76
    buffer_load_dwordx4 v72, s[20:23], s91 offen offset:128 nt lds
    s_waitcnt lgkmcnt(2)
    v_max3_f32 v36, v8, v10, v12
    v_max_f32 v36, v36, v14
    v_smfmac_f32_16x16x64_bf16 v[68:71], v[20:23], v[200:207], v76
    s_add_u32 m0, s66, 6144
    v_sub_f32 v8, v8, v36
    v_sub_f32 v10, v10, v36
    v_smfmac_f32_16x16x64_bf16 v[40:43], v[24:27], v[208:215], v76
    s_add_u32 s91, s93, 49152
    v_exp_f32 v8, v8
    v_sub_f32 v12, v12, v36
    v_smfmac_f32_16x16x64_bf16 v[44:47], v[24:27], v[216:223], v76
    buffer_load_dwordx4 v72, s[20:23], s91 offen nt lds
    v_exp_f32 v10, v10
    v_sub_f32 v14, v14, v36
    v_smfmac_f32_16x16x64_bf16 v[48:51], v[24:27], v[224:231], v76
    s_add_u32 m0, s66, 7040
    v_exp_f32 v12, v12
    v_mul_f32 v37, v8, v9
    v_smfmac_f32_16x16x64_bf16 v[52:55], v[24:27], v[232:239], v76
    v_exp_f32 v14, v14
    v_fmac_f32 v37, v10, v11
    v_smfmac_f32_16x16x64_bf16 v[40:43], v[28:31], a[128:135], v76
    buffer_load_dwordx4 v72, s[20:23], s91 offen offset:128 nt lds
    v_fmac_f32 v37, v12, v13
    v_smfmac_f32_16x16x64_bf16 v[44:47], v[28:31], a[192:199], v76
    v_fmac_f32 v37, v14, v15
    v_smfmac_f32_16x16x64_bf16 v[48:51], v[28:31], a[32:39], v76
    buffer_store_dwordx2 v[36:37], v39, s[40:43], s73 offen
    v_smfmac_f32_16x16x64_bf16 v[52:55], v[28:31], a[96:103], v76
    v_lshl_add_u32 v33, v33, 2, v0
    v_smfmac_f32_16x16x64_bf16 v[56:59], v[28:31], a[160:167], v76
    v_and_b32 v33, 7, v33
    v_smfmac_f32_16x16x64_bf16 v[60:63], v[28:31], a[224:231], v76
    v_lshlrev_b32 v33, 3, v33
    v_smfmac_f32_16x16x64_bf16 v[64:67], v[28:31], a[8:15], v76
    s_add_u32 s79, s46, 33280
    v_and_b32 v34, 15, v0
    v_smfmac_f32_16x16x64_bf16 v[68:71], v[28:31], a[72:79], v76
    v_lshrrev_b32 v35, 4, v0
    s_waitcnt lgkmcnt(0)
    v_smfmac_f32_16x16x32_bf16 v[56:59], v[16:17], v[240:243], v76
    v_mul_u32_u24 v35, 576, v35
    v_smfmac_f32_16x16x32_bf16 v[60:63], v[16:17], v[244:247], v76
    v_lshl_add_u32 v34, v34, 2, v35
    v_smfmac_f32_16x16x32_bf16 v[64:67], v[16:17], v[248:251], v76
    s_add_u32 s70, s88, 1024
    v_add_u32 v34, s70, v34
    v_lshlrev_b32 v35, 3, v0
    v_smfmac_f32_16x16x32_bf16 v[68:71], v[16:17], v[252:255], v76
    v_add_u32 v35, 148480, v35
    v_add_f32 v40, v40, v41
    v_smfmac_f32_16x16x32_bf16 v[56:59], v[18:19], a[0:3], v76
    v_add_f32 v44, v44, v45
    v_smfmac_f32_16x16x32_bf16 v[60:63], v[18:19], a[4:7], v76
    v_add_f32 v48, v48, v49
    v_smfmac_f32_16x16x32_bf16 v[64:67], v[18:19], a[64:67], v76
    v_add_f32 v52, v52, v53
    v_smfmac_f32_16x16x32_bf16 v[68:71], v[18:19], a[68:71], v76
    ds_write2_b32 v34, v40, v44 offset0:0 offset1:16
    ds_write2_b32 v34, v48, v52 offset0:32 offset1:48
    v_mov_b32 v24, -1
    v_mov_b32 v25, -1
    v_mov_b32 v26, -1
    v_add_f32 v56, v56, v57
    v_add_f32 v60, v60, v61
    ds_write2_b32 v34, v56, v60 offset0:64 offset1:80
    v_add_f32 v64, v64, v65
    v_add_f32 v68, v68, v69
    ds_write2_b32 v34, v64, v68 offset0:96 offset1:112
    v_mov_b32 v27, -1
    v_mov_b32 v28, -1
    v_mov_b32 v29, -1
    v_mov_b32 v30, -1
    v_mov_b32 v31, -1
    v_mov_b32 v72, -1
    v_mov_b32 v73, -1
    s_waitcnt vmcnt(5)
    s_cmp_lg_u32 s3, 0
    s_waitcnt lgkmcnt(0)
    s_barrier
    s_cbranch_scc1 L_skip_116
    ds_read_b64 v[16:17], v35
    ds_read_b64 v[18:19], v35 offset:4096
    ds_read_b64 v[20:21], v35 offset:8192
    ds_read_b64 v[22:23], v35 offset:12288
    s_waitcnt lgkmcnt(3)
    v_pk_mul_f32 v[16:17], v[16:17], v[8:9] op_sel_hi:[1,0]
    s_waitcnt lgkmcnt(2)
    v_pk_fma_f32 v[16:17], v[18:19], v[10:11], v[16:17] op_sel_hi:[1,0,1]
    s_waitcnt lgkmcnt(1)
    v_pk_fma_f32 v[16:17], v[20:21], v[12:13], v[16:17] op_sel_hi:[1,0,1]
    s_waitcnt lgkmcnt(0)
    v_pk_fma_f32 v[16:17], v[22:23], v[14:15], v[16:17] op_sel_hi:[1,0,1]
    v_cvt_pk_bf16_f32 v16, v16, v17
    buffer_store_dword v16, v38, s[40:43], s73 offen
L_skip_116:
    s_cmp_ge_u32 s61, 18
    s_cbranch_scc1 L_idle_117
    buffer_load_dwordx2 v[72:73], v33, s[40:43], s79 offen offset:2048 sc1
    buffer_load_dwordx4 v[24:27], v32, s[40:43], s79 offen offset:0 sc1
    buffer_load_dwordx4 v[28:31], v32, s[40:43], s79 offen offset:1024 sc1
    v_lshrrev_b32 v18, 5, v0
    s_add_u32 s70, s88, 3584
    v_lshl_add_u32 v78, v0, 2, s70
    s_and_b32 s90, s3, 1
    s_mov_b32 s71, 151040
    v_and_b32 v74, 7, v0
    v_subrev_u32 v18, s90, v18
    v_lshlrev_b32 v74, 4, v74
    v_bfe_u32 v79, v0, 2, 1
    v_mul_i32_i24 v18, 19968, v18
    v_lshl_add_u32 v79, v79, 7, v74
    v_bfe_u32 v75, v0, 4, 1
    v_add_u32 v18, v18, v2
    v_lshl_add_u32 v75, v75, 13, v74
    v_bfe_u32 v8, v0, 3, 1
    v_xor_b32 v19, 32, v18
    v_lshl_add_u32 v75, v8, 11, v75
    v_lshl_add_u32 v74, v8, 8, v74
    ds_read_b64_tr_b16 v[40:41], v18 offset:0
    v_lshlrev_b32 v8, 12, v8
    v_add3_u32 v79, v79, v8, s71
    ds_read_b64_tr_b16 v[42:43], v18 offset:1024
    s_and_b32 s70, s61, 30
    buffer_load_dwordx2 v[72:73], v33, s[40:43], s79 offen offset:2048 sc1
    buffer_load_dwordx4 v[24:27], v32, s[40:43], s79 offen offset:0 sc1
    buffer_load_dwordx4 v[28:31], v32, s[40:43], s79 offen offset:1024 sc1
    s_add_u32 s73, s70, 36
    ds_read_b64_tr_b16 v[44:45], v19 offset:0
    s_and_b32 s71, s73, -4
    s_add_u32 s73, s73, s71
    ds_read_b64_tr_b16 v[46:47], v19 offset:1024
    s_lshl_b32 s73, s73, 11
    s_add_u32 s73, s73, 901120
    ds_read_b64_tr_b16 v[48:49], v18 offset:2048
    s_and_b32 s71, s61, 1
    s_lshl_b32 s69, s60, 1
    ds_read_b64_tr_b16 v[50:51], v18 offset:3072
    s_add_u32 s69, s69, s71
    s_lshl_b32 s69, s69, 7
    ds_read_b64_tr_b16 v[52:53], v19 offset:2048
    s_add_u32 s73, s73, s69
    s_add_u32 s70, s70, s61
    ds_read_b64_tr_b16 v[54:55], v19 offset:3072
    s_lshl_b32 s70, s70, 7
    s_add_u32 s69, s58, s70
    ds_read_b64_tr_b16 v[56:57], v18 offset:4096
    s_add_u32 s69, s69, 55296
    ds_read_b64_tr_b16 v[58:59], v18 offset:5120
    ds_read_b64_tr_b16 v[60:61], v19 offset:4096
    ds_read_b64_tr_b16 v[62:63], v19 offset:5120
    ds_read_b64_tr_b16 v[64:65], v18 offset:6144
    ds_read_b64_tr_b16 v[66:67], v18 offset:7168
    ds_read_b64_tr_b16 v[68:69], v19 offset:6144
    ds_read_b64_tr_b16 v[70:71], v19 offset:7168
    s_waitcnt vmcnt(7)
    v_bfe_u32 v208, v0, 4, 1
    v_bfe_u32 v209, v0, 2, 2
    v_lshl_add_u32 v208, v208, 3, v209
    v_mul_u32_u24 v208, 8192, v208
    v_lshrrev_b32 v209, 5, v0
    v_lshl_add_u32 v208, v209, 6, v208
    v_bfe_u32 v209, v0, 4, 1
    v_lshlrev_b32 v209, 1, v209
    v_xor_b32 v209, v0, v209
    v_and_b32 v209, 3, v209
    v_lshl_add_u32 v208, v209, 4, v208
    s_and_b32 s90, s3, 1
    s_mul_i32 s90, s90, 131008
    s_add_u32 s90, s90, s67
    v_add_u32 v208, s90, v208
    s_mov_b32 s80, 0
L_spin_119:
    buffer_load_dwordx4 v[24:27], v32, s[40:43], s79 offen offset:0 sc1
    buffer_load_dwordx4 v[28:31], v32, s[40:43], s79 offen offset:1024 sc1
    s_add_u32 s80, s80, 1024
    s_cbranch_scc1 L_abort
    s_waitcnt vmcnt(2)
    v_cmp_u_f32 vcc, v27, v31
    s_cbranch_vccnz L_spin_119
    s_waitcnt lgkmcnt(0)
    v_mov_b64 v[76:77], v[72:73]
    v_mfma_f32_16x16x32_bf16 v[16:19], v[24:27], v[48:51], 0
    s_nop 0
    v_max_f32_dpp v34, v76, v76 row_ror:1 row_mask:0xf bank_mask:0xf
    v_mfma_f32_16x16x32_bf16 v[16:19], v[28:31], v[64:67], v[16:19]
    s_nop 0
    v_max_f32_dpp v34, v34, v34 row_ror:2 row_mask:0xf bank_mask:0xf
    v_mfma_f32_16x16x32_bf16 v[12:15], v[24:27], v[44:47], 0
    s_nop 0
    v_max_f32_dpp v34, v34, v34 row_ror:4 row_mask:0xf bank_mask:0xf
    v_sub_f32 v34, v76, v34
    v_mfma_f32_16x16x32_bf16 v[12:15], v[28:31], v[60:63], v[12:15]
    v_exp_f32 v34, v34
    v_mfma_f32_16x16x32_bf16 v[8:11], v[24:27], v[40:43], 0
    v_mul_f32 v35, v34, v77
    v_mfma_f32_16x16x32_bf16 v[8:11], v[28:31], v[56:59], v[8:11]
    v_mov_b32_dpp v36, v34 row_newbcast:0 row_mask:0xf bank_mask:0xf
    v_mov_b32_dpp v37, v34 row_newbcast:1 row_mask:0xf bank_mask:0xf
    v_mfma_f32_16x16x32_bf16 v[20:23], v[24:27], v[52:55], 0
    v_mov_b32_dpp v38, v34 row_newbcast:2 row_mask:0xf bank_mask:0xf
    v_mov_b32_dpp v39, v34 row_newbcast:3 row_mask:0xf bank_mask:0xf
    v_mfma_f32_16x16x32_bf16 v[20:23], v[28:31], v[68:71], v[20:23]
    v_add_f32_dpp v35, v35, v35 row_ror:1 row_mask:0xf bank_mask:0xf
    v_pk_mul_f32 v[16:17], v[16:17], v[36:37]
    v_pk_fma_f32 v[16:17], v[18:19], v[38:39], v[16:17]
    v_add_f32 v16, v16, v17
    v_add_f32_dpp v35, v35, v35 row_ror:2 row_mask:0xf bank_mask:0xf
    v_pk_mul_f32 v[12:13], v[12:13], v[36:37]
    v_pk_fma_f32 v[12:13], v[14:15], v[38:39], v[12:13]
    v_add_f32 v12, v12, v13
    v_add_f32_dpp v35, v35, v35 row_ror:4 row_mask:0xf bank_mask:0xf
    v_pk_mul_f32 v[8:9], v[8:9], v[36:37]
    v_pk_fma_f32 v[8:9], v[10:11], v[38:39], v[8:9]
    v_add_f32 v8, v8, v9
    v_permlane32_swap_b32 v16, v12
    v_rcp_f32 v35, v35
    v_add_f32 v8, v8, v12
    v_pk_mul_f32 v[20:21], v[20:21], v[36:37]
    v_pk_fma_f32 v[20:21], v[22:23], v[38:39], v[20:21]
    v_add_f32 v20, v20, v21
    v_add_f32 v20, v20, v16
    s_nop 1
    v_permlane16_swap_b32 v8, v20
    v_add_f32 v34, v8, v20
    v_mul_f32 v34, v34, v35
    ds_write_b32 v78, v34
    v_cmp_u_f32 vcc, v34, v34
    s_cbranch_vccnz L_mlagain_122
    s_cmp_lg_u32 s3, 0
    s_waitcnt lgkmcnt(0)
    s_barrier
    s_cbranch_scc1 L_skip_123
    s_mov_b32 exec_hi, 0
    ds_read_b128 v[8:11], v79
    ds_read_b128 v[12:15], v79 offset:8192
    s_waitcnt vmcnt(0) lgkmcnt(0)
    v_pk_add_f32 v[32:33], v[8:9], v[12:13]
    v_pk_add_f32 v[34:35], v[10:11], v[14:15]
    buffer_store_dwordx4 v[32:35], v75, s[40:43], s73 offen sc1
    buffer_store_dwordx4 v[32:35], v74, s[40:43], s69 offen
    s_mov_b64 exec, -1
    s_branch L_skip_123x
L_skip_123:
    s_waitcnt vmcnt(0)
L_skip_123x:
L_join_118:
    s_add_u32 m0, s65, 8192
    s_add_u32 s91, s98, 0
    buffer_load_dwordx4 v208, s[24:27], s91 offen nt lds
    s_add_u32 m0, s65, 9216
    s_add_u32 s91, s98, 32768
    buffer_load_dwordx4 v208, s[24:27], s91 offen nt lds
    s_add_u32 m0, s65, 10240
    s_add_u32 s91, s98, 262144
    buffer_load_dwordx4 v208, s[24:27], s91 offen nt lds
    s_add_u32 m0, s65, 11264
    s_add_u32 s91, s98, 294912
    buffer_load_dwordx4 v208, s[24:27], s91 offen nt lds
    s_add_u32 m0, s65, 12288
    s_add_u32 s91, s98, 524288
    buffer_load_dwordx4 v208, s[24:27], s91 offen nt lds
    s_add_u32 m0, s65, 13312
    s_add_u32 s91, s98, 557056
    buffer_load_dwordx4 v208, s[24:27], s91 offen nt lds
    v_bfe_u32 v16, v0, 2, 3
    v_lshlrev_b32 v16, 13, v16
    v_lshrrev_b32 v17, 5, v0
    v_lshl_add_u32 v16, v17, 6, v16
    v_bfe_u32 v17, v0, 4, 1
    v_lshlrev_b32 v17, 1, v17
    v_xor_b32 v17, v0, v17
    v_and_b32 v17, 3, v17
    v_lshl_add_u32 v16, v17, 4, v16
    s_lshl_b32 s90, s63, 2
    s_add_u32 s90, s90, s3
    s_lshl_b32 s90, s90, 9
    s_lshr_b32 s91, s64, 21
    s_add_u32 s90, s90, s91
    s_lshl_b32 s90, s90, 8
    s_add_u32 m0, s65, 16384
    s_add_u32 s91, s90, 0
    buffer_load_dwordx4 v16, s[28:31], s91 offen nt lds
    s_add_u32 m0, s65, 17280
    s_nop 0
    buffer_load_dwordx4 v16, s[28:31], s91 offen offset:128 nt lds
    s_add_u32 m0, s65, 18432
    s_add_u32 s91, s90, 65536
    buffer_load_dwordx4 v16, s[28:31], s91 offen nt lds
    s_add_u32 m0, s65, 19328
    s_nop 0
    buffer_load_dwordx4 v16, s[28:31], s91 offen offset:128 nt lds
    s_add_u32 s79, s44, s59
    s_add_u32 s79, s79, 13312
    s_cmp_ge_u32 s63, 6
    s_cbranch_scc1 L_qidle_124
    v_lshrrev_b32 v14, 3, v0
    v_lshlrev_b32 v12, 8, v14
    v_and_b32 v13, 7, v0
    v_lshl_add_u32 v12, v13, 4, v12
    s_mul_i32 s70, s63, 3
    s_add_u32 s70, s70, s3
    s_add_u32 s76, s70, 36
    s_and_b32 s71, s76, -4
    s_add_u32 s76, s76, s71
    s_lshl_b32 s76, s76, 11
    s_add_u32 s76, s76, 901120
    s_add_u32 s76, s76, s52
    s_sub_u32 s70, s70, s60
    s_lshl_b32 s70, s70, 8
    s_add_u32 s70, s70, s58
    s_add_u32 s70, s70, 55296
    s_sub_u32 s70, s70, s76
    v_cmp_eq_u32 vcc, s60, v14
    v_add_u32 v15, s70, v12
    s_nop 0
    v_cndmask_b32 v12, v12, v15, vcc
    s_cmp_eq_u32 s3, 3
    s_cselect_b32 s70, 1073741824, 0
    v_add_u32 v12, s70, v12
    v_lshrrev_b32 v14, 4, v0
    v_lshlrev_b32 v13, 3, v13
    v_lshl_add_u32 v13, v14, 1, v13
    s_lshl_b32 s70, s3, 6
    s_add_u32 s70, s70, 150784
    v_add_u32 v13, s70, v13
    v_lshlrev_b32 v14, 4, v14
    v_and_b32 v15, 3, v0
    v_lshl_add_u32 v14, v15, 6, v14
    v_add_u32 v14, 150784, v14
    v_mov_b32 v24, -1
    v_mov_b32 v25, -1
    v_mov_b32 v26, -1
    v_mov_b32 v27, -1
    v_mov_b32 v28, -1
    v_mov_b32 v29, -1
    v_mov_b32 v30, -1
    v_mov_b32 v31, -1
    s_lshl_b32 s73, s63, 8
    s_add_u32 s73, s73, s79
    buffer_load_dwordx4 v[24:27], v12, s[40:43], s76 offen sc1
    buffer_load_dwordx4 v[28:31], v12, s[40:43], s76 offen offset:128 sc1
    s_waitcnt vmcnt(6)
    s_barrier
    v_lshrrev_b32 v22, 5, v0
    s_and_b32 s90, s3, 1
    v_subrev_u32 v22, s90, v22
    v_mul_i32_i24 v22, 19968, v22
    v_add_u32 v22, v22, v2
    v_xor_b32 v23, 32, v22
    ds_read_b64_tr_b16 v[36:37], v22 offset:8192
    ds_read_b64_tr_b16 v[38:39], v22 offset:9216
    ds_read_b64_tr_b16 v[40:41], v23 offset:8192
    ds_read_b64_tr_b16 v[42:43], v23 offset:9216
    ds_read_b64_tr_b16 v[44:45], v22 offset:10240
    ds_read_b64_tr_b16 v[46:47], v22 offset:11264
    ds_read_b64_tr_b16 v[48:49], v23 offset:10240
    ds_read_b64_tr_b16 v[50:51], v23 offset:11264
    ds_read_b64_tr_b16 v[52:53], v22 offset:12288
    ds_read_b64_tr_b16 v[54:55], v22 offset:13312
    ds_read_b64_tr_b16 v[56:57], v23 offset:12288
    ds_read_b64_tr_b16 v[58:59], v23 offset:13312
    s_mov_b32 s80, 0
    v_cmp_u_f32 vcc, v27, v31
    s_cbranch_vccz L_go_127
    s_branch L_chk_128
L_spin_126:
    s_waitcnt vmcnt(16)
    buffer_load_dwordx4 v[24:27], v12, s[40:43], s76 offen sc1
    buffer_load_dwordx4 v[28:31], v12, s[40:43], s76 offen offset:128 sc1
    s_add_u32 s80, s80, 1024
    s_cbranch_scc1 L_abort
L_chk_128:
    v_cmp_u_f32 vcc, v27, v31
    s_cbranch_vccz L_go_127
    v_cmp_u_f32 vcc, v27, v31
    s_cbranch_vccz L_go_127
    v_cmp_u_f32 vcc, v27, v31
    s_cbranch_vccz L_go_127
    v_cmp_u_f32 vcc, v27, v31
    s_cbranch_vccz L_go_127
    v_cmp_u_f32 vcc, v27, v31
    s_cbranch_vccz L_go_127
    v_cmp_u_f32 vcc, v27, v31
    s_cbranch_vccz L_go_127
    v_cmp_u_f32 vcc, v27, v31
    s_cbranch_vccz L_go_127
    v_cmp_u_f32 vcc, v27, v31
    s_cbranch_vccz L_go_127
    v_cmp_u_f32 vcc, v27, v31
    s_cbranch_vccz L_go_127
    v_cmp_u_f32 vcc, v27, v31
    s_cbranch_vccnz L_spin_126
L_go_127:
    v_pk_add_f32 v[8:9], v[24:25], v[28:29]
    v_pk_add_f32 v[10:11], v[26:27], v[30:31]
    s_nop 1
    v_permlane32_swap_b32 v8, v10
    v_permlane32_swap_b32 v9, v11
    v_add_f32 v8, v8, v10
    v_add_f32 v9, v9, v11
    s_nop 1
    v_permlane16_swap_b32 v8, v9
    v_add_f32 v8, v8, v9
    s_nop 1
    v_add_f32_dpp v8, v8, v8 row_ror:8 row_mask:0xf bank_mask:0xf
    v_add_f32 v8, v8, v4
    v_cvt_pk_bf16_f32 v9, v8, v8
    ds_write_b16 v13, v9
    v_cmp_u_f32 vcc, v8, v8
    s_cbranch_vccnz L_spin_126
    v_lshlrev_b32 v4, 16, v9
    s_waitcnt lgkmcnt(0)
    s_barrier
    ds_read_b128 v[76:79], v14
    s_waitcnt lgkmcnt(0)
    v_mfma_f32_16x16x32_bf16 v[32:35], v[76:79], v[76:79], 0
    v_mfma_f32_16x16x32_bf16 v[8:11], v[76:79], v[36:39], 0
    v_lshlrev_b32 v36, 4, v0
    v_and_b32 v37, 32, v0
    v_mfma_f32_16x16x32_bf16 v[12:15], v[76:79], v[40:43], 0
    v_lshl_add_u32 v37, v37, 26, v36
    v_mov_b32 v40, -1
    v_mfma_f32_16x16x32_bf16 v[16:19], v[76:79], v[44:47], 0
    v_mov_b32 v41, -1
    v_mov_b32 v42, -1
    v_mfma_f32_16x16x32_bf16 v[20:23], v[76:79], v[48:51], 0
    v_mov_b32 v43, -1
    v_mov_b32 v44, -1
    s_waitcnt vmcnt(0)
    v_mfma_f32_16x16x32_bf16 v[24:27], v[76:79], v[52:55], 0
    v_mov_b32 v45, -1
    v_mov_b32 v46, -1
    v_mfma_f32_16x16x32_bf16 v[28:31], v[76:79], v[56:59], 0
    v_mov_b32 v47, -1
    s_mov_b64 exec, 0xffff
    v_mov_b32_dpp v10, v32 row_newbcast:0 row_mask:0xf bank_mask:0xf
    v_mov_b32_dpp v11, v35 row_newbcast:0 row_mask:0xf bank_mask:0xf
    v_add_f32 v8, v8, v17
    v_add_f32_dpp v10, v33, v10 row_newbcast:1 row_mask:0xf bank_mask:0xf
    v_add_f32_dpp v11, v35, v11 row_newbcast:1 row_mask:0xf bank_mask:0xf
    v_add_f32 v9, v12, v21
    v_add_f32_dpp v10, v34, v10 row_newbcast:2 row_mask:0xf bank_mask:0xf
    v_add_f32_dpp v11, v35, v11 row_newbcast:2 row_mask:0xf bank_mask:0xf
    v_add_f32 v8, v8, v26
    v_add_f32 v9, v9, v30
    buffer_store_dwordx4 v[8:11], v36, s[40:43], s73 offen
    s_mov_b64 exec, -1
L_qjoin_125:
    buffer_load_dwordx4 v[40:43], v36, s[40:43], s79 offen sc1
    buffer_load_dwordx4 v[44:47], v37, s[40:43], s79 offen offset:1024 sc1
    v_and_b32 v26, 7, v0
    v_lshlrev_b32 v26, 6, v26
    v_bfe_u32 v27, v0, 3, 1
    v_lshl_add_u32 v26, v27, 11, v26
    v_lshlrev_b32 v27, 3, v0
    v_and_b32 v27, 32, v27
    v_xor_b32 v27, v0, v27
    v_and_b32 v27, 48, v27
    v_add3_u32 v26, v26, v27, s65
    ds_read_b128 v[60:63], v26 offset:16384
    ds_read_b128 v[64:67], v26 offset:16896
    ds_read_b128 v[68:71], v26 offset:17408
    ds_read_b128 v[72:75], v26 offset:17920
    v_lshrrev_b32 v22, 4, v0
    v_and_b32 v23, 1, v22
    v_lshlrev_b32 v22, 4, v22
    v_mul_u32_u24 v23, 4080, v23
    v_add_u32 v22, v23, v22
    v_and_b32 v23, 15, v0
    v_lshl_add_u32 v22, v23, 1, v22
    s_lshl_b32 s70, s3, 6
    s_add_u32 s70, s70, 154880
    v_add_u32 v22, s70, v22
    v_lshrrev_b32 v25, 4, v0
    v_lshlrev_b32 v24, 4, v25
    v_add_u32 v24, 154880, v24
    v_lshlrev_b32 v25, 3, v25
    v_and_b32 v21, 1, v0
    v_lshl_add_u32 v21, v21, 13, v25
    s_lshl_b32 s69, s61, 2
    s_add_u32 s69, s69, s3
    s_lshl_b32 s69, s69, 5
    s_and_b32 s77, s60, 6
    s_add_u32 s77, s77, s60
    s_lshl_b32 s77, s77, 12
    s_add_u32 s77, s77, 1196032
    s_add_u32 s73, s69, s77
    s_add_u32 s69, s69, s58
    s_add_u32 s69, s69, 68608
    s_sub_u32 s77, s69, s73
    s_sub_u32 s77, s77, s52
    s_mov_b32 s80, 0
L_spin_132:
    buffer_load_dwordx4 v[40:43], v36, s[40:43], s79 offen sc1
    buffer_load_dwordx4 v[44:47], v37, s[40:43], s79 offen offset:1024 sc1
    s_add_u32 s80, s80, 1024
    s_cbranch_scc1 L_abort
    s_waitcnt vmcnt(2)
    v_cmp_u_f32 vcc, v43, v47
    s_cbranch_vccnz L_spin_132
    v_pk_add_f32 v[12:13], v[40:41], v[44:45]
    v_pk_add_f32 v[14:15], v[42:43], v[46:47]
    s_nop 0
    v_permlane32_swap_b32 v12, v13
    v_permlane32_swap_b32 v14, v15
    v_add_f32 v12, v12, v13
    v_add_f32 v14, v14, v15
    s_nop 1
    v_permlane16_swap_b32 v12, v14
    v_add_f32 v12, v12, v14
    s_nop 0
    v_readlane_b32 s71, v12, 48
    v_readlane_b32 s72, v12, 16
    v_cmp_u_f32 vcc, v12, v12
    v_fma_f32 v13, -s71, v6, v12
    v_cvt_pk_bf16_f32 v13, v13, v13
    ds_write_b16 v22, v13
    s_cbranch_vccnz L_spin_132
    v_mov_b32 v14, 0x3ae38e39
    v_mul_f32 v15, s71, v14
    v_mul_f32 v14, s72, v14
    v_fma_f32 v14, -v15, v15, v14
    v_max_f32 v14, 0, v14
    v_add_f32 v14, 0x3727c5ac, v14
    v_rsq_f32 v14, v14
    s_waitcnt lgkmcnt(0)
    s_barrier
    ds_read_b128 v[28:31], v24 offset:0
    ds_read_b128 v[32:35], v24 offset:64
    ds_read_b128 v[48:51], v24 offset:128
    ds_read_b128 v[52:55], v24 offset:192
    v_mul_f32 v14, 0x3e0293ee, v14
    s_nop 0
    v_readfirstlane_b32 s81, v14
    s_waitcnt lgkmcnt(3)
    v_mfma_f32_16x16x32_bf16 v[8:11], v[60:63], v[28:31], 0
    s_waitcnt lgkmcnt(2)
    v_mfma_f32_16x16x32_bf16 v[8:11], v[64:67], v[32:35], v[8:11]
    s_waitcnt lgkmcnt(1)
    v_mfma_f32_16x16x32_bf16 v[8:11], v[68:71], v[48:51], v[8:11]
    s_waitcnt lgkmcnt(0)
    v_mfma_f32_16x16x32_bf16 v[8:11], v[72:75], v[52:55], v[8:11]
    s_mov_b32 exec_lo, 0x30003
    s_mov_b32 exec_hi, 0x30003
    s_nop 5
    v_mul_f32 v8, s81, v8
    v_mul_f32 v9, s81, v9
    v_mul_f32 v10, s81, v10
    v_mul_f32 v11, s81, v11
    v_cvt_pk_bf16_f32 v78, v8, v9
    v_cvt_pk_bf16_f32 v79, v10, v11
    buffer_store_dwordx2 v[78:79], v21, s[40:43], s73 offen sc1
    buffer_store_dwordx2 v[78:79], v25, s[40:43], s69 offen
    s_mov_b64 exec, -1
    s_barrier
    v_lshrrev_b32 v24, 4, v0
    v_bfe_u32 v25, v0, 2, 2
    v_lshl_add_u32 v24, v24, 3, v25
    v_mul_u32_u24 v24, 1152, v24
    v_bfe_u32 v25, v0, 4, 1
    v_lshlrev_b32 v25, 1, v25
    v_xor_b32 v25, v0, v25
    v_and_b32 v25, 3, v25
    v_lshl_add_u32 v24, v25, 4, v24
    v_add_u32 v24, s68, v24
    s_add_u32 m0, s65, 0
    s_add_u32 s91, s99, 0
    buffer_load_dwordx4 v24, s[36:39], s91 offen  lds
    s_add_u32 m0, s65, 1024
    s_add_u32 s91, s99, 4608
    buffer_load_dwordx4 v24, s[36:39], s91 offen  lds
    s_add_u32 m0, s65, 2048
    s_add_u32 s91, s99, 36864
    buffer_load_dwordx4 v24, s[36:39], s91 offen  lds
    s_add_u32 m0, s65, 3072
    s_add_u32 s91, s99, 41472
    buffer_load_dwordx4 v24, s[36:39], s91 offen  lds
    s_add_u32 m0, s65, 4096
    s_add_u32 s91, s99, 73728
    buffer_load_dwordx4 v24, s[36:39], s91 offen  lds
    s_add_u32 m0, s65, 5120
    s_add_u32 s91, s99, 78336
    buffer_load_dwordx4 v24, s[36:39], s91 offen  lds
    v_bfe_u32 v72, v0, 2, 3
    v_lshlrev_b32 v72, 11, v72
    v_lshrrev_b32 v73, 5, v0
    v_lshl_add_u32 v72, v73, 6, v72
    v_bfe_u32 v73, v0, 4, 1
    v_lshlrev_b32 v73, 1, v73
    v_xor_b32 v73, v0, v73
    v_and_b32 v73, 3, v73
    v_lshl_add_u32 v72, v73, 4, v72
    v_and_b32 v74, 0x2000, v72
    v_add_u32 v72, v72, v74
    v_add_u32 v74, 32768, v72
    v_bfe_u32 v75, v0, 3, 2
    s_sub_u32 s70, s60, 4
    v_cmp_eq_u32 vcc, s60, v75
    v_add_u32 v73, s77, v72
    s_nop 0
    v_cndmask_b32 v72, v72, v73, vcc
    v_cmp_eq_u32 vcc, s70, v75
    v_add_u32 v73, s77, v74
    s_nop 0
    v_cndmask_b32 v74, v74, v73, vcc
    s_mov_b32 s71, 147456
    v_and_b32 v76, 7, v0
    v_lshlrev_b32 v76, 6, v76
    v_bfe_u32 v77, v0, 3, 1
    v_lshl_add_u32 v76, v77, 11, v76
    v_lshlrev_b32 v77, 3, v0
    v_and_b32 v77, 32, v77
    v_xor_b32 v77, v0, v77
    v_and_b32 v77, 48, v77
    v_add3_u32 v76, v76, v77, s71
    s_lshl_b32 s70, s3, 12
    s_sub_u32 s70, s70, 65536
    v_add_u32 v77, s70, v76
    v_lshlrev_b32 v73, 6, v0
    v_bfe_u32 v75, v0, 1, 3
    v_lshl_add_u32 v73, v75, 2, v73
    v_add_u32 v73, s88, v73
    s_lshl_b32 s76, s86, 10
    s_lshl_b32 s70, s3, 8
    s_add_u32 s76, s76, s70
    s_add_u32 s76, s76, 1196032
    s_add_u32 s76, s76, s52
    s_mul_i32 s73, s87, 120
    s_sub_u32 s73, s1, s73
    s_and_b32 s69, s3, 1
    s_lshl_b32 s69, s69, 3
    s_lshr_b32 s71, s3, 1
    s_lshl_b32 s71, s71, 10
    s_add_u32 s69, s69, s71
    s_mov_b32 s80, 0
    s_waitcnt vmcnt(8)
    v_lshrrev_b32 v208, 5, v0
    v_lshlrev_b32 v208, 11, v208
    v_bfe_u32 v209, v0, 2, 3
    v_lshl_add_u32 v208, v209, 6, v208
    v_bfe_u32 v209, v0, 4, 1
    v_lshl_add_u32 v208, v209, 5, v208
    v_and_b32 v209, 3, v0
    v_lshl_add_u32 v208, v209, 3, v208
    v_add_u32 v208, s66, v208
    v_xor_b32 v209, 32, v208
    ds_read_b64_tr_b16 v[144:145], v208 offset:0
    ds_read_b64_tr_b16 v[146:147], v208 offset:4096
    ds_read_b64_tr_b16 v[148:149], v209 offset:0
    ds_read_b64_tr_b16 v[150:151], v209 offset:4096
    ds_read_b64_tr_b16 v[152:153], v208 offset:8192
    ds_read_b64_tr_b16 v[154:155], v208 offset:12288
    ds_read_b64_tr_b16 v[156:157], v209 offset:8192
    ds_read_b64_tr_b16 v[158:159], v209 offset:12288
    ds_read_b64_tr_b16 v[160:161], v208 offset:512
    ds_read_b64_tr_b16 v[162:163], v208 offset:4608
    ds_read_b64_tr_b16 v[164:165], v209 offset:512
    ds_read_b64_tr_b16 v[166:167], v209 offset:4608
    ds_read_b64_tr_b16 v[168:169], v208 offset:8704
    ds_read_b64_tr_b16 v[170:171], v208 offset:12800
    ds_read_b64_tr_b16 v[172:173], v209 offset:8704
    ds_read_b64_tr_b16 v[174:175], v209 offset:12800
    ds_read_b64_tr_b16 v[176:177], v208 offset:1024
    ds_read_b64_tr_b16 v[178:179], v208 offset:5120
    ds_read_b64_tr_b16 v[180:181], v209 offset:1024
    ds_read_b64_tr_b16 v[182:183], v209 offset:5120
    ds_read_b64_tr_b16 v[184:185], v208 offset:9216
    ds_read_b64_tr_b16 v[186:187], v208 offset:13312
    ds_read_b64_tr_b16 v[188:189], v209 offset:9216
    ds_read_b64_tr_b16 v[190:191], v209 offset:13312
    ds_read_b64_tr_b16 v[192:193], v208 offset:1536
    ds_read_b64_tr_b16 v[194:195], v208 offset:5632
    ds_read_b64_tr_b16 v[196:197], v209 offset:1536
    ds_read_b64_tr_b16 v[198:199], v209 offset:5632
    ds_read_b64_tr_b16 v[200:201], v208 offset:9728
    ds_read_b64_tr_b16 v[202:203], v208 offset:13824
    ds_read_b64_tr_b16 v[204:205], v209 offset:9728
    ds_read_b64_tr_b16 v[206:207], v209 offset:13824
    s_add_u32 m0, s88, 0
    s_nop 0
    buffer_load_dwordx4 v72, s[40:43], s76 offen offset:0 sc1 lds
    s_add_u32 m0, s88, 896
    s_nop 0
    buffer_load_dwordx4 v72, s[40:43], s76 offen offset:128 sc1 lds
    s_add_u32 m0, s88, 2048
    s_nop 0
    buffer_load_dwordx4 v74, s[40:43], s76 offen offset:0 sc1 lds
    s_add_u32 m0, s88, 2944
    s_nop 0
    buffer_load_dwordx4 v74, s[40:43], s76 offen offset:128 sc1 lds
    ds_read_b128 v[80:83], v77 offset:0
    ds_read_b128 v[84:87], v77 offset:512
    ds_read_b128 v[88:91], v77 offset:1024
    ds_read_b128 v[92:95], v77 offset:1536
    ds_read_b128 v[96:99], v77 offset:16384
    ds_read_b128 v[100:103], v77 offset:16896
    ds_read_b128 v[104:107], v77 offset:17408
    ds_read_b128 v[108:111], v77 offset:17920
    ds_read_b128 v[112:115], v77 offset:32768
    ds_read_b128 v[116:119], v77 offset:33280
    ds_read_b128 v[120:123], v77 offset:33792
    ds_read_b128 v[124:127], v77 offset:34304
    ds_read_b128 v[128:131], v77 offset:49152
    ds_read_b128 v[132:135], v77 offset:49664
    ds_read_b128 v[136:139], v77 offset:50176
    ds_read_b128 v[140:143], v77 offset:50688
    s_branch L_qaa_136x
L_qaa_136:
    s_and_b32 s70, vcc_lo, 0xffff
    s_cbranch_scc0 L_qaa_136s0
    s_add_u32 m0, s88, 0
    s_nop 0
    buffer_load_dwordx4 v72, s[40:43], s76 offen offset:0 sc1 lds
L_qaa_136s0:
    s_and_b32 s70, vcc_lo, 0xffff0000
    s_cbranch_scc0 L_qaa_136s1
    s_add_u32 m0, s88, 896
    s_nop 0
    buffer_load_dwordx4 v72, s[40:43], s76 offen offset:128 sc1 lds
L_qaa_136s1:
    s_and_b32 s70, vcc_hi, 0xffff
    s_cbranch_scc0 L_qaa_136s2
    s_add_u32 m0, s88, 2048
    s_nop 0
    buffer_load_dwordx4 v74, s[40:43], s76 offen offset:0 sc1 lds
L_qaa_136s2:
    s_and_b32 s70, vcc_hi, 0xffff0000
    s_cbranch_scc0 L_qaa_136s3
    s_add_u32 m0, s88, 2944
    s_nop 0
    buffer_load_dwordx4 v74, s[40:43], s76 offen offset:128 sc1 lds
L_qaa_136s3:
L_qaa_136x:
    s_waitcnt vmcnt(0)
    ds_read2_b32 v[78:79], v73 offset0:0 offset1:8
    s_add_u32 s80, s80, 4096
    s_cbranch_scc1 L_abort
    s_waitcnt lgkmcnt(0)
    v_cmp_u_f32 vcc, v78, v79
    s_cbranch_vccnz L_qaa_136
    s_barrier
    ds_read_b128 v[8:11], v76 offset:0
    ds_read_b128 v[12:15], v76 offset:512
    ds_read_b128 v[16:19], v76 offset:1024
    ds_read_b128 v[20:23], v76 offset:1536
    ds_read_b128 v[24:27], v76 offset:4096
    s_waitcnt lgkmcnt(4)
    v_mfma_f32_16x16x32_bf16 v[72:75], v[80:83], v[8:11], 0
    ds_read_b128 v[28:31], v76 offset:4608
    s_waitcnt lgkmcnt(4)
    v_mfma_f32_16x16x32_bf16 v[72:75], v[84:87], v[12:15], v[72:75]
    ds_read_b128 v[32:35], v76 offset:5120
    s_waitcnt lgkmcnt(4)
    v_mfma_f32_16x16x32_bf16 v[72:75], v[88:91], v[16:19], v[72:75]
    ds_read_b128 v[36:39], v76 offset:5632
    s_waitcnt lgkmcnt(4)
    v_mfma_f32_16x16x32_bf16 v[72:75], v[92:95], v[20:23], v[72:75]
    ds_read_b128 v[40:43], v76 offset:8192
    s_waitcnt lgkmcnt(4)
    v_mfma_f32_16x16x32_bf16 v[72:75], v[96:99], v[24:27], v[72:75]
    ds_read_b128 v[44:47], v76 offset:8704
    s_waitcnt lgkmcnt(4)
    v_mfma_f32_16x16x32_bf16 v[72:75], v[100:103], v[28:31], v[72:75]
    ds_read_b128 v[48:51], v76 offset:9216
    s_waitcnt lgkmcnt(4)
    v_mfma_f32_16x16x32_bf16 v[72:75], v[104:107], v[32:35], v[72:75]
    ds_read_b128 v[52:55], v76 offset:9728
    s_waitcnt lgkmcnt(4)
    v_mfma_f32_16x16x32_bf16 v[72:75], v[108:111], v[36:39], v[72:75]
    ds_read_b128 v[56:59], v76 offset:12288
    s_waitcnt lgkmcnt(4)
    v_mfma_f32_16x16x32_bf16 v[72:75], v[112:115], v[40:43], v[72:75]
    ds_read_b128 v[60:63], v76 offset:12800
    v_and_b32 v79, 15, v0
    s_waitcnt lgkmcnt(4)
    v_mfma_f32_16x16x32_bf16 v[72:75], v[116:119], v[44:47], v[72:75]
    ds_read_b128 v[64:67], v76 offset:13312
    v_lshlrev_b32 v79, 4, v79
    s_waitcnt lgkmcnt(4)
    v_mfma_f32_16x16x32_bf16 v[72:75], v[120:123], v[48:51], v[72:75]
    ds_read_b128 v[68:71], v76 offset:13824
    v_add_u32 v79, 147456, v79
    s_waitcnt lgkmcnt(4)
    v_mfma_f32_16x16x32_bf16 v[72:75], v[124:127], v[52:55], v[72:75]
    s_waitcnt lgkmcnt(3)
    v_mfma_f32_16x16x32_bf16 v[72:75], v[128:131], v[56:59], v[72:75]
    s_waitcnt lgkmcnt(2)
    v_mfma_f32_16x16x32_bf16 v[72:75], v[132:135], v[60:63], v[72:75]
    s_waitcnt lgkmcnt(1)
    v_mfma_f32_16x16x32_bf16 v[72:75], v[136:139], v[64:67], v[72:75]
    s_waitcnt lgkmcnt(0)
    s_waitcnt vmcnt(0)
    s_barrier
    v_mfma_f32_16x16x32_bf16 v[72:75], v[140:143], v[68:71], v[72:75]
    v_lshl_add_u32 v40, s3, 2, v79
    v_lshlrev_b32 v43, 4, v0
    v_add_u32 v43, 147456, v43
    v_add_u32 v42, s69, v43
    s_nop 3
    v_max3_f32 v78, v72, v73, v74
    v_max_f32 v78, v78, v75
    v_mov_b32 v41, v78
    s_nop 1
    v_permlane16_swap_b32 v78, v41
    v_max_f32 v78, v78, v41
    v_mov_b32 v41, v78
    s_nop 1
    v_permlane32_swap_b32 v78, v41
    v_max_f32 v78, v78, v41
    ds_write_b32 v40, v78
    v_lshl_add_u32 v40, s3, 2, v43
    s_waitcnt lgkmcnt(0)
    s_barrier
    ds_read_b128 v[44:47], v79
    s_waitcnt lgkmcnt(0)
    v_max3_f32 v78, v44, v45, v46
    v_max_f32 v78, v78, v47
    v_ceil_f32 v78, v78
    v_sub_f32 v72, v72, v78
    v_sub_f32 v73, v73, v78
    v_exp_f32 v72, v72
    v_pk_add_f32 v[46:47], v[44:45], v[46:47]
    v_exp_f32 v73, v73
    v_cmp_u_f32 vcc, v46, v47
    v_sub_f32 v74, v74, v78
    v_sub_f32 v75, v75, v78
    v_exp_f32 v74, v74
    v_exp_f32 v75, v75
    s_cbranch_vccnz L_redo_137
    v_cvt_pk_bf16_f32 v44, v72, v73
    v_cvt_pk_bf16_f32 v45, v74, v75
    ds_write_b64 v42, v[44:45] offset:1024
    v_pk_add_f32 v[72:73], v[72:73], v[74:75]
    v_add_f32 v72, v72, v73
    ds_write_b32 v40, v72 offset:3072
    s_waitcnt lgkmcnt(0)
    s_barrier
    ds_read_b128 v[8:11], v43 offset:1024
    ds_read_b128 v[12:15], v43 offset:2048
    ds_read_b128 v[72:75], v43 offset:3072
    s_waitcnt lgkmcnt(2)
    v_mfma_f32_16x16x32_bf16 v[40:43], v[8:11], v[144:147], 0
    v_mfma_f32_16x16x32_bf16 v[44:47], v[8:11], v[148:151], 0
    s_waitcnt lgkmcnt(0)
    v_mfma_f32_16x16x32_bf16 v[40:43], v[12:15], v[152:155], v[40:43]
    v_pk_add_f32 v[72:73], v[72:73], v[74:75]
    v_and_b32 v74, 15, v0
    v_add_f32 v79, v72, v73
    v_mfma_f32_16x16x32_bf16 v[44:47], v[12:15], v[156:159], v[44:47]
    v_lshlrev_b32 v75, 7, v74
    v_mov_b32 v72, v79
    v_lshlrev_b32 v74, 3, v74
    v_mfma_f32_16x16x32_bf16 v[48:51], v[8:11], v[160:163], 0
    v_lshrrev_b32 v73, 4, v0
    v_permlane16_swap_b32 v79, v72
    v_add_f32 v79, v79, v72
    v_mfma_f32_16x16x32_bf16 v[52:55], v[8:11], v[164:167], 0
    v_lshl_add_u32 v74, v73, 12, v74
    v_mov_b32 v72, v79
    v_lshl_add_u32 v75, v73, 28, v75
    v_mfma_f32_16x16x32_bf16 v[48:51], v[12:15], v[168:171], v[48:51]
    v_add_u32 v75, s89, v75
    v_mfma_f32_16x16x32_bf16 v[52:55], v[12:15], v[172:175], v[52:55]
    v_permlane32_swap_b32 v79, v72
    v_mfma_f32_16x16x32_bf16 v[56:59], v[8:11], v[176:179], 0
    v_add_f32 v79, v79, v72
    v_mfma_f32_16x16x32_bf16 v[60:63], v[8:11], v[180:183], 0
    v_and_b32 v72, 32, v0
    v_lshl_add_u32 v74, v72, 8, v74
    v_mfma_f32_16x16x32_bf16 v[56:59], v[12:15], v[184:187], v[56:59]
    v_cvt_pk_bf16_f32 v44, v40, v44
    v_cvt_pk_bf16_f32 v40, v41, v45
    v_mfma_f32_16x16x32_bf16 v[60:63], v[12:15], v[188:191], v[60:63]
    v_cvt_pk_bf16_f32 v45, v48, v52
    buffer_store_dwordx2 v[44:45], v74, s[40:43], s47 offen offset:0
    v_mfma_f32_16x16x32_bf16 v[64:67], v[8:11], v[192:195], 0
    buffer_store_dwordx2 v[78:79], v75, s[40:43], s73 offen
    v_cvt_pk_bf16_f32 v41, v49, v53
    buffer_store_dwordx2 v[40:41], v74, s[40:43], s47 offen offset:1024
    v_mfma_f32_16x16x32_bf16 v[68:71], v[8:11], v[196:199], 0
    v_cvt_pk_bf16_f32 v46, v42, v46
    v_cvt_pk_bf16_f32 v42, v43, v47
    v_mfma_f32_16x16x32_bf16 v[64:67], v[12:15], v[200:203], v[64:67]
    v_cvt_pk_bf16_f32 v47, v50, v54
    buffer_store_dwordx2 v[46:47], v74, s[40:43], s47 offen offset:2048
    v_mfma_f32_16x16x32_bf16 v[68:71], v[12:15], v[204:207], v[68:71]
    v_cvt_pk_bf16_f32 v43, v51, v55
    buffer_store_dwordx2 v[42:43], v74, s[40:43], s47 offen offset:3072
    v_cvt_pk_bf16_f32 v60, v56, v60
    v_cvt_pk_bf16_f32 v56, v57, v61
    v_cvt_pk_bf16_f32 v62, v58, v62
    v_cvt_pk_bf16_f32 v58, v59, v63
    v_and_b32 v72, 3, v0
    v_lshlrev_b32 v72, 3, v72
    v_cvt_pk_bf16_f32 v61, v64, v68
    buffer_store_dwordx2 v[60:61], v74, s[40:43], s47 offen offset:128
    v_cvt_pk_bf16_f32 v57, v65, v69
    buffer_store_dwordx2 v[56:57], v74, s[40:43], s47 offen offset:1152
    v_cvt_pk_bf16_f32 v63, v66, v70
    buffer_store_dwordx2 v[62:63], v74, s[40:43], s47 offen offset:2176
    v_cvt_pk_bf16_f32 v59, v67, v71
    buffer_store_dwordx2 v[58:59], v74, s[40:43], s47 offen offset:3200
    v_lshl_add_u32 v73, v73, 5, v72
    v_mov_b32 v32, -1
    v_mov_b32 v33, -1
    buffer_load_dwordx2 v[32:33], v73, s[40:43], s1 offen sc1
    v_lshrrev_b32 v77, 4, v0
    v_and_b32 v76, 15, v0
    v_lshlrev_b32 v72, 4, v76
    v_lshl_add_u32 v72, v77, 17, v72
    s_add_u32 s95, s0, 32768
    s_add_u32 s96, s0, 65536
    s_add_u32 s97, s0, 98304
    v_and_b32 v78, 1, v76
    v_lshlrev_b32 v78, 4, v78
    v_mov_b32 v79, 0xffff
    v_lshlrev_b32 v78, v78, v79
    v_lshrrev_b32 v79, 1, v76
    v_cmp_eq_u32 vcc, 0, v79
    s_nop 1
    v_cndmask_b32 v64, 0, v78, vcc
    v_cmp_eq_u32 vcc, 1, v79
    s_nop 1
    v_cndmask_b32 v65, 0, v78, vcc
    v_cmp_eq_u32 vcc, 2, v79
    s_nop 1
    v_cndmask_b32 v66, 0, v78, vcc
    v_cmp_eq_u32 vcc, 3, v79
    s_nop 1
    v_cndmask_b32 v67, 0, v78, vcc
    s_lshl_b32 s71, s87, 1
    s_add_u32 s71, s71, s86
    s_and_b32 s72, s71, 15
    s_lshl_b32 s73, s72, 14
    s_lshl_b32 s70, s3, 11
    s_add_u32 s73, s73, s70
    s_and_b32 s70, s71, 8
    s_add_u32 s72, s72, s70
    s_lshl_b32 s72, s72, 10
    s_lshl_b32 s70, s55, 7
    s_add_u32 s70, s70, s54
    s_add_u32 s73, s73, s70
    s_add_u32 s73, s73, 1261568
    s_add_u32 s72, s72, s70
    s_add_u32 s72, s72, 1523712
    s_mov_b32 s74, 10
    s_and_b32 s70, s71, 3
    s_lshl_b32 s76, s70, 2
    s_add_u32 s76, s76, s3
    s_lshl_b32 s76, s76, 8
    s_add_u32 s76, s76, s58
    s_add_u32 s76, s76, 76800
    s_lshl_b32 s77, s70, 7
    s_add_u32 s77, s77, s58
    s_add_u32 s77, s77, 81408
    s_lshr_b32 s69, s71, 2
    s_cmp_eq_u32 s69, s60
    s_cselect_b32 s73, s76, s73
    s_cselect_b32 s72, s77, s72
    s_cselect_b32 s74, 7, s74
    v_and_b32 v74, 7, v0
    v_lshlrev_b32 v74, 4, v74
    v_lshl_add_u32 v74, v77, 3, v74
    v_bfe_u32 v75, v0, 3, 1
    v_lshl_add_u32 v74, v75, s74, v74
    v_and_b32 v75, 32, v0
    v_lshl_add_u32 v74, v75, 26, v74
    v_mov_b32 v75, 1073741824
    v_writelane_b32 v75, s89, 0
    s_mov_b32 s80, 0
L_spin_138:
    buffer_load_dwordx2 v[32:33], v73, s[40:43], s1 offen sc1
    s_add_u32 s80, s80, 1024
    s_cbranch_scc1 L_abort
    s_waitcnt vmcnt(1)
    v_cmp_u_f32 vcc, v32, v33
    s_cbranch_vccnz L_spin_138
    v_max_f32_dpp v44, v32, v32 quad_perm:[1,0,3,2] row_mask:0xf bank_mask:0xf
    s_nop 1
    v_max_f32_dpp v44, v44, v44 quad_perm:[2,3,0,1] row_mask:0xf bank_mask:0xf
    v_mov_b32 v45, v44
    s_nop 1
    v_permlane16_swap_b32 v44, v45
    v_max_f32 v44, v44, v45
    v_mov_b32 v45, v44
    s_nop 1
    v_permlane32_swap_b32 v44, v45
    v_max_f32 v44, v44, v45
    v_sub_f32 v40, v32, v44
    v_exp_f32 v40, v40
    s_nop 0
    v_cvt_pk_bf16_f32 v42, v40, v40
    v_mul_f32 v45, v40, v33
    buffer_load_dwordx4 v[8:11], v72, s[40:43], s0 offen sc1
    buffer_load_dwordx4 v[12:15], v72, s[40:43], s95 offen sc1
    buffer_load_dwordx4 v[16:19], v72, s[40:43], s96 offen sc1
    buffer_load_dwordx4 v[20:23], v72, s[40:43], s97 offen sc1
    v_and_b32_dpp v48, v42, v64 quad_perm:[0,0,0,0] row_mask:0xf bank_mask:0xf
    v_and_b32_dpp v49, v42, v65 quad_perm:[0,0,0,0] row_mask:0xf bank_mask:0xf
    v_and_b32_dpp v50, v42, v66 quad_perm:[0,0,0,0] row_mask:0xf bank_mask:0xf
    v_add_f32_dpp v45, v45, v45 quad_perm:[1,0,3,2] row_mask:0xf bank_mask:0xf
    v_and_b32_dpp v51, v42, v67 quad_perm:[0,0,0,0] row_mask:0xf bank_mask:0xf
    s_nop 0
    v_add_f32_dpp v45, v45, v45 quad_perm:[2,3,0,1] row_mask:0xf bank_mask:0xf
    v_and_b32_dpp v52, v42, v64 quad_perm:[1,1,1,1] row_mask:0xf bank_mask:0xf
    v_mov_b32 v46, v45
    v_and_b32_dpp v53, v42, v65 quad_perm:[1,1,1,1] row_mask:0xf bank_mask:0xf
    s_nop 0
    v_permlane16_swap_b32 v45, v46
    v_and_b32_dpp v54, v42, v66 quad_perm:[1,1,1,1] row_mask:0xf bank_mask:0xf
    v_add_f32 v45, v45, v46
    v_and_b32_dpp v55, v42, v67 quad_perm:[1,1,1,1] row_mask:0xf bank_mask:0xf
    v_mov_b32 v46, v45
    v_and_b32_dpp v56, v42, v64 quad_perm:[2,2,2,2] row_mask:0xf bank_mask:0xf
    s_nop 0
    v_permlane32_swap_b32 v45, v46
    v_and_b32_dpp v57, v42, v65 quad_perm:[2,2,2,2] row_mask:0xf bank_mask:0xf
    v_add_f32 v45, v45, v46
    v_and_b32_dpp v58, v42, v66 quad_perm:[2,2,2,2] row_mask:0xf bank_mask:0xf
    v_and_b32_dpp v59, v42, v67 quad_perm:[2,2,2,2] row_mask:0xf bank_mask:0xf
    s_cmp_eq_u32 s69, s60
    s_cbranch_scc1 L_loc_141
    buffer_store_dwordx2 v[44:45], v75, s[40:43], s72 offen sc1
    s_branch L_loc_141x
L_loc_141:
    buffer_store_dwordx2 v[44:45], v75, s[40:43], s72 offen
L_loc_141x:
    v_and_b32_dpp v60, v42, v64 quad_perm:[3,3,3,3] row_mask:0xf bank_mask:0xf
    v_and_b32_dpp v61, v42, v65 quad_perm:[3,3,3,3] row_mask:0xf bank_mask:0xf
    v_and_b32_dpp v62, v42, v66 quad_perm:[3,3,3,3] row_mask:0xf bank_mask:0xf
    v_and_b32_dpp v63, v42, v67 quad_perm:[3,3,3,3] row_mask:0xf bank_mask:0xf
    s_mov_b32 s80, 0
L_paw_142:
    s_waitcnt vmcnt(4)
    v_mfma_f32_16x16x32_bf16 v[68:71], v[48:51], v[8:11], 0
    s_waitcnt vmcnt(3)
    v_mfma_f32_16x16x32_bf16 v[68:71], v[52:55], v[12:15], v[68:71]
    s_waitcnt vmcnt(2)
    v_mfma_f32_16x16x32_bf16 v[68:71], v[56:59], v[16:19], v[68:71]
    s_waitcnt vmcnt(1)
    v_mfma_f32_16x16x32_bf16 v[68:71], v[60:63], v[20:23], v[68:71]
    s_nop 7
    v_cmp_u_f32 vcc, v68, v68
    v_cvt_pk_bf16_f32 v46, v68, v69
    v_cvt_pk_bf16_f32 v47, v70, v71
    s_cbranch_vccnz L_retry_143
    s_cmp_eq_u32 s69, s60
    s_cbranch_scc1 L_loc_144
    buffer_store_dwordx2 v[46:47], v74, s[40:43], s73 offen sc1
    s_branch L_loc_144x
L_loc_144:
    buffer_store_dwordx2 v[46:47], v74, s[40:43], s73 offen
L_loc_144x:
    v_bfe_u32 v76, v0, 2, 3
    v_lshlrev_b32 v76, 7, v76
    v_lshrrev_b32 v77, 5, v0
    v_lshl_add_u32 v76, v77, 6, v76
    v_bfe_u32 v77, v0, 4, 1
    v_lshlrev_b32 v77, 1, v77
    v_xor_b32 v77, v0, v77
    v_and_b32 v77, 3, v77
    v_lshl_add_u32 v76, v77, 4, v76
    v_bfe_u32 v78, v0, 2, 3
    v_lshlrev_b32 v77, 7, v78
    s_and_b32 s77, s62, 15
    s_lshl_b32 s76, s77, 4
    s_add_u32 s76, s76, s63
    s_lshl_b32 s76, s76, 10
    s_add_u32 s76, s76, s53
    s_add_u32 s76, s76, 1261568
    s_and_b32 s70, s62, 8
    s_add_u32 s77, s77, s70
    s_lshl_b32 s77, s77, 10
    s_add_u32 s77, s77, s53
    s_add_u32 s77, s77, 1523712
    s_sub_u32 s70, s61, s55
    s_lshl_b32 s70, s70, 7
    s_add_u32 s70, s70, s58
    s_add_u32 s70, s70, 76800
    s_sub_u32 s70, s70, s76
    s_lshr_b32 s71, s61, 3
    s_sub_u32 s71, s71, s55
    s_lshl_b32 s71, s71, 7
    s_add_u32 s71, s71, s58
    s_add_u32 s71, s71, 81408
    s_sub_u32 s71, s71, s77
    v_cmp_eq_u32 vcc, s55, v78
    v_add_u32 v79, s70, v76
    s_nop 0
    v_cndmask_b32 v76, v76, v79, vcc
    v_cmp_eq_u32 vcc, s55, v78
    v_add_u32 v79, s71, v77
    s_nop 0
    v_cndmask_b32 v77, v77, v79, vcc
    v_mov_b32 v64, -1
    v_mov_b32 v65, -1
    v_mov_b32 v66, -1
    v_mov_b32 v67, -1
    v_mov_b32 v68, -1
    v_mov_b32 v69, -1
    s_barrier
    v_lshrrev_b32 v8, 4, v0
    v_bfe_u32 v9, v0, 2, 2
    v_lshlrev_b32 v8, 1, v8
    v_lshl_add_u32 v8, v9, 4, v8
    v_mul_u32_u24 v8, 8192, v8
    v_bfe_u32 v9, v0, 4, 1
    v_lshlrev_b32 v9, 1, v9
    v_xor_b32 v9, v0, v9
    v_and_b32 v9, 3, v9
    v_lshl_add_u32 v8, v9, 4, v8
    s_lshl_b32 s90, s63, 18
    s_sub_u32 s90, s98, s90
    s_add_u32 m0, s88, 0
    s_add_u32 s91, s90, 0
    buffer_load_dwordx4 v8, s[32:35], s91 offen  lds
    s_add_u32 m0, s88, 1024
    s_add_u32 s91, s90, 8192
    buffer_load_dwordx4 v8, s[32:35], s91 offen  lds
    s_add_u32 m0, s88, 2048
    s_add_u32 s91, s90, 65536
    buffer_load_dwordx4 v8, s[32:35], s91 offen  lds
    s_add_u32 m0, s88, 3072
    s_add_u32 s91, s90, 73728
    buffer_load_dwordx4 v8, s[32:35], s91 offen  lds
    v_lshrrev_b32 v8, 4, v0
    v_bfe_u32 v9, v0, 2, 2
    v_lshl_add_u32 v8, v8, 3, v9
    v_mul_u32_u24 v8, 1152, v8
    v_bfe_u32 v9, v0, 4, 1
    v_lshlrev_b32 v9, 1, v9
    v_xor_b32 v9, v0, v9
    v_and_b32 v9, 3, v9
    v_lshl_add_u32 v8, v9, 4, v8
    v_add_u32 v8, s68, v8
    s_add_u32 m0, s65, 6144
    s_add_u32 s91, s99, 110592
    buffer_load_dwordx4 v8, s[36:39], s91 offen  lds
    s_add_u32 m0, s65, 7168
    s_add_u32 s91, s99, 115200
    buffer_load_dwordx4 v8, s[36:39], s91 offen  lds
    buffer_load_dwordx2 v[68:69], v77, s[40:43], s77 offen sc1
    buffer_load_dwordx4 v[64:67], v76, s[40:43], s76 offen sc1
    v_and_b32 v74, 7, v0
    v_lshlrev_b32 v74, 6, v74
    v_lshlrev_b32 v75, 3, v0
    v_and_b32 v75, 32, v75
    v_xor_b32 v75, v0, v75
    v_and_b32 v75, 48, v75
    v_add3_u32 v74, v74, v75, s88
    v_lshrrev_b32 v78, 3, v0
    v_and_b32 v79, 7, v0
    v_lshlrev_b32 v79, 1, v79
    v_lshl_add_u32 v78, v78, 7, v79
    s_lshl_b32 s70, s3, 9
    s_add_u32 s73, s45, s70
    s_add_u32 s73, s73, 41984
    s_sub_u32 s70, s88, s65
    v_add_u32 v70, s70, v2
    v_add_u32 v71, s70, v7
    v_lshl_add_u32 v75, v0, 4, s88
    v_and_b32 v32, 7, v0
    v_lshlrev_b32 v32, 4, v32
    v_bfe_u32 v33, v0, 3, 1
    v_lshl_add_u32 v32, v33, 9, v32
    v_lshrrev_b32 v33, 4, v0
    v_lshl_add_u32 v32, v33, 7, v32
    s_add_u32 s79, s46, 41984
    v_mov_b32 v24, -1
    v_mov_b32 v25, -1
    v_mov_b32 v26, -1
    v_mov_b32 v27, -1
    v_mov_b32 v28, -1
    v_mov_b32 v29, -1
    v_mov_b32 v30, -1
    v_mov_b32 v31, -1
    s_waitcnt vmcnt(4)
    ds_read_b64_tr_b16 v[40:41], v70 offset:0
    ds_read_b64_tr_b16 v[42:43], v70 offset:1024
    ds_read_b64_tr_b16 v[44:45], v71 offset:0
    ds_read_b64_tr_b16 v[46:47], v71 offset:1024
    ds_read_b64_tr_b16 v[48:49], v70 offset:2048
    ds_read_b64_tr_b16 v[50:51], v70 offset:3072
    ds_read_b64_tr_b16 v[52:53], v71 offset:2048
    ds_read_b64_tr_b16 v[54:55], v71 offset:3072
    s_mov_b32 s80, 0
    v_cmp_u_f32 vcc, v68, v69
    s_cbranch_vccz L_go_146
    s_branch L_chk_147
L_spin_145:
    s_waitcnt vmcnt(16)
    buffer_load_dwordx2 v[68:69], v77, s[40:43], s77 offen sc1
    buffer_load_dwordx4 v[64:67], v76, s[40:43], s76 offen sc1
    s_add_u32 s80, s80, 1024
    s_cbranch_scc1 L_abort
L_chk_147:
    v_cmp_u_f32 vcc, v68, v69
    s_cbranch_vccz L_go_146
    v_cmp_u_f32 vcc, v68, v69
    s_cbranch_vccz L_go_146
    v_cmp_u_f32 vcc, v68, v69
    s_cbranch_vccz L_go_146
    v_cmp_u_f32 vcc, v68, v69
    s_cbranch_vccz L_go_146
    v_cmp_u_f32 vcc, v68, v69
    s_cbranch_vccz L_go_146
    v_cmp_u_f32 vcc, v68, v69
    s_cbranch_vccz L_go_146
    v_cmp_u_f32 vcc, v68, v69
    s_cbranch_vccz L_go_146
    v_cmp_u_f32 vcc, v68, v69
    s_cbranch_vccz L_go_146
    v_cmp_u_f32 vcc, v68, v69
    s_cbranch_vccz L_go_146
    v_cmp_u_f32 vcc, v68, v69
    s_cbranch_vccnz L_spin_145
L_go_146:
    s_mov_b32 s80, 0
    v_cmp_u_f32 vcc, v64, v67
    s_cbranch_vccz L_go_149
    s_branch L_chk_150
L_spin_148:
    s_waitcnt vmcnt(8)
    buffer_load_dwordx4 v[64:67], v76, s[40:43], s76 offen sc1
    s_add_u32 s80, s80, 1024
    s_cbranch_scc1 L_abort
L_chk_150:
    v_cmp_u_f32 vcc, v64, v67
    s_cbranch_vccz L_go_149
    v_cmp_u_f32 vcc, v64, v67
    s_cbranch_vccz L_go_149
    v_cmp_u_f32 vcc, v64, v67
    s_cbranch_vccz L_go_149
    v_cmp_u_f32 vcc, v64, v67
    s_cbranch_vccz L_go_149
    v_cmp_u_f32 vcc, v64, v67
    s_cbranch_vccz L_go_149
    v_cmp_u_f32 vcc, v64, v67
    s_cbranch_vccz L_go_149
    v_cmp_u_f32 vcc, v64, v67
    s_cbranch_vccz L_go_149
    v_cmp_u_f32 vcc, v64, v67
    s_cbranch_vccz L_go_149
    v_cmp_u_f32 vcc, v64, v67
    s_cbranch_vccz L_go_149
    v_cmp_u_f32 vcc, v64, v67
    s_cbranch_vccnz L_spin_148
L_go_149:
    ds_write_b128 v75, v[64:67]
    ds_read_b128 v[16:19], v74
    ds_read_b128 v[20:23], v74 offset:512
    v_max_f32_dpp v12, v68, v68 row_ror:4 row_mask:0xf bank_mask:0xf
    s_nop 1
    v_max_f32_dpp v12, v12, v12 row_ror:8 row_mask:0xf bank_mask:0xf
    v_mov_b32 v13, v12
    s_nop 1
    v_permlane16_swap_b32 v12, v13
    v_max_f32 v12, v12, v13
    v_sub_f32 v12, v68, v12
    v_exp_f32 v12, v12
    s_nop 0
    v_mul_f32 v13, v12, v69
    v_mov_b32_dpp v8, v12 row_newbcast:0 row_mask:0xf bank_mask:0xf
    v_mov_b32_dpp v9, v12 row_newbcast:4 row_mask:0xf bank_mask:0xf
    v_mov_b32_dpp v10, v12 row_newbcast:8 row_mask:0xf bank_mask:0xf
    v_mov_b32_dpp v11, v12 row_newbcast:12 row_mask:0xf bank_mask:0xf
    s_waitcnt lgkmcnt(0)
    v_mfma_f32_16x16x32_bf16 v[56:59], v[16:19], v[40:43], 0
    v_add_f32_dpp v13, v13, v13 row_ror:4 row_mask:0xf bank_mask:0xf
    v_mfma_f32_16x16x32_bf16 v[60:63], v[16:19], v[44:47], 0
    s_nop 0
    v_add_f32_dpp v13, v13, v13 row_ror:8 row_mask:0xf bank_mask:0xf
    v_mfma_f32_16x16x32_bf16 v[56:59], v[20:23], v[48:51], v[56:59]
    v_mov_b32 v12, v13
    v_mfma_f32_16x16x32_bf16 v[60:63], v[20:23], v[52:55], v[60:63]
    s_nop 0
    v_permlane16_swap_b32 v13, v12
    v_add_f32 v13, v13, v12
    v_rcp_f32 v13, v13
    s_nop 0
    v_pk_mul_f32 v[36:37], v[8:9], v[12:13] op_sel:[0,1]
    v_pk_mul_f32 v[38:39], v[10:11], v[12:13] op_sel:[0,1]
    v_pk_mul_f32 v[56:57], v[56:57], v[36:37]
    v_pk_mul_f32 v[60:61], v[60:61], v[36:37]
    v_pk_fma_f32 v[56:57], v[58:59], v[38:39], v[56:57]
    v_pk_fma_f32 v[60:61], v[62:63], v[38:39], v[60:61]
    v_add_f32 v14, v56, v57
    v_add_f32 v15, v60, v61
    s_nop 1
    v_permlane16_swap_b32 v14, v15
    v_add_f32 v14, v14, v15
    v_cmp_u_f32 vcc, v14, v14
    s_cbranch_vccnz L_spin_148
    v_mov_b32_dpp v15, v14 quad_perm:[1,1,3,3] row_mask:0xf bank_mask:0xf
    s_mov_b64 exec, 0x55555555
    v_cvt_pk_bf16_f32 v15, v14, v15
    buffer_store_dword v15, v78, s[40:43], s73 offen
    s_mov_b64 exec, -1
    s_cmp_ge_u32 s61, 18
    s_cbranch_scc1 L_idle_151
    buffer_load_dwordx4 v[24:27], v32, s[40:43], s79 offen offset:0 sc1
    buffer_load_dwordx4 v[28:31], v32, s[40:43], s79 offen offset:1024 sc1
    s_waitcnt vmcnt(3)
    ds_read_b64_tr_b16 v[40:41], v2 offset:0
    s_add_u32 s70, s88, 3584
    v_lshl_add_u32 v78, v0, 2, s70
    ds_read_b64_tr_b16 v[42:43], v2 offset:1024
    s_mov_b32 s71, 151040
    v_and_b32 v74, 7, v0
    ds_read_b64_tr_b16 v[44:45], v7 offset:0
    v_lshlrev_b32 v74, 4, v74
    v_bfe_u32 v79, v0, 2, 1
    ds_read_b64_tr_b16 v[46:47], v7 offset:1024
    v_lshl_add_u32 v79, v79, 7, v74
    v_bfe_u32 v75, v0, 4, 1
    ds_read_b64_tr_b16 v[48:49], v2 offset:2048
    v_lshl_add_u32 v75, v75, 13, v74
    v_bfe_u32 v8, v0, 3, 1
    ds_read_b64_tr_b16 v[50:51], v2 offset:3072
    v_lshl_add_u32 v75, v8, 11, v75
    v_lshl_add_u32 v74, v8, 8, v74
    ds_read_b64_tr_b16 v[52:53], v7 offset:2048
    v_lshlrev_b32 v8, 12, v8
    v_add3_u32 v79, v79, v8, s71
    ds_read_b64_tr_b16 v[54:55], v7 offset:3072
    s_and_b32 s70, s61, 30
    buffer_load_dwordx4 v[24:27], v32, s[40:43], s79 offen offset:0 sc1
    buffer_load_dwordx4 v[28:31], v32, s[40:43], s79 offen offset:1024 sc1
    s_add_u32 s73, s70, 54
    ds_read_b64_tr_b16 v[56:57], v2 offset:4096
    s_and_b32 s71, s73, -4
    s_add_u32 s73, s73, s71
    ds_read_b64_tr_b16 v[58:59], v2 offset:5120
    s_lshl_b32 s73, s73, 11
    s_add_u32 s73, s73, 901120
    ds_read_b64_tr_b16 v[60:61], v7 offset:4096
    s_and_b32 s71, s61, 1
    s_lshl_b32 s69, s60, 1
    ds_read_b64_tr_b16 v[62:63], v7 offset:5120
    s_add_u32 s69, s69, s71
    s_lshl_b32 s69, s69, 7
    ds_read_b64_tr_b16 v[64:65], v2 offset:6144
    s_add_u32 s73, s73, s69
    s_add_u32 s70, s70, s61
    ds_read_b64_tr_b16 v[66:67], v2 offset:7168
    s_lshl_b32 s70, s70, 7
    s_add_u32 s69, s58, s70
    ds_read_b64_tr_b16 v[68:69], v7 offset:6144
    s_add_u32 s69, s69, 59904
    ds_read_b64_tr_b16 v[70:71], v7 offset:7168
    s_mov_b32 s80, 0
L_spin_153:
    buffer_load_dwordx4 v[24:27], v32, s[40:43], s79 offen offset:0 sc1
    buffer_load_dwordx4 v[28:31], v32, s[40:43], s79 offen offset:1024 sc1
    s_add_u32 s80, s80, 1024
    s_cbranch_scc1 L_abort
    s_waitcnt vmcnt(2)
    v_cmp_u_f32 vcc, v27, v31
    s_cbranch_vccnz L_spin_153
    s_waitcnt lgkmcnt(0)
    v_mfma_f32_16x16x32_bf16 v[16:19], v[24:27], v[48:51], 0
    v_mfma_f32_16x16x32_bf16 v[16:19], v[28:31], v[64:67], v[16:19]
    v_mfma_f32_16x16x32_bf16 v[12:15], v[24:27], v[44:47], 0
    v_mfma_f32_16x16x32_bf16 v[12:15], v[28:31], v[60:63], v[12:15]
    v_mfma_f32_16x16x32_bf16 v[8:11], v[24:27], v[40:43], 0
    v_mfma_f32_16x16x32_bf16 v[8:11], v[28:31], v[56:59], v[8:11]
    v_mfma_f32_16x16x32_bf16 v[20:23], v[24:27], v[52:55], 0
    v_mfma_f32_16x16x32_bf16 v[20:23], v[28:31], v[68:71], v[20:23]
    s_nop 1
    v_pk_add_f32 v[16:17], v[16:17], v[18:19]
    v_add_f32 v16, v16, v17
    v_pk_add_f32 v[12:13], v[12:13], v[14:15]
    v_add_f32 v12, v12, v13
    v_pk_add_f32 v[8:9], v[8:9], v[10:11]
    v_add_f32 v8, v8, v9
    v_permlane32_swap_b32 v16, v12
    v_add_f32 v8, v8, v12
    v_pk_add_f32 v[20:21], v[20:21], v[22:23]
    v_add_f32 v20, v20, v21
    v_add_f32 v20, v20, v16
    s_nop 1
    v_permlane16_swap_b32 v8, v20
    v_add_f32 v34, v8, v20
    ds_write_b32 v78, v34
    v_cmp_u_f32 vcc, v34, v34
    s_cbranch_vccnz L_spin_153
    s_cmp_lg_u32 s3, 0
    s_waitcnt lgkmcnt(0)
    s_barrier
    s_cbranch_scc1 L_skip_156
    s_mov_b32 exec_hi, 0
    ds_read_b128 v[8:11], v79
    ds_read_b128 v[12:15], v79 offset:8192
    s_waitcnt vmcnt(0) lgkmcnt(0)
    v_pk_add_f32 v[32:33], v[8:9], v[12:13]
    v_pk_add_f32 v[34:35], v[10:11], v[14:15]
    buffer_store_dwordx4 v[32:35], v75, s[40:43], s73 offen sc1
    buffer_store_dwordx4 v[32:35], v74, s[40:43], s69 offen
    s_mov_b64 exec, -1
    s_branch L_skip_156x
L_skip_156:
    s_waitcnt vmcnt(0)
L_skip_156x:
L_join_152:
    s_sub_u32 s70, s61, 24
    s_cmp_lt_u32 s70, 6
    s_cselect_b32 s70, s60, 1
    s_cmp_eq_u32 s3, 3
    s_cselect_b32 s70, 1, s70
    s_cmp_eq_u32 s70, 0
    s_cbranch_scc1 L_fin_157
    s_endpgm
L_fin_157:
    v_lshrrev_b32 v14, 3, v0
    v_lshlrev_b32 v12, 8, v14
    v_and_b32 v13, 7, v0
    v_lshl_add_u32 v12, v13, 4, v12
    s_mul_i32 s70, s63, 3
    s_add_u32 s70, s70, s3
    s_add_u32 s76, s70, 54
    s_and_b32 s71, s76, -4
    s_add_u32 s76, s76, s71
    s_lshl_b32 s76, s76, 11
    s_add_u32 s76, s76, 901120
    s_add_u32 s76, s76, s52
    s_sub_u32 s70, s70, s60
    s_lshl_b32 s70, s70, 8
    s_add_u32 s70, s70, s58
    s_add_u32 s70, s70, 59904
    s_sub_u32 s70, s70, s76
    v_cmp_eq_u32 vcc, s60, v14
    v_add_u32 v15, s70, v12
    s_nop 0
    v_cndmask_b32 v12, v12, v15, vcc
    s_cmp_eq_u32 s3, 3
    s_cselect_b32 s70, 1073741824, 0
    v_add_u32 v12, s70, v12
    v_lshrrev_b32 v14, 4, v0
    v_lshlrev_b32 v13, 3, v13
    v_lshl_add_u32 v13, v14, 1, v13
    s_lshl_b32 s70, s3, 6
    s_add_u32 s70, s70, 150784
    v_add_u32 v13, s70, v13
    v_lshlrev_b32 v14, 4, v14
    v_and_b32 v15, 3, v0
    v_lshl_add_u32 v14, v15, 6, v14
    v_add_u32 v14, 150784, v14
    v_mov_b32 v24, -1
    v_mov_b32 v25, -1
    v_mov_b32 v26, -1
    v_mov_b32 v27, -1
    v_mov_b32 v28, -1
    v_mov_b32 v29, -1
    v_mov_b32 v30, -1
    v_mov_b32 v31, -1
    v_subrev_u32 v13, 150784, v13
    s_mul_i32 s73, s63, 192
    s_mov_b32 s80, 0
L_spin_158:
    s_waitcnt vmcnt(16)
    buffer_load_dwordx4 v[24:27], v12, s[40:43], s76 offen sc1
    buffer_load_dwordx4 v[28:31], v12, s[40:43], s76 offen offset:128 sc1
    s_add_u32 s80, s80, 1024
    s_cbranch_scc1 L_abort
L_chk_160:
    v_cmp_u_f32 vcc, v27, v31
    s_cbranch_vccz L_go_159
    v_cmp_u_f32 vcc, v27, v31
    s_cbranch_vccz L_go_159
    v_cmp_u_f32 vcc, v27, v31
    s_cbranch_vccz L_go_159
    v_cmp_u_f32 vcc, v27, v31
    s_cbranch_vccz L_go_159
    v_cmp_u_f32 vcc, v27, v31
    s_cbranch_vccz L_go_159
    v_cmp_u_f32 vcc, v27, v31
    s_cbranch_vccz L_go_159
    v_cmp_u_f32 vcc, v27, v31
    s_cbranch_vccz L_go_159
    v_cmp_u_f32 vcc, v27, v31
    s_cbranch_vccz L_go_159
    v_cmp_u_f32 vcc, v27, v31
    s_cbranch_vccz L_go_159
    v_cmp_u_f32 vcc, v27, v31
    s_cbranch_vccnz L_spin_158
L_go_159:
    v_pk_add_f32 v[8:9], v[24:25], v[28:29]
    v_pk_add_f32 v[10:11], v[26:27], v[30:31]
    s_nop 1
    v_permlane32_swap_b32 v8, v10
    v_permlane32_swap_b32 v9, v11
    v_add_f32 v8, v8, v10
    v_add_f32 v9, v9, v11
    s_nop 1
    v_permlane16_swap_b32 v8, v9
    v_add_f32 v8, v8, v9
    s_nop 1
    v_add_f32_dpp v8, v8, v8 row_ror:8 row_mask:0xf bank_mask:0xf
    v_add_f32 v8, v8, v4
    v_cvt_pk_bf16_f32 v9, v8, v8
    v_cmp_u_f32 vcc, v8, v8
    s_cbranch_vccnz L_spin_158
    buffer_store_short v9, v13, s[48:51], s73 offen
    s_endpgm
L_retry_45:
    s_add_u32 s80, s80, 1
    s_cmp_ge_u32 s80, 1048576
    s_cbranch_scc1 L_abort
    s_nop 3
    buffer_load_dwordx4 v[40:43], v36, s[40:43], s76 offen sc1
    buffer_load_dwordx4 v[44:47], v37, s[40:43], s76 offen offset:1024 sc1
    buffer_load_dwordx4 v[26:29], v36, s[40:43], s77 offen sc1
    buffer_load_dwordx4 v[30:33], v37, s[40:43], s77 offen offset:1024 sc1
    s_waitcnt vmcnt(0)
    s_branch L_qw_44
L_retry_46:
    s_add_u32 s80, s80, 1
    s_cmp_ge_u32 s80, 1048576
    s_cbranch_scc1 L_abort
    s_nop 3
    buffer_load_dwordx4 v[40:43], v36, s[40:43], s76 offen sc1
    buffer_load_dwordx4 v[44:47], v37, s[40:43], s76 offen offset:1024 sc1
    buffer_load_dwordx4 v[26:29], v36, s[40:43], s77 offen sc1
    buffer_load_dwordx4 v[30:33], v37, s[40:43], s77 offen offset:1024 sc1
    s_waitcnt vmcnt(0)
    s_branch L_qw_44
L_retry_53:
    s_add_u32 s80, s80, 1
    s_cmp_ge_u32 s80, 1048576
    s_cbranch_scc1 L_abort
    s_nop 3
    buffer_load_dword v29, v28, s[40:43], 0 offen sc1
    s_waitcnt vmcnt(0)
    s_branch L_pz_52
L_mlr_67:
    s_add_u32 s80, s80, 1
    s_cmp_ge_u32 s80, 1048576
    s_cbranch_scc1 L_abort
    buffer_load_dwordx2 v[36:37], v33, s[40:43], s79 offen offset:2048 sc1
    s_waitcnt vmcnt(0)
    v_max_f32_dpp v9, v36, v36 row_ror:1 row_mask:0xf bank_mask:0xf
    s_nop 1
    v_max_f32_dpp v9, v9, v9 row_ror:2 row_mask:0xf bank_mask:0xf
    s_nop 1
    v_max_f32_dpp v9, v9, v9 row_ror:4 row_mask:0xf bank_mask:0xf
    v_sub_f32 v9, v36, v9
    v_exp_f32 v9, v9
    s_nop 0
    v_mul_f32 v11, v9, v37
    s_nop 1
    v_add_f32_dpp v11, v11, v11 row_ror:1 row_mask:0xf bank_mask:0xf
    s_nop 1
    v_add_f32_dpp v11, v11, v11 row_ror:2 row_mask:0xf bank_mask:0xf
    s_nop 1
    v_add_f32_dpp v11, v11, v11 row_ror:4 row_mask:0xf bank_mask:0xf
    v_rcp_f32 v11, v11
    s_nop 0
    v_mul_f32 v9, v9, v11
    s_nop 1
    v_mov_b32_dpp v36, v9 row_newbcast:0 row_mask:0xf bank_mask:0xf
    v_mov_b32_dpp v37, v9 row_newbcast:1 row_mask:0xf bank_mask:0xf
    v_mov_b32_dpp v72, v9 row_newbcast:2 row_mask:0xf bank_mask:0xf
    v_mov_b32_dpp v73, v9 row_newbcast:3 row_mask:0xf bank_mask:0xf
    s_nop 1
    s_branch L_mlw_66
L_idle_64:
    s_barrier
    v_mov_b32 v42, -1
    v_mov_b32 v43, -1
    v_mov_b32 v44, -1
    v_mov_b32 v45, -1
    s_mul_i32 s90, s60, 14
    s_add_u32 s90, s90, s61
    s_sub_u32 s90, s90, 18
    s_lshl_b32 s90, s90, 2
    s_add_u32 s90, s90, s3
    s_mul_i32 s90, s90, 256
    s_add_u32 s90, s90, 1048576
    s_cmp_lt_u32 s90, 1130496
    s_cselect_b32 s90, s90, 1073741824
    v_lshl_add_u32 v40, v0, 4, s90
    s_mov_b64 exec, 0xffff
    buffer_store_dwordx4 v[42:45], v40, s[40:43], 0 offen sc1
    s_mov_b64 exec, -1
    s_sub_u32 s90, s61, 18
    s_xor_b32 s92, s68, 1073741824
    s_lshl_b32 s90, s90, 2
    s_add_u32 s90, s90, s3
    s_mul_i32 s90, s90, 37
    v_min_u32 v40, 36, v0
    v_add_u32 v40, s90, v40
    v_min_u32 v40, 2047, v40
    v_add_u32 v40, 2048, v40
    v_lshrrev_b32 v41, 3, v40
    v_and_b32 v40, 7, v40
    v_lshlrev_b32 v40, 7, v40
    v_lshl_add_u32 v40, v41, 13, v40
    s_lshl_b32 s91, s60, 10
    v_add_u32 v40, s92, v40
    v_subrev_u32 v41, 37, v0
    v_ashrrev_i32 v41, 31, v41
    v_bfi_b32 v40, v41, v40, 2.0
    buffer_load_dword v3, v40, s[28:31], s91 offen
    v_mov_b32 v42, -1
    v_mov_b32 v43, -1
    v_mov_b32 v44, -1
    v_mov_b32 v45, -1
    v_lshlrev_b32 v40, 4, v0
    s_mul_i32 s90, s86, 6
    s_sub_u32 s90, s61, s90
    s_sub_u32 s90, s90, 18
    s_lshl_b32 s90, s90, 2
    s_add_u32 s90, s90, s3
    s_cmp_lt_u32 s90, 24
    s_cselect_b32 s92, 0, 1073741824
    v_add_u32 v40, s92, v40
    s_and_b32 s91, s90, 24
    s_add_u32 s91, s91, s90
    s_lshl_b32 s91, s91, 10
    s_and_b32 s92, s47, 0xfff82000
    s_add_u32 s91, s91, s92
    buffer_store_dwordx4 v[42:45], v40, s[40:43], s91 offen
    s_add_u32 s91, s91, 49152
    buffer_store_dwordx4 v[42:45], v40, s[40:43], s91 offen
    s_add_u32 s91, s91, 49152
    buffer_store_dwordx4 v[42:45], v40, s[40:43], s91 offen
    s_add_u32 s91, s91, 49152
    buffer_store_dwordx4 v[42:45], v40, s[40:43], s91 offen
    s_add_u32 s91, s91, 49152
    buffer_store_dwordx4 v[42:45], v40, s[40:43], s91 offen
    s_add_u32 s91, s91, 49152
    buffer_store_dwordx4 v[42:45], v40, s[40:43], s91 offen
    s_add_u32 s91, s91, 49152
    buffer_store_dwordx4 v[42:45], v40, s[40:43], s91 offen
    s_add_u32 s91, s91, 49152
    buffer_store_dwordx4 v[42:45], v40, s[40:43], s91 offen
    s_add_u32 s91, s91, 49152
    buffer_store_dwordx4 v[42:45], v40, s[40:43], s91 offen
    s_add_u32 s91, s91, 49152
    buffer_store_dwordx4 v[42:45], v40, s[40:43], s91 offen
    s_add_u32 s91, s91, 49152
    s_and_b32 s92, s90, 1
    s_lshl_b32 s92, s92, 10
    s_and_b32 s74, s1, 0xfffff800
    s_add_u32 s92, s92, s74
    s_cmp_lt_u32 s90, 16
    s_cselect_b32 s91, s91, s92
    buffer_store_dwordx4 v[42:45], v40, s[40:43], s91 offen
    s_sub_u32 s90, s61, 18
    s_xor_b32 s92, s68, 1073741824
    s_lshl_b32 s90, s90, 2
    s_add_u32 s90, s90, s3
    s_mul_i32 s90, s90, 74
    v_min_u32 v40, 36, v0
    v_add_u32 v40, s90, v40
    v_min_u32 v40, 4095, v40
    v_lshrrev_b32 v41, 3, v40
    v_and_b32 v40, 7, v40
    v_lshlrev_b32 v40, 7, v40
    v_lshl_add_u32 v40, v41, 13, v40
    s_lshl_b32 s91, s60, 10
    v_add_u32 v40, s92, v40
    v_subrev_u32 v41, 37, v0
    v_ashrrev_i32 v41, 31, v41
    v_bfi_b32 v40, v41, v40, 2.0
    buffer_load_dword v3, v40, s[32:35], s91 offen
    v_min_u32 v40, 36, v0
    v_add_u32 v40, s90, v40
    v_add_u32 v40, 37, v40
    v_min_u32 v40, 4095, v40
    v_lshrrev_b32 v41, 3, v40
    v_and_b32 v40, 7, v40
    v_lshlrev_b32 v40, 7, v40
    v_lshl_add_u32 v40, v41, 13, v40
    s_lshl_b32 s91, s60, 10
    v_add_u32 v40, s92, v40
    v_subrev_u32 v41, 37, v0
    v_ashrrev_i32 v41, 31, v41
    v_bfi_b32 v40, v41, v40, 2.0
    buffer_load_dword v3, v40, s[32:35], s91 offen
    v_bfe_u32 v76, v0, 2, 3
    v_lshlrev_b32 v76, 10, v76
    v_lshrrev_b32 v77, 5, v0
    v_lshl_add_u32 v76, v77, 6, v76
    v_bfe_u32 v77, v0, 4, 1
    v_lshlrev_b32 v77, 1, v77
    v_xor_b32 v77, v0, v77
    v_and_b32 v77, 3, v77
    v_lshl_add_u32 v76, v77, 4, v76
    s_waitcnt vmcnt(15)
    s_barrier
    s_branch L_join_65
L_qidle_72:
    v_bfe_u32 v16, v0, 2, 3
    v_lshlrev_b32 v16, 13, v16
    v_lshrrev_b32 v17, 5, v0
    v_lshl_add_u32 v16, v17, 6, v16
    v_bfe_u32 v17, v0, 4, 1
    v_lshlrev_b32 v17, 1, v17
    v_xor_b32 v17, v0, v17
    v_and_b32 v17, 3, v17
    v_lshl_add_u32 v16, v17, 4, v16
    s_lshl_b32 s90, s63, 2
    s_add_u32 s90, s90, s3
    s_lshl_b32 s90, s90, 9
    s_lshr_b32 s91, s64, 21
    s_add_u32 s90, s90, s91
    s_lshl_b32 s90, s90, 8
    s_add_u32 m0, s66, 0
    s_add_u32 s91, s90, 0
    buffer_load_dwordx4 v16, s[28:31], s91 offen  lds
    s_add_u32 m0, s66, 896
    s_nop 0
    buffer_load_dwordx4 v16, s[28:31], s91 offen offset:128  lds
    s_add_u32 m0, s66, 2048
    s_add_u32 s91, s90, 65536
    buffer_load_dwordx4 v16, s[28:31], s91 offen  lds
    s_add_u32 m0, s66, 2944
    s_nop 0
    buffer_load_dwordx4 v16, s[28:31], s91 offen offset:128  lds
    v_lshlrev_b32 v36, 4, v0
    v_and_b32 v37, 32, v0
    v_lshl_add_u32 v37, v37, 26, v36
    v_mov_b32 v40, -1
    v_mov_b32 v41, -1
    v_mov_b32 v42, -1
    v_mov_b32 v43, -1
    v_mov_b32 v44, -1
    v_mov_b32 v45, -1
    v_mov_b32 v46, -1
    v_mov_b32 v47, -1
    s_add_u32 s76, s58, s59
    s_add_u32 s76, s76, 8704
    v_lshrrev_b32 v12, 5, v0
    v_lshlrev_b32 v12, 7, v12
    v_mov_b32 v24, -1
    buffer_load_dword v24, v12, s[40:43], s76 offen sc1
    s_mov_b32 s80, 0
L_spin_77:
    buffer_load_dword v24, v12, s[40:43], s76 offen sc1
    s_add_u32 s80, s80, 1024
    s_cbranch_scc1 L_abort
    s_waitcnt vmcnt(1)
    v_cmp_u_f32 vcc, v24, v24
    s_cbranch_vccnz L_spin_77
    s_waitcnt vmcnt(0)
    s_branch L_qjoin_73
L_redo_85:
    s_waitcnt vmcnt(0) lgkmcnt(0)
    s_barrier
    v_bfe_u32 v72, v0, 2, 3
    v_lshlrev_b32 v72, 11, v72
    v_lshrrev_b32 v73, 5, v0
    v_lshl_add_u32 v72, v73, 6, v72
    v_bfe_u32 v73, v0, 4, 1
    v_lshlrev_b32 v73, 1, v73
    v_xor_b32 v73, v0, v73
    v_and_b32 v73, 3, v73
    v_lshl_add_u32 v72, v73, 4, v72
    v_and_b32 v74, 0x2000, v72
    v_add_u32 v72, v72, v74
    v_add_u32 v74, 32768, v72
    v_bfe_u32 v75, v0, 3, 2
    s_sub_u32 s70, s60, 4
    v_cmp_eq_u32 vcc, s60, v75
    v_add_u32 v73, s77, v72
    s_nop 0
    v_cndmask_b32 v72, v72, v73, vcc
    v_cmp_eq_u32 vcc, s70, v75
    v_add_u32 v73, s77, v74
    s_nop 0
    v_cndmask_b32 v74, v74, v73, vcc
    s_mov_b32 s71, 147456
    v_and_b32 v76, 7, v0
    v_lshlrev_b32 v76, 6, v76
    v_bfe_u32 v77, v0, 3, 1
    v_lshl_add_u32 v76, v77, 11, v76
    v_lshlrev_b32 v77, 3, v0
    v_and_b32 v77, 32, v77
    v_xor_b32 v77, v0, v77
    v_and_b32 v77, 48, v77
    v_add3_u32 v76, v76, v77, s71
    s_lshl_b32 s70, s3, 12
    s_sub_u32 s70, s70, 65536
    v_add_u32 v77, s70, v76
    v_lshlrev_b32 v73, 6, v0
    v_bfe_u32 v75, v0, 1, 3
    v_lshl_add_u32 v73, v75, 2, v73
    v_add_u32 v73, s88, v73
    v_mov_b32 v3, 1073741824
    v_mov_b32 v75, 1073741824
    s_add_u32 m0, s88, 0
    s_nop 0
    buffer_load_dwordx4 v72, s[40:43], s76 offen offset:0 sc1 lds
    s_add_u32 m0, s88, 896
    s_nop 0
    buffer_load_dwordx4 v72, s[40:43], s76 offen offset:128 sc1 lds
    s_add_u32 m0, s88, 2048
    s_nop 0
    buffer_load_dwordx4 v74, s[40:43], s76 offen offset:0 sc1 lds
    s_add_u32 m0, s88, 2944
    s_nop 0
    buffer_load_dwordx4 v74, s[40:43], s76 offen offset:128 sc1 lds
    ds_read_b128 v[32:35], v77 offset:0
    ds_read_b128 v[36:39], v77 offset:512
    ds_read_b128 v[40:43], v77 offset:1024
    ds_read_b128 v[44:47], v77 offset:1536
    ds_read_b128 v[48:51], v77 offset:16384
    ds_read_b128 v[52:55], v77 offset:16896
    ds_read_b128 v[56:59], v77 offset:17408
    ds_read_b128 v[60:63], v77 offset:17920
    ds_read_b128 v[64:67], v77 offset:32768
    ds_read_b128 v[68:71], v77 offset:33280
    s_branch L_qaa_84
L_retry_91:
    s_add_u32 s80, s80, 1
    s_cmp_ge_u32 s80, 1048576
    s_cbranch_scc1 L_abort
    s_nop 3
    buffer_load_dwordx4 v[8:11], v72, s[40:43], s0 offen sc1
    buffer_load_dwordx4 v[12:15], v72, s[40:43], s95 offen sc1
    buffer_load_dwordx4 v[16:19], v72, s[40:43], s96 offen sc1
    buffer_load_dwordx4 v[20:23], v72, s[40:43], s97 offen sc1
    s_waitcnt vmcnt(0)
    s_branch L_paw_90
L_idle_99:
    s_barrier
    v_mov_b32 v42, -1
    v_mov_b32 v43, -1
    v_mov_b32 v44, -1
    v_mov_b32 v45, -1
    s_mul_i32 s90, s60, 14
    s_add_u32 s90, s90, s61
    s_sub_u32 s90, s90, 18
    s_lshl_b32 s90, s90, 2
    s_add_u32 s90, s90, s3
    s_mul_i32 s90, s90, 1024
    s_add_u32 s90, s90, 1130496
    s_cmp_lt_u32 s90, 1572864
    s_cselect_b32 s90, s90, 1073741824
    v_lshl_add_u32 v40, v0, 4, s90
    buffer_store_dwordx4 v[42:45], v40, s[40:43], 0 offen sc1
    s_mov_b64 exec, -1
    v_bfe_u32 v76, v0, 4, 1
    v_bfe_u32 v77, v0, 2, 2
    v_lshl_add_u32 v76, v76, 3, v77
    v_mul_u32_u24 v76, 8192, v76
    v_lshrrev_b32 v77, 5, v0
    v_lshl_add_u32 v76, v77, 6, v76
    v_bfe_u32 v77, v0, 4, 1
    v_lshlrev_b32 v77, 1, v77
    v_xor_b32 v77, v0, v77
    v_and_b32 v77, 3, v77
    v_lshl_add_u32 v76, v77, 4, v76
    s_and_b32 s90, s3, 1
    s_mul_i32 s90, s90, 131008
    s_add_u32 s90, s90, s67
    v_add_u32 v76, s90, v76
    s_waitcnt vmcnt(1)
    s_barrier
    s_branch L_join_100
L_qidle_105:
    v_bfe_u32 v72, v0, 2, 3
    v_lshlrev_b32 v72, 10, v72
    v_lshrrev_b32 v60, 5, v0
    v_lshl_add_u32 v72, v60, 6, v72
    v_bfe_u32 v60, v0, 4, 1
    v_lshlrev_b32 v60, 1, v60
    v_xor_b32 v60, v0, v60
    v_and_b32 v60, 3, v60
    v_lshl_add_u32 v72, v60, 4, v72
    v_bfe_u32 v73, v0, 4, 1
    v_bfe_u32 v60, v0, 2, 2
    v_lshl_add_u32 v73, v73, 3, v60
    v_mul_u32_u24 v73, 1152, v73
    v_lshrrev_b32 v60, 5, v0
    v_lshl_add_u32 v73, v60, 6, v73
    v_bfe_u32 v60, v0, 4, 1
    v_lshlrev_b32 v60, 1, v60
    v_xor_b32 v60, v0, v60
    v_and_b32 v60, 3, v60
    v_lshl_add_u32 v73, v60, 4, v73
    s_and_b32 s90, s3, 1
    s_mul_i32 s90, s90, 18368
    s_add_u32 s90, s90, s68
    v_add_u32 v73, s90, v73
    v_lshrrev_b32 v74, 5, v0
    v_lshlrev_b32 v74, 11, v74
    v_bfe_u32 v75, v0, 2, 3
    v_lshl_add_u32 v74, v75, 6, v74
    v_bfe_u32 v75, v0, 4, 1
    v_lshl_add_u32 v74, v75, 5, v74
    v_and_b32 v75, 3, v0
    v_lshl_add_u32 v74, v75, 3, v74
    v_add_u32 v74, s65, v74
    v_xor_b32 v75, 32, v74
    v_mov_b64 v[60:61], 0
    v_mov_b64 v[62:63], 0
    v_mov_b64 v[64:65], 0
    v_mov_b64 v[66:67], 0
    v_mov_b64 v[68:69], 0
    v_mov_b64 v[70:71], 0
    v_lshlrev_b32 v36, 4, v0
    v_and_b32 v37, 32, v0
    v_lshl_add_u32 v37, v37, 26, v36
    v_mov_b32 v40, -1
    v_mov_b32 v41, -1
    v_mov_b32 v42, -1
    v_mov_b32 v43, -1
    v_mov_b32 v44, -1
    v_mov_b32 v45, -1
    v_mov_b32 v46, -1
    v_mov_b32 v47, -1
    s_add_u32 s76, s58, 50688
    v_lshrrev_b32 v12, 5, v0
    v_lshlrev_b32 v12, 7, v12
    v_mov_b32 v24, -1
    buffer_load_dword v24, v12, s[40:43], s76 offen sc1
    s_mov_b32 s80, 0
L_spin_110:
    buffer_load_dword v24, v12, s[40:43], s76 offen sc1
    s_add_u32 s80, s80, 1024
    s_cbranch_scc1 L_abort
    s_waitcnt vmcnt(1)
    v_cmp_u_f32 vcc, v24, v24
    s_cbranch_vccnz L_spin_110
    s_waitcnt vmcnt(0)
    s_branch L_qjoin_106
L_mlagain_122:
    buffer_load_dwordx2 v[72:73], v33, s[40:43], s79 offen offset:2048 sc1
    s_branch L_spin_119
L_idle_117:
    v_bfe_u32 v208, v0, 4, 1
    v_bfe_u32 v209, v0, 2, 2
    v_lshl_add_u32 v208, v208, 3, v209
    v_mul_u32_u24 v208, 8192, v208
    v_lshrrev_b32 v209, 5, v0
    v_lshl_add_u32 v208, v209, 6, v208
    v_bfe_u32 v209, v0, 4, 1
    v_lshlrev_b32 v209, 1, v209
    v_xor_b32 v209, v0, v209
    v_and_b32 v209, 3, v209
    v_lshl_add_u32 v208, v209, 4, v208
    s_and_b32 s90, s3, 1
    s_mul_i32 s90, s90, 131008
    s_add_u32 s90, s90, s67
    v_add_u32 v208, s90, v208
    s_waitcnt vmcnt(0)
    s_barrier
    s_branch L_join_118
L_qidle_124:
    v_lshlrev_b32 v36, 4, v0
    v_and_b32 v37, 32, v0
    v_lshl_add_u32 v37, v37, 26, v36
    v_mov_b32 v40, -1
    v_mov_b32 v41, -1
    v_mov_b32 v42, -1
    v_mov_b32 v43, -1
    v_mov_b32 v44, -1
    v_mov_b32 v45, -1
    v_mov_b32 v46, -1
    v_mov_b32 v47, -1
    s_add_u32 s76, s58, 55296
    v_lshrrev_b32 v12, 5, v0
    v_lshlrev_b32 v12, 7, v12
    v_mov_b32 v24, -1
    buffer_load_dword v24, v12, s[40:43], s76 offen sc1
    s_mov_b32 s80, 0
L_spin_129:
    buffer_load_dword v24, v12, s[40:43], s76 offen sc1
    s_add_u32 s80, s80, 1024
    s_cbranch_scc1 L_abort
    s_waitcnt vmcnt(1)
    v_cmp_u_f32 vcc, v24, v24
    s_cbranch_vccnz L_spin_129
    s_waitcnt vmcnt(0)
    s_branch L_qjoin_125
L_redo_137:
    s_waitcnt vmcnt(0) lgkmcnt(0)
    s_barrier
    v_bfe_u32 v72, v0, 2, 3
    v_lshlrev_b32 v72, 11, v72
    v_lshrrev_b32 v73, 5, v0
    v_lshl_add_u32 v72, v73, 6, v72
    v_bfe_u32 v73, v0, 4, 1
    v_lshlrev_b32 v73, 1, v73
    v_xor_b32 v73, v0, v73
    v_and_b32 v73, 3, v73
    v_lshl_add_u32 v72, v73, 4, v72
    v_and_b32 v74, 0x2000, v72
    v_add_u32 v72, v72, v74
    v_add_u32 v74, 32768, v72
    v_bfe_u32 v75, v0, 3, 2
    s_sub_u32 s70, s60, 4
    v_cmp_eq_u32 vcc, s60, v75
    v_add_u32 v73, s77, v72
    s_nop 0
    v_cndmask_b32 v72, v72, v73, vcc
    v_cmp_eq_u32 vcc, s70, v75
    v_add_u32 v73, s77, v74
    s_nop 0
    v_cndmask_b32 v74, v74, v73, vcc
    s_mov_b32 s71, 147456
    v_and_b32 v76, 7, v0
    v_lshlrev_b32 v76, 6, v76
    v_bfe_u32 v77, v0, 3, 1
    v_lshl_add_u32 v76, v77, 11, v76
    v_lshlrev_b32 v77, 3, v0
    v_and_b32 v77, 32, v77
    v_xor_b32 v77, v0, v77
    v_and_b32 v77, 48, v77
    v_add3_u32 v76, v76, v77, s71
    s_lshl_b32 s70, s3, 12
    s_sub_u32 s70, s70, 65536
    v_add_u32 v77, s70, v76
    v_lshlrev_b32 v73, 6, v0
    v_bfe_u32 v75, v0, 1, 3
    v_lshl_add_u32 v73, v75, 2, v73
    v_add_u32 v73, s88, v73
    v_mov_b32 v3, 1073741824
    v_mov_b32 v75, 1073741824
    s_add_u32 m0, s88, 0
    s_nop 0
    buffer_load_dwordx4 v72, s[40:43], s76 offen offset:0 sc1 lds
    s_add_u32 m0, s88, 896
    s_nop 0
    buffer_load_dwordx4 v72, s[40:43], s76 offen offset:128 sc1 lds
    s_add_u32 m0, s88, 2048
    s_nop 0
    buffer_load_dwordx4 v74, s[40:43], s76 offen offset:0 sc1 lds
    s_add_u32 m0, s88, 2944
    s_nop 0
    buffer_load_dwordx4 v74, s[40:43], s76 offen offset:128 sc1 lds
    ds_read_b128 v[80:83], v77 offset:0
    ds_read_b128 v[84:87], v77 offset:512
    ds_read_b128 v[88:91], v77 offset:1024
    ds_read_b128 v[92:95], v77 offset:1536
    ds_read_b128 v[96:99], v77 offset:16384
    ds_read_b128 v[100:103], v77 offset:16896
    ds_read_b128 v[104:107], v77 offset:17408
    ds_read_b128 v[108:111], v77 offset:17920
    ds_read_b128 v[112:115], v77 offset:32768
    ds_read_b128 v[116:119], v77 offset:33280
    ds_read_b128 v[120:123], v77 offset:33792
    ds_read_b128 v[124:127], v77 offset:34304
    ds_read_b128 v[128:131], v77 offset:49152
    ds_read_b128 v[132:135], v77 offset:49664
    ds_read_b128 v[136:139], v77 offset:50176
    ds_read_b128 v[140:143], v77 offset:50688
    s_branch L_qaa_136
L_retry_143:
    s_add_u32 s80, s80, 1
    s_cmp_ge_u32 s80, 1048576
    s_cbranch_scc1 L_abort
    s_nop 3
    buffer_load_dwordx4 v[8:11], v72, s[40:43], s0 offen sc1
    buffer_load_dwordx4 v[12:15], v72, s[40:43], s95 offen sc1
    buffer_load_dwordx4 v[16:19], v72, s[40:43], s96 offen sc1
    buffer_load_dwordx4 v[20:23], v72, s[40:43], s97 offen sc1
    s_waitcnt vmcnt(0)
    s_branch L_paw_142
L_idle_151:
    s_waitcnt vmcnt(0)
    s_barrier
    s_branch L_join_152
L_end_fast:
L_slow:
    s_add_u32 s76, s44, s59
    s_add_u32 s76, s76, 13312
    s_add_u32 s77, s76, 24576
    s_lshl_b32 s70, s63, 8
    s_add_u32 s70, s70, s67
    v_lshl_add_u32 v76, v0, 4, s70
    s_mov_b64 exec, 0xffff
    buffer_store_dwordx4 v[8:11], v76, s[40:43], s76 offen sc1
    buffer_store_dwordx4 v[60:63], v76, s[40:43], s77 offen sc1
    s_mov_b64 exec, -1
    s_xor_b32 s78, s64, 263168
    s_waitcnt vmcnt(8)
    s_cmp_lg_u32 s101, 0
    s_cbranch_scc1 L_lag_161
    s_waitcnt vmcnt(6)
L_lag_161:
    buffer_load_dwordx4 a[192:195], v72, s[4:7], s78 offen offset:0 nt
    buffer_load_dwordx4 a[196:199], v72, s[4:7], s78 offen offset:128 nt
    s_lshl_b32 s97, s2, 2
    s_add_u32 s97, s97, s3
    s_lshl_b32 s96, s60, 21
    s_add_u32 s56, s20, s96
    s_addc_u32 s57, s21, 0
    s_add_u32 s94, s40, 507904
    s_addc_u32 s95, s41, 0
    s_cmp_eq_u32 s97, 995
    s_cselect_b64 s[56:57], s[94:95], s[56:57]
    s_cselect_b32 s97, 994, s97
    s_and_b32 s97, s97, 1011
    s_mov_b32 s96, 0
    s_cmp_lg_u32 s97, 994
    s_cbranch_scc1 L_np_162
    s_memtime s[70:71]
    s_load_dword s90, s[56:57], 0x2000 glc
    s_waitcnt lgkmcnt(0)
    s_memtime s[72:73]
    s_waitcnt lgkmcnt(0)
    s_sub_u32 s95, s72, s70
    s_memtime s[70:71]
    s_load_dword s90, s[56:57], 0x0 glc
    s_waitcnt lgkmcnt(0)
    s_memtime s[72:73]
    s_waitcnt lgkmcnt(0)
    s_sub_u32 s94, s72, s70
    s_cmp_gt_u32 s94, s95
    s_addc_u32 s96, s96, 0
L_np_162:
    s_waitcnt vmcnt(8)
    s_cmp_lg_u32 s101, 0
    s_cbranch_scc1 L_lag_163
    s_waitcnt vmcnt(6)
L_lag_163:
    buffer_load_dwordx4 a[200:203], v72, s[4:7], s78 offen offset:256 nt
    buffer_load_dwordx4 a[204:207], v72, s[4:7], s78 offen offset:384 nt
    s_waitcnt vmcnt(8)
    s_cmp_lg_u32 s101, 0
    s_cbranch_scc1 L_lag_164
    s_waitcnt vmcnt(6)
L_lag_164:
    buffer_load_dwordx4 a[208:211], v72, s[4:7], s78 offen offset:512 nt
    buffer_load_dwordx4 a[212:215], v72, s[4:7], s78 offen offset:640 nt
    s_waitcnt vmcnt(8)
    s_cmp_lg_u32 s101, 0
    s_cbranch_scc1 L_lag_165
    s_waitcnt vmcnt(4)
L_lag_165:
    buffer_load_dwordx4 a[216:219], v72, s[4:7], s78 offen offset:768 nt
    s_cmp_lg_u32 s97, 994
    s_cbranch_scc1 L_np_166
    s_memtime s[70:71]
    s_load_dword s90, s[56:57], 0x1000 glc
    s_waitcnt lgkmcnt(0)
    s_memtime s[72:73]
    s_waitcnt lgkmcnt(0)
    s_sub_u32 s94, s72, s70
    s_memtime s[70:71]
    s_load_dword s90, s[56:57], 0x3000 glc
    s_waitcnt lgkmcnt(0)
    s_memtime s[72:73]
    s_waitcnt lgkmcnt(0)
    s_sub_u32 s95, s72, s70
    s_cmp_gt_u32 s94, s95
    s_addc_u32 s96, s96, 0
L_np_166:
    buffer_load_dwordx4 a[220:223], v72, s[4:7], s78 offen offset:896 nt
    s_xor_b32 s78, s64, 304128
    s_waitcnt vmcnt(6)
    s_cmp_lg_u32 s101, 0
    s_cbranch_scc1 L_lag_167
    s_waitcnt vmcnt(4)
L_lag_167:
    buffer_load_dwordx4 a[224:227], v72, s[4:7], s78 offen offset:0 nt
    buffer_load_dwordx4 a[228:231], v72, s[4:7], s78 offen offset:128 nt
    s_waitcnt vmcnt(6)
    s_cmp_lg_u32 s101, 0
    s_cbranch_scc1 L_lag_168
    s_waitcnt vmcnt(4)
L_lag_168:
    buffer_load_dwordx4 a[232:235], v72, s[4:7], s78 offen offset:256 nt
    buffer_load_dwordx4 a[236:239], v72, s[4:7], s78 offen offset:384 nt
    s_cmp_lg_u32 s97, 994
    s_cbranch_scc1 L_np_169
    s_memtime s[70:71]
    s_load_dword s90, s[56:57], 0x6000 glc
    s_waitcnt lgkmcnt(0)
    s_memtime s[72:73]
    s_waitcnt lgkmcnt(0)
    s_sub_u32 s95, s72, s70
    s_memtime s[70:71]
    s_load_dword s90, s[56:57], 0x4000 glc
    s_waitcnt lgkmcnt(0)
    s_memtime s[72:73]
    s_waitcnt lgkmcnt(0)
    s_sub_u32 s94, s72, s70
    s_cmp_gt_u32 s94, s95
    s_addc_u32 s96, s96, 0
    s_cmp_gt_u32 s96, 1
    s_cselect_b32 s95, 0x2000, 0
    s_add_u32 s94, s60, 1
    s_cmp_eq_u32 s3, 3
    s_cselect_b32 s70, s52, 0
    s_cselect_b32 s94, 0, s94
    s_xor_b32 s95, s95, s70
    s_lshl_b32 s94, s94, 7
    v_mov_b32 v64, s95
    v_mov_b32 v65, 499712
    buffer_store_dword v64, v65, s[40:43], s94 offen sc1
L_np_169:
    s_waitcnt vmcnt(6)
    s_cmp_lg_u32 s101, 0
    s_cbranch_scc1 L_lag_170
    s_waitcnt vmcnt(4)
L_lag_170:
    buffer_load_dwordx4 a[240:243], v72, s[4:7], s78 offen offset:512 nt
    buffer_load_dwordx4 a[244:247], v72, s[4:7], s78 offen offset:640 nt
    s_waitcnt vmcnt(6)
    s_cmp_lg_u32 s101, 0
    s_cbranch_scc1 L_lag_171
    s_waitcnt vmcnt(4)
L_lag_171:
    buffer_load_dwordx4 a[248:251], v72, s[4:7], s78 offen offset:768 nt
    buffer_load_dwordx4 a[252:255], v72, s[4:7], s78 offen offset:896 nt
    v_lshrrev_b32 v73, 5, v0
    v_lshlrev_b32 v73, 6, v73
    v_bfe_u32 v74, v0, 2, 1
    v_lshl_add_u32 v73, v74, 8, v73
    v_bfe_u32 v74, v0, 3, 1
    v_lshl_add_u32 v73, v74, 9, v73
    v_bfe_u32 v74, v0, 4, 1
    v_lshl_add_u32 v73, v74, 11, v73
    v_bfe_u32 v74, v0, 4, 1
    v_lshlrev_b32 v74, 1, v74
    v_xor_b32 v74, v0, v74
    v_and_b32 v74, 3, v74
    v_lshl_add_u32 v73, v74, 4, v73
    v_lshrrev_b32 v3, 5, v0
    v_lshlrev_b32 v3, 11, v3
    v_bfe_u32 v79, v0, 2, 3
    v_lshl_add_u32 v3, v79, 6, v3
    v_bfe_u32 v79, v0, 4, 1
    v_lshl_add_u32 v3, v79, 5, v3
    v_and_b32 v79, 3, v0
    v_lshl_add_u32 v3, v79, 3, v3
    v_add_u32 v3, s65, v3
    v_xor_b32 v79, 32, v3
    v_lshlrev_b32 v36, 4, v0
    v_and_b32 v37, 32, v0
    v_lshl_add_u32 v37, v37, 26, v36
    v_lshrrev_b32 v22, 4, v0
    v_and_b32 v23, 1, v22
    v_lshlrev_b32 v22, 4, v22
    v_mul_u32_u24 v23, 4080, v23
    v_add_u32 v22, v23, v22
    v_and_b32 v23, 15, v0
    v_lshl_add_u32 v22, v23, 1, v22
    s_lshl_b32 s70, s3, 6
    s_add_u32 s70, s70, 154880
    v_add_u32 v22, s70, v22
    v_and_b32 v24, 1, v0
    v_lshlrev_b32 v24, 6, v24
    v_lshrrev_b32 v25, 4, v0
    v_lshl_add_u32 v24, v25, 4, v24
    v_add_u32 v24, 154880, v24
    s_mov_b32 s80, 0
    s_waitcnt vmcnt(6)
    s_cmp_lg_u32 s101, 0
    s_cbranch_scc1 L_lag_172
    s_waitcnt vmcnt(4)
L_lag_172:
    s_add_u32 m0, s65, 16384
    s_xor_b32 s78, s64, 0
    buffer_load_dwordx4 v73, s[8:11], s78 offen nt lds
    s_add_u32 m0, s65, 17408
    s_xor_b32 s78, s64, 65536
    buffer_load_dwordx4 v73, s[8:11], s78 offen nt lds
    s_waitcnt vmcnt(6)
    s_cmp_lg_u32 s101, 0
    s_cbranch_scc1 L_lag_173
    s_waitcnt vmcnt(4)
L_lag_173:
    s_add_u32 m0, s65, 18432
    s_xor_b32 s78, s64, 4096
    buffer_load_dwordx4 v73, s[8:11], s78 offen nt lds
    s_add_u32 m0, s65, 19456
    s_xor_b32 s78, s64, 69632
    buffer_load_dwordx4 v73, s[8:11], s78 offen nt lds
    s_waitcnt vmcnt(6)
    s_cmp_lg_u32 s101, 0
    s_cbranch_scc1 L_lag_174
    s_waitcnt vmcnt(4)
L_lag_174:
    s_add_u32 m0, s65, 0
    s_xor_b32 s78, s64, 128
    buffer_load_dwordx4 v73, s[8:11], s78 offen nt lds
    s_add_u32 m0, s65, 1024
    s_xor_b32 s78, s64, 65664
    buffer_load_dwordx4 v73, s[8:11], s78 offen nt lds
    s_waitcnt vmcnt(6)
    s_cmp_lg_u32 s101, 0
    s_cbranch_scc1 L_lag_175
    s_waitcnt vmcnt(4)
L_lag_175:
    s_add_u32 m0, s65, 2048
    s_xor_b32 s78, s64, 4224
    buffer_load_dwordx4 v73, s[8:11], s78 offen nt lds
    s_add_u32 m0, s65, 3072
    s_xor_b32 s78, s64, 69760
    buffer_load_dwordx4 v73, s[8:11], s78 offen nt lds
    s_waitcnt vmcnt(6)
    s_cmp_lg_u32 s101, 0
    s_cbranch_scc1 L_lag_176
    s_waitcnt vmcnt(4)
L_lag_176:
    s_add_u32 m0, s65, 4096
    s_xor_b32 s78, s64, 40960
    buffer_load_dwordx4 v73, s[8:11], s78 offen nt lds
    s_add_u32 m0, s65, 5120
    s_xor_b32 s78, s64, 106496
    buffer_load_dwordx4 v73, s[8:11], s78 offen nt lds
    s_waitcnt vmcnt(6)
    ds_read_b64_tr_b16 v[80:81], v3 offset:16384
    ds_read_b64_tr_b16 v[82:83], v3 offset:17408
    ds_read_b64_tr_b16 v[88:89], v79 offset:16384
    ds_read_b64_tr_b16 v[90:91], v79 offset:17408
    ds_read_b64_tr_b16 v[96:97], v3 offset:16896
    ds_read_b64_tr_b16 v[98:99], v3 offset:17920
    ds_read_b64_tr_b16 v[104:105], v79 offset:16896
    ds_read_b64_tr_b16 v[106:107], v79 offset:17920
    s_and_b32 s70, s69, 5
    s_cmp_eq_u32 s70, 5
    s_cselect_b32 s101, 1, 0
    s_cmp_lg_u32 s101, 0
    s_cbranch_scc1 L_lag_177
    s_waitcnt vmcnt(4)
L_lag_177:
    s_add_u32 m0, s65, 6144
    s_xor_b32 s78, s64, 45056
    buffer_load_dwordx4 v73, s[8:11], s78 offen nt lds
    s_add_u32 m0, s65, 7168
    s_xor_b32 s78, s64, 110592
    buffer_load_dwordx4 v73, s[8:11], s78 offen nt lds
    s_waitcnt lgkmcnt(0)
    s_waitcnt vmcnt(6)
    s_cmp_lg_u32 s101, 0
    s_cbranch_scc1 L_lag_178
    s_waitcnt vmcnt(4)
L_lag_178:
    s_add_u32 m0, s65, 8192
    s_xor_b32 s78, s64, 41088
    buffer_load_dwordx4 v73, s[8:11], s78 offen nt lds
    s_add_u32 m0, s65, 9216
    s_xor_b32 s78, s64, 106624
    buffer_load_dwordx4 v73, s[8:11], s78 offen nt lds
    s_waitcnt vmcnt(6)
    ds_read_b64_tr_b16 v[112:113], v3 offset:0
    ds_read_b64_tr_b16 v[114:115], v3 offset:1024
    ds_read_b64_tr_b16 v[120:121], v79 offset:0
    ds_read_b64_tr_b16 v[122:123], v79 offset:1024
    ds_read_b64_tr_b16 v[128:129], v3 offset:512
    ds_read_b64_tr_b16 v[130:131], v3 offset:1536
    ds_read_b64_tr_b16 v[136:137], v79 offset:512
    ds_read_b64_tr_b16 v[138:139], v79 offset:1536
    buffer_load_dwordx4 v[40:43], v36, s[40:43], s76 offen sc1
    buffer_load_dwordx4 v[44:47], v37, s[40:43], s76 offen offset:1024 sc1
    buffer_load_dwordx4 v[26:29], v36, s[40:43], s77 offen sc1
    buffer_load_dwordx4 v[30:33], v37, s[40:43], s77 offen offset:1024 sc1
    s_cmp_lg_u32 s101, 0
    s_cbranch_scc1 L_lag_179
    s_waitcnt vmcnt(8)
L_lag_179:
    s_add_u32 m0, s65, 10240
    s_xor_b32 s78, s64, 45184
    buffer_load_dwordx4 v73, s[8:11], s78 offen nt lds
    s_add_u32 m0, s65, 11264
    s_xor_b32 s78, s64, 110720
    buffer_load_dwordx4 v73, s[8:11], s78 offen nt lds
    s_waitcnt lgkmcnt(0)
    s_waitcnt vmcnt(10)
    s_cmp_lg_u32 s101, 0
    s_cbranch_scc1 L_lag_180
    s_waitcnt vmcnt(8)
L_lag_180:
    s_add_u32 m0, s65, 12288
    s_xor_b32 s78, s64, 1024
    buffer_load_dwordx4 v73, s[8:11], s78 offen nt lds
    s_add_u32 m0, s65, 13312
    s_xor_b32 s78, s64, 66560
    buffer_load_dwordx4 v73, s[8:11], s78 offen nt lds
    s_waitcnt vmcnt(10)
    ds_read_b64_tr_b16 v[84:85], v3 offset:4096
    ds_read_b64_tr_b16 v[86:87], v3 offset:5120
    ds_read_b64_tr_b16 v[92:93], v79 offset:4096
    ds_read_b64_tr_b16 v[94:95], v79 offset:5120
    ds_read_b64_tr_b16 v[100:101], v3 offset:4608
    ds_read_b64_tr_b16 v[102:103], v3 offset:5632
    ds_read_b64_tr_b16 v[108:109], v79 offset:4608
    ds_read_b64_tr_b16 v[110:111], v79 offset:5632
    s_cmp_lg_u32 s101, 0
    s_cbranch_scc1 L_lag_181
    s_waitcnt vmcnt(8)
L_lag_181:
    s_add_u32 m0, s65, 14336
    s_xor_b32 s78, s64, 5120
    buffer_load_dwordx4 v73, s[8:11], s78 offen nt lds
    s_add_u32 m0, s65, 15360
    s_xor_b32 s78, s64, 70656
    buffer_load_dwordx4 v73, s[8:11], s78 offen nt lds
    s_waitcnt lgkmcnt(0)
    s_waitcnt vmcnt(10)
    s_cmp_lg_u32 s101, 0
    s_cbranch_scc1 L_lag_182
    s_waitcnt vmcnt(4)
L_lag_182:
    s_add_u32 m0, s65, 16384
    s_xor_b32 s78, s64, 1152
    buffer_load_dwordx4 v73, s[8:11], s78 offen nt lds
    s_add_u32 m0, s65, 17408
    s_xor_b32 s78, s64, 66688
    buffer_load_dwordx4 v73, s[8:11], s78 offen nt lds
    s_waitcnt vmcnt(6)
    ds_read_b64_tr_b16 v[116:117], v3 offset:8192
    ds_read_b64_tr_b16 v[118:119], v3 offset:9216
    ds_read_b64_tr_b16 v[124:125], v79 offset:8192
    ds_read_b64_tr_b16 v[126:127], v79 offset:9216
    ds_read_b64_tr_b16 v[132:133], v3 offset:8704
    ds_read_b64_tr_b16 v[134:135], v3 offset:9728
    ds_read_b64_tr_b16 v[140:141], v79 offset:8704
    ds_read_b64_tr_b16 v[142:143], v79 offset:9728
    s_add_u32 m0, s65, 18432
    s_xor_b32 s78, s64, 5248
    buffer_load_dwordx4 v73, s[8:11], s78 offen nt lds
    s_add_u32 m0, s65, 19456
    s_xor_b32 s78, s64, 70784
    buffer_load_dwordx4 v73, s[8:11], s78 offen nt lds
    s_add_u32 m0, s65, 0
    s_xor_b32 s78, s64, 41984
    buffer_load_dwordx4 v73, s[8:11], s78 offen nt lds
    s_add_u32 m0, s65, 1024
    s_xor_b32 s78, s64, 107520
    buffer_load_dwordx4 v73, s[8:11], s78 offen nt lds
    s_add_u32 m0, s65, 2048
    s_xor_b32 s78, s64, 46080
    buffer_load_dwordx4 v73, s[8:11], s78 offen nt lds
    s_add_u32 m0, s65, 3072
    s_xor_b32 s78, s64, 111616
    buffer_load_dwordx4 v73, s[8:11], s78 offen nt lds
    s_add_u32 m0, s65, 4096
    s_xor_b32 s78, s64, 42112
    buffer_load_dwordx4 v73, s[8:11], s78 offen nt lds
    s_add_u32 m0, s65, 5120
    s_xor_b32 s78, s64, 107648
    buffer_load_dwordx4 v73, s[8:11], s78 offen nt lds
    s_add_u32 m0, s65, 6144
    s_xor_b32 s78, s64, 46208
    buffer_load_dwordx4 v73, s[8:11], s78 offen nt lds
    s_add_u32 m0, s65, 7168
    s_xor_b32 s78, s64, 111744
    buffer_load_dwordx4 v73, s[8:11], s78 offen nt lds
    s_waitcnt lgkmcnt(0)
L_qw_183:
    v_pk_add_f32 v[12:13], v[26:27], v[30:31]
    v_pk_add_f32 v[14:15], v[28:29], v[32:33]
    s_nop 0
    v_permlane32_swap_b32 v12, v13
    v_permlane32_swap_b32 v14, v15
    v_add_f32 v12, v12, v13
    v_add_f32 v14, v14, v15
    s_nop 1
    v_permlane16_swap_b32 v12, v14
    v_add_f32 v12, v12, v14
    v_mul_f32 v5, 0x3ae38e39, v12
    v_cmp_u_f32 vcc, v5, v5
    s_cbranch_vccnz L_retry_184
    v_mov_b32 v6, v5
    s_nop 1
    v_permlane16_swap_b32 v5, v6
    v_pk_add_f32 v[12:13], v[40:41], v[44:45]
    v_pk_add_f32 v[14:15], v[42:43], v[46:47]
    s_nop 0
    v_permlane32_swap_b32 v12, v13
    v_permlane32_swap_b32 v14, v15
    v_add_f32 v12, v12, v13
    v_add_f32 v14, v14, v15
    s_nop 1
    v_permlane16_swap_b32 v12, v14
    v_add_f32 v12, v12, v14
    s_nop 0
    v_readlane_b32 s71, v12, 48
    v_readlane_b32 s72, v12, 16
    v_cmp_u_f32 vcc, v12, v12
    v_fma_f32 v13, -s71, v5, v12
    v_cvt_pk_bf16_f32 v13, v13, v13
    ds_write_b16 v22, v13
    s_cbranch_vccnz L_retry_185
    v_mov_b32 v14, 0x3ae38e39
    v_mul_f32 v15, s71, v14
    v_mul_f32 v14, s72, v14
    v_fma_f32 v14, -v15, v15, v14
    v_max_f32 v14, 0, v14
    v_add_f32 v14, 0x3727c5ac, v14
    v_rsq_f32 v14, v14
    s_waitcnt lgkmcnt(0)
    s_barrier
    ds_read_b128 v[48:51], v24
    ds_read_b128 v[52:55], v24 offset:128
    v_mul_f32 v14, 0x3e0293ee, v14
    s_nop 0
    v_readfirstlane_b32 s81, v14
    s_waitcnt lgkmcnt(0)
    v_mfma_f32_16x16x32_bf16 v[16:19], v[48:51], a[0:3], 0
    v_mfma_f32_16x16x32_bf16 v[16:19], v[52:55], a[4:7], v[16:19]
    v_mfma_f32_16x16x32_bf16 v[20:23], v[48:51], a[8:11], 0
    v_mfma_f32_16x16x32_bf16 v[20:23], v[52:55], a[12:15], v[20:23]
    v_mfma_f32_16x16x32_bf16 v[24:27], v[48:51], a[16:19], 0
    v_mfma_f32_16x16x32_bf16 v[24:27], v[52:55], a[20:23], v[24:27]
    v_mfma_f32_16x16x32_bf16 v[28:31], v[48:51], a[24:27], 0
    v_mfma_f32_16x16x32_bf16 v[28:31], v[52:55], a[28:31], v[28:31]
    s_nop 1
    v_add_f32_dpp v32, v17, v16 row_ror:8 row_mask:0x1 bank_mask:0x3
    v_mfma_f32_16x16x32_bf16 v[16:19], v[48:51], a[32:35], 0
    v_mfma_f32_16x16x32_bf16 v[16:19], v[52:55], a[36:39], v[16:19]
    v_add_f32_dpp v33, v21, v20 row_ror:8 row_mask:0x1 bank_mask:0x3
    v_mfma_f32_16x16x32_bf16 v[20:23], v[48:51], a[40:43], 0
    v_mfma_f32_16x16x32_bf16 v[20:23], v[52:55], a[44:47], v[20:23]
    v_add_f32_dpp v34, v25, v24 row_ror:8 row_mask:0x1 bank_mask:0x3
    v_mfma_f32_16x16x32_bf16 v[24:27], v[48:51], a[48:51], 0
    v_mfma_f32_16x16x32_bf16 v[24:27], v[52:55], a[52:55], v[24:27]
    v_add_f32_dpp v35, v29, v28 row_ror:8 row_mask:0x1 bank_mask:0x3
    v_mfma_f32_16x16x32_bf16 v[28:31], v[48:51], a[56:59], 0
    v_mfma_f32_16x16x32_bf16 v[28:31], v[52:55], a[60:63], v[28:31]
    v_add_f32_dpp v32, v16, v17 row_ror:8 row_mask:0x1 bank_mask:0xc
    v_mfma_f32_16x16x32_bf16 v[16:19], v[48:51], a[64:67], 0
    v_mfma_f32_16x16x32_bf16 v[16:19], v[52:55], a[68:71], v[16:19]
    v_add_f32_dpp v33, v20, v21 row_ror:8 row_mask:0x1 bank_mask:0xc
    v_mfma_f32_16x16x32_bf16 v[20:23], v[48:51], a[72:75], 0
    v_mfma_f32_16x16x32_bf16 v[20:23], v[52:55], a[76:79], v[20:23]
    v_add_f32_dpp v34, v24, v25 row_ror:8 row_mask:0x1 bank_mask:0xc
    v_mfma_f32_16x16x32_bf16 v[24:27], v[48:51], a[80:83], 0
    v_mfma_f32_16x16x32_bf16 v[24:27], v[52:55], a[84:87], v[24:27]
    v_add_f32_dpp v35, v28, v29 row_ror:8 row_mask:0x1 bank_mask:0xc
    v_mfma_f32_16x16x32_bf16 v[28:31], v[48:51], a[88:91], 0
    v_mfma_f32_16x16x32_bf16 v[28:31], v[52:55], a[92:95], v[28:31]
    v_add_f32_dpp v32, v17, v16 row_ror:8 row_mask:0x2 bank_mask:0x3
    v_mfma_f32_16x16x32_bf16 v[16:19], v[48:51], a[96:99], 0
    v_mfma_f32_16x16x32_bf16 v[16:19], v[52:55], a[100:103], v[16:19]
    v_add_f32_dpp v33, v21, v20 row_ror:8 row_mask:0x2 bank_mask:0x3
    v_mfma_f32_16x16x32_bf16 v[20:23], v[48:51], a[104:107], 0
    v_mfma_f32_16x16x32_bf16 v[20:23], v[52:55], a[108:111], v[20:23]
    v_add_f32_dpp v34, v25, v24 row_ror:8 row_mask:0x2 bank_mask:0x3
    v_mfma_f32_16x16x32_bf16 v[24:27], v[48:51], a[112:115], 0
    v_mfma_f32_16x16x32_bf16 v[24:27], v[52:55], a[116:119], v[24:27]
    v_add_f32_dpp v35, v29, v28 row_ror:8 row_mask:0x2 bank_mask:0x3
    v_mfma_f32_16x16x32_bf16 v[28:31], v[48:51], a[120:123], 0
    v_mfma_f32_16x16x32_bf16 v[28:31], v[52:55], a[124:127], v[28:31]
    v_add_f32_dpp v32, v16, v17 row_ror:8 row_mask:0x2 bank_mask:0xc
    v_mfma_f32_16x16x32_bf16 v[16:19], v[48:51], a[128:131], 0
    v_mfma_f32_16x16x32_bf16 v[16:19], v[52:55], a[132:135], v[16:19]
    v_add_f32_dpp v33, v20, v21 row_ror:8 row_mask:0x2 bank_mask:0xc
    v_mfma_f32_16x16x32_bf16 v[20:23], v[48:51], a[136:139], 0
    v_mfma_f32_16x16x32_bf16 v[20:23], v[52:55], a[140:143], v[20:23]
    v_add_f32_dpp v34, v24, v25 row_ror:8 row_mask:0x2 bank_mask:0xc
    v_mfma_f32_16x16x32_bf16 v[24:27], v[48:51], a[144:147], 0
    v_mfma_f32_16x16x32_bf16 v[24:27], v[52:55], a[148:151], v[24:27]
    v_add_f32_dpp v35, v28, v29 row_ror:8 row_mask:0x2 bank_mask:0xc
    v_mfma_f32_16x16x32_bf16 v[28:31], v[48:51], a[152:155], 0
    v_mfma_f32_16x16x32_bf16 v[28:31], v[52:55], a[156:159], v[28:31]
    v_add_f32_dpp v32, v17, v16 row_ror:8 row_mask:0x4 bank_mask:0x3
    v_mfma_f32_16x16x32_bf16 v[16:19], v[48:51], a[160:163], 0
    v_mfma_f32_16x16x32_bf16 v[16:19], v[52:55], a[164:167], v[16:19]
    v_add_f32_dpp v33, v21, v20 row_ror:8 row_mask:0x4 bank_mask:0x3
    v_mfma_f32_16x16x32_bf16 v[20:23], v[48:51], a[168:171], 0
    v_mfma_f32_16x16x32_bf16 v[20:23], v[52:55], a[172:175], v[20:23]
    v_add_f32_dpp v34, v25, v24 row_ror:8 row_mask:0x4 bank_mask:0x3
    v_mfma_f32_16x16x32_bf16 v[24:27], v[48:51], a[176:179], 0
    v_mfma_f32_16x16x32_bf16 v[24:27], v[52:55], a[180:183], v[24:27]
    v_add_f32_dpp v35, v29, v28 row_ror:8 row_mask:0x4 bank_mask:0x3
    v_mfma_f32_16x16x32_bf16 v[28:31], v[48:51], a[184:187], 0
    v_mfma_f32_16x16x32_bf16 v[28:31], v[52:55], a[188:191], v[28:31]
    v_add_f32_dpp v32, v16, v17 row_ror:8 row_mask:0x4 bank_mask:0xc
    v_mfma_f32_16x16x32_bf16 v[16:19], v[48:51], a[192:195], 0
    v_mfma_f32_16x16x32_bf16 v[16:19], v[52:55], a[196:199], v[16:19]
    v_add_f32_dpp v33, v20, v21 row_ror:8 row_mask:0x4 bank_mask:0xc
    v_mfma_f32_16x16x32_bf16 v[20:23], v[48:51], a[200:203], 0
    v_mfma_f32_16x16x32_bf16 v[20:23], v[52:55], a[204:207], v[20:23]
    v_add_f32_dpp v34, v24, v25 row_ror:8 row_mask:0x4 bank_mask:0xc
    v_mfma_f32_16x16x32_bf16 v[24:27], v[48:51], a[208:211], 0
    v_mfma_f32_16x16x32_bf16 v[24:27], v[52:55], a[212:215], v[24:27]
    v_add_f32_dpp v35, v28, v29 row_ror:8 row_mask:0x4 bank_mask:0xc
    v_mfma_f32_16x16x32_bf16 v[28:31], v[48:51], a[216:219], 0
    v_mfma_f32_16x16x32_bf16 v[28:31], v[52:55], a[220:223], v[28:31]
    v_add_f32_dpp v32, v17, v16 row_ror:8 row_mask:0x8 bank_mask:0x3
    v_mfma_f32_16x16x32_bf16 v[16:19], v[48:51], a[224:227], 0
    v_mfma_f32_16x16x32_bf16 v[16:19], v[52:55], a[228:231], v[16:19]
    v_add_f32_dpp v33, v21, v20 row_ror:8 row_mask:0x8 bank_mask:0x3
    v_mfma_f32_16x16x32_bf16 v[20:23], v[48:51], a[232:235], 0
    v_mfma_f32_16x16x32_bf16 v[20:23], v[52:55], a[236:239], v[20:23]
    v_add_f32_dpp v34, v25, v24 row_ror:8 row_mask:0x8 bank_mask:0x3
    v_mfma_f32_16x16x32_bf16 v[24:27], v[48:51], a[240:243], 0
    v_mfma_f32_16x16x32_bf16 v[24:27], v[52:55], a[244:247], v[24:27]
    v_add_f32_dpp v35, v29, v28 row_ror:8 row_mask:0x8 bank_mask:0x3
    v_mfma_f32_16x16x32_bf16 v[28:31], v[48:51], a[248:251], 0
    v_mfma_f32_16x16x32_bf16 v[28:31], v[52:55], a[252:255], v[28:31]
    v_add_f32_dpp v32, v16, v17 row_ror:8 row_mask:0x8 bank_mask:0xc
    s_nop 0
    v_add_f32_dpp v33, v20, v21 row_ror:8 row_mask:0x8 bank_mask:0xc
    s_nop 1
    v_add_f32_dpp v34, v24, v25 row_ror:8 row_mask:0x8 bank_mask:0xc
    s_nop 1
    v_add_f32_dpp v35, v28, v29 row_ror:8 row_mask:0x8 bank_mask:0xc
    v_max3_f32 v36, v32, v33, v34
    v_max_f32 v36, v36, v35
    v_mul_f32 v32, s81, v32
    v_mul_f32 v33, s81, v33
    v_max_f32_dpp v36, v36, v36 quad_perm:[1,0,3,2] row_mask:0xf bank_mask:0xf
    v_mul_f32 v34, s81, v34
    v_mul_f32 v35, s81, v35
    v_max_f32_dpp v36, v36, v36 quad_perm:[2,3,0,1] row_mask:0xf bank_mask:0xf
    v_lshl_add_u32 v38, v0, 3, s88
    v_lshrrev_b32 v78, 4, v0
    v_max_f32_dpp v36, v36, v36 row_half_mirror row_mask:0xf bank_mask:0xf
    v_lshl_add_u32 v78, v78, 4, s88
    s_nop 0
    v_max_f32_dpp v36, v36, v36 row_mirror row_mask:0xf bank_mask:0xf
    s_nop 1
    v_max_f32_dpp v36, v36, v36 row_bcast:15 row_mask:0xa bank_mask:0xf
    s_nop 1
    v_max_f32_dpp v36, v36, v36 row_bcast:31 row_mask:0xc bank_mask:0xf
    v_mul_f32 v36, s81, v36
    s_nop 0
    v_readlane_b32 s75, v36, 63
    s_nop 1
    v_subrev_f32 v32, s75, v32
    v_subrev_f32 v33, s75, v33
    v_subrev_f32 v34, s75, v34
    v_subrev_f32 v35, s75, v35
    v_exp_f32 v32, v32
    v_exp_f32 v33, v33
    v_exp_f32 v34, v34
    v_exp_f32 v35, v35
    v_cvt_pk_bf16_f32 v36, v32, v33
    v_cvt_pk_bf16_f32 v37, v34, v35
    ds_write_b64 v38, v[36:37] offset:512
    v_add_f32 v32, v32, v33
    v_add_f32 v34, v34, v35
    v_add_f32 v33, v32, v34
    v_mov_b32 v32, s75
    s_lshl_b32 s70, s3, 3
    v_add_f32_dpp v33, v33, v33 quad_perm:[1,0,3,2] row_mask:0xf bank_mask:0xf
    s_add_u32 s70, s70, 151296
    v_mov_b32 v34, s70
    v_add_f32_dpp v33, v33, v33 quad_perm:[2,3,0,1] row_mask:0xf bank_mask:0xf
    s_nop 1
    v_add_f32_dpp v33, v33, v33 row_half_mirror row_mask:0xf bank_mask:0xf
    s_nop 1
    v_add_f32_dpp v33, v33, v33 row_mirror row_mask:0xf bank_mask:0xf
    s_nop 1
    v_add_f32_dpp v33, v33, v33 row_bcast:15 row_mask:0xa bank_mask:0xf
    s_nop 1
    v_add_f32_dpp v33, v33, v33 row_bcast:31 row_mask:0xc bank_mask:0xf
    s_nop 0
    v_readlane_b32 s71, v33, 63
    s_nop 1
    v_mov_b32 v33, s71
    ds_write_b64 v34, v[32:33]
    ds_read_b128 v[16:19], v78 offset:512
    ds_read_b128 v[74:77], v78 offset:576
    s_waitcnt lgkmcnt(0)
    v_mfma_f32_16x16x32_bf16 v[40:43], v[16:19], v[80:83], 0
    v_mfma_f32_16x16x32_bf16 v[44:47], v[16:19], v[88:91], 0
    v_mfma_f32_16x16x32_bf16 v[48:51], v[16:19], v[96:99], 0
    v_mfma_f32_16x16x32_bf16 v[52:55], v[16:19], v[104:107], 0
    v_mfma_f32_16x16x32_bf16 v[56:59], v[16:19], v[112:115], 0
    v_mfma_f32_16x16x32_bf16 v[60:63], v[16:19], v[120:123], 0
    v_mfma_f32_16x16x32_bf16 v[64:67], v[16:19], v[128:131], 0
    v_mfma_f32_16x16x32_bf16 v[68:71], v[16:19], v[136:139], 0
    v_mfma_f32_16x16x32_bf16 v[40:43], v[74:77], v[84:87], v[40:43]
    v_mfma_f32_16x16x32_bf16 v[44:47], v[74:77], v[92:95], v[44:47]
    v_mfma_f32_16x16x32_bf16 v[48:51], v[74:77], v[100:103], v[48:51]
    v_mfma_f32_16x16x32_bf16 v[52:55], v[74:77], v[108:111], v[52:55]
    v_mfma_f32_16x16x32_bf16 v[56:59], v[74:77], v[116:119], v[56:59]
    v_mfma_f32_16x16x32_bf16 v[60:63], v[74:77], v[124:127], v[60:63]
    v_mfma_f32_16x16x32_bf16 v[64:67], v[74:77], v[132:135], v[64:67]
    v_mfma_f32_16x16x32_bf16 v[68:71], v[74:77], v[140:143], v[68:71]
    s_waitcnt vmcnt(12)
    ds_read_b128 v[74:77], v78 offset:640
    ds_read_b64_tr_b16 v[144:145], v3 offset:12288
    ds_read_b64_tr_b16 v[146:147], v3 offset:13312
    ds_read_b64_tr_b16 v[152:153], v79 offset:12288
    ds_read_b64_tr_b16 v[154:155], v79 offset:13312
    ds_read_b64_tr_b16 v[160:161], v3 offset:12800
    ds_read_b64_tr_b16 v[162:163], v3 offset:13824
    ds_read_b64_tr_b16 v[168:169], v79 offset:12800
    ds_read_b64_tr_b16 v[170:171], v79 offset:13824
    v_bfe_u32 v16, v0, 4, 1
    v_bfe_u32 v17, v0, 2, 2
    v_lshl_add_u32 v16, v16, 3, v17
    v_mul_u32_u24 v16, 1152, v16
    v_lshrrev_b32 v17, 5, v0
    v_lshl_add_u32 v16, v17, 6, v16
    v_bfe_u32 v17, v0, 4, 1
    v_lshlrev_b32 v17, 1, v17
    v_xor_b32 v17, v0, v17
    v_and_b32 v17, 3, v17
    v_lshl_add_u32 v16, v17, 4, v16
    s_and_b32 s90, s3, 1
    s_mul_i32 s90, s90, 18368
    s_add_u32 s90, s90, s68
    v_add_u32 v16, s90, v16
    s_add_u32 m0, s66, 6144
    s_add_u32 s91, s99, 0
    buffer_load_dwordx4 v16, s[16:19], s91 offen  lds
    s_add_u32 m0, s66, 7168
    s_add_u32 s91, s99, 4608
    buffer_load_dwordx4 v16, s[16:19], s91 offen  lds
    s_add_u32 m0, s66, 8192
    s_add_u32 s91, s99, 36864
    buffer_load_dwordx4 v16, s[16:19], s91 offen  lds
    s_add_u32 m0, s66, 9216
    s_add_u32 s91, s99, 41472
    buffer_load_dwordx4 v16, s[16:19], s91 offen  lds
    s_add_u32 m0, s66, 10240
    s_add_u32 s91, s99, 73728
    buffer_load_dwordx4 v16, s[16:19], s91 offen  lds
    s_add_u32 m0, s66, 11264
    s_add_u32 s91, s99, 78336
    buffer_load_dwordx4 v16, s[16:19], s91 offen  lds
    s_add_u32 m0, s66, 12288
    s_add_u32 s91, s99, 110592
    buffer_load_dwordx4 v16, s[16:19], s91 offen  lds
    s_add_u32 m0, s66, 13312
    s_add_u32 s91, s99, 115200
    buffer_load_dwordx4 v16, s[16:19], s91 offen  lds
    s_waitcnt lgkmcnt(0)
    v_mfma_f32_16x16x32_bf16 v[40:43], v[74:77], v[144:147], v[40:43]
    v_mfma_f32_16x16x32_bf16 v[44:47], v[74:77], v[152:155], v[44:47]
    v_mfma_f32_16x16x32_bf16 v[48:51], v[74:77], v[160:163], v[48:51]
    v_mfma_f32_16x16x32_bf16 v[52:55], v[74:77], v[168:171], v[52:55]
    s_waitcnt vmcnt(16)
    ds_read_b64_tr_b16 v[176:177], v3 offset:16384
    ds_read_b64_tr_b16 v[178:179], v3 offset:17408
    ds_read_b64_tr_b16 v[184:185], v79 offset:16384
    ds_read_b64_tr_b16 v[186:187], v79 offset:17408
    ds_read_b64_tr_b16 v[192:193], v3 offset:16896
    ds_read_b64_tr_b16 v[194:195], v3 offset:17920
    ds_read_b64_tr_b16 v[200:201], v79 offset:16896
    ds_read_b64_tr_b16 v[202:203], v79 offset:17920
    s_and_b32 s70, s60, 3
    s_add_u32 s70, s70, 1
    s_lshl_b32 s70, s70, 7
    v_lshrrev_b32 v28, 5, v0
    v_mul_u32_u24 v28, s70, v28
    v_add_u32 v28, 499712, v28
    buffer_load_dword v29, v28, s[40:43], 0 offen sc1
    s_waitcnt lgkmcnt(0)
    v_mfma_f32_16x16x32_bf16 v[56:59], v[74:77], v[176:179], v[56:59]
    v_mfma_f32_16x16x32_bf16 v[60:63], v[74:77], v[184:187], v[60:63]
    v_mfma_f32_16x16x32_bf16 v[64:67], v[74:77], v[192:195], v[64:67]
    v_mfma_f32_16x16x32_bf16 v[68:71], v[74:77], v[200:203], v[68:71]
    s_waitcnt vmcnt(15)
    s_cmp_lg_u32 s101, 0
    s_cbranch_scc1 L_lag_186
    s_waitcnt vmcnt(13)
L_lag_186:
    s_add_u32 m0, s65, 8192
    s_xor_b32 s78, s64, 262144
    buffer_load_dwordx4 v73, s[8:11], s78 offen nt lds
    s_add_u32 m0, s65, 9216
    s_xor_b32 s78, s64, 327680
    buffer_load_dwordx4 v73, s[8:11], s78 offen nt lds
    s_waitcnt vmcnt(15)
    ds_read_b128 v[74:77], v78 offset:704
    ds_read_b64_tr_b16 v[148:149], v3 offset:0
    ds_read_b64_tr_b16 v[150:151], v3 offset:1024
    ds_read_b64_tr_b16 v[156:157], v79 offset:0
    ds_read_b64_tr_b16 v[158:159], v79 offset:1024
    ds_read_b64_tr_b16 v[164:165], v3 offset:512
    ds_read_b64_tr_b16 v[166:167], v3 offset:1536
    ds_read_b64_tr_b16 v[172:173], v79 offset:512
    ds_read_b64_tr_b16 v[174:175], v79 offset:1536
    s_cmp_lg_u32 s101, 0
    s_cbranch_scc1 L_lag_187
    s_waitcnt vmcnt(13)
L_lag_187:
    s_add_u32 m0, s65, 10240
    s_xor_b32 s78, s64, 266240
    buffer_load_dwordx4 v73, s[8:11], s78 offen nt lds
    s_add_u32 m0, s65, 11264
    s_xor_b32 s78, s64, 331776
    buffer_load_dwordx4 v73, s[8:11], s78 offen nt lds
    s_waitcnt lgkmcnt(0)
    v_mfma_f32_16x16x32_bf16 v[40:43], v[74:77], v[148:151], v[40:43]
    v_mfma_f32_16x16x32_bf16 v[44:47], v[74:77], v[156:159], v[44:47]
    v_mfma_f32_16x16x32_bf16 v[48:51], v[74:77], v[164:167], v[48:51]
    v_mfma_f32_16x16x32_bf16 v[52:55], v[74:77], v[172:175], v[52:55]
    s_waitcnt vmcnt(15)
    s_cmp_lg_u32 s101, 0
    s_cbranch_scc1 L_lag_188
    s_waitcnt vmcnt(13)
L_lag_188:
    s_add_u32 m0, s65, 12288
    s_xor_b32 s78, s64, 262272
    buffer_load_dwordx4 v73, s[8:11], s78 offen nt lds
    s_add_u32 m0, s65, 13312
    s_xor_b32 s78, s64, 327808
    buffer_load_dwordx4 v73, s[8:11], s78 offen nt lds
    s_waitcnt vmcnt(15)
    ds_read_b64_tr_b16 v[180:181], v3 offset:4096
    ds_read_b64_tr_b16 v[182:183], v3 offset:5120
    ds_read_b64_tr_b16 v[188:189], v79 offset:4096
    ds_read_b64_tr_b16 v[190:191], v79 offset:5120
    ds_read_b64_tr_b16 v[196:197], v3 offset:4608
    ds_read_b64_tr_b16 v[198:199], v3 offset:5632
    ds_read_b64_tr_b16 v[204:205], v79 offset:4608
    ds_read_b64_tr_b16 v[206:207], v79 offset:5632
    s_cmp_lg_u32 s101, 0
    s_cbranch_scc1 L_lag_189
    s_waitcnt vmcnt(4)
L_lag_189:
    s_add_u32 m0, s65, 14336
    s_xor_b32 s78, s64, 266368
    buffer_load_dwordx4 v73, s[8:11], s78 offen nt lds
    s_add_u32 m0, s65, 15360
    s_xor_b32 s78, s64, 331904
    buffer_load_dwordx4 v73, s[8:11], s78 offen nt lds
    s_waitcnt lgkmcnt(0)
    v_mfma_f32_16x16x32_bf16 v[56:59], v[74:77], v[180:183], v[56:59]
    v_mfma_f32_16x16x32_bf16 v[60:63], v[74:77], v[188:191], v[60:63]
    v_mfma_f32_16x16x32_bf16 v[64:67], v[74:77], v[196:199], v[64:67]
    v_mfma_f32_16x16x32_bf16 v[68:71], v[74:77], v[204:207], v[68:71]
    s_waitcnt vmcnt(6)
    s_cmp_lg_u32 s101, 0
    s_cbranch_scc1 L_lag_190
    s_waitcnt vmcnt(4)
L_lag_190:
    s_add_u32 m0, s65, 16384
    s_xor_b32 s78, s64, 303104
    buffer_load_dwordx4 v73, s[8:11], s78 offen nt lds
    s_add_u32 m0, s65, 17408
    s_xor_b32 s78, s64, 368640
    buffer_load_dwordx4 v73, s[8:11], s78 offen nt lds
    s_waitcnt vmcnt(6)
    ds_read_b128 v[74:77], v78 offset:768
    ds_read_b64_tr_b16 v[208:209], v3 offset:8192
    ds_read_b64_tr_b16 v[210:211], v3 offset:9216
    ds_read_b64_tr_b16 v[216:217], v79 offset:8192
    ds_read_b64_tr_b16 v[218:219], v79 offset:9216
    ds_read_b64_tr_b16 v[224:225], v3 offset:8704
    ds_read_b64_tr_b16 v[226:227], v3 offset:9728
    ds_read_b64_tr_b16 v[232:233], v79 offset:8704
    ds_read_b64_tr_b16 v[234:235], v79 offset:9728
    s_mov_b32 s80, 0
L_pz_191:
    v_cmp_eq_u32 vcc, -1, v29
    s_cbranch_vccnz L_retry_192
    v_and_b32 v29, 0x2000, v29
    s_nop 0
    v_readlane_b32 s70, v29, 0
    v_readlane_b32 s71, v29, 32
    s_xor_b32 s52, s52, s70
    s_xor_b32 s53, s53, s70
    s_xor_b32 s54, s54, s70
    s_xor_b32 s47, s47, s70
    s_xor_b32 s0, s0, s70
    s_xor_b32 s93, s93, s71
    s_lshr_b32 s71, s71, 11
    s_xor_b32 s55, s55, s71
    s_add_u32 m0, s65, 18432
    s_xor_b32 s78, s64, 307200
    buffer_load_dwordx4 v73, s[8:11], s78 offen nt lds
    s_add_u32 m0, s65, 19456
    s_xor_b32 s78, s64, 372736
    buffer_load_dwordx4 v73, s[8:11], s78 offen nt lds
    s_add_u32 m0, s65, 0
    s_xor_b32 s78, s64, 303232
    buffer_load_dwordx4 v73, s[8:11], s78 offen nt lds
    s_add_u32 m0, s65, 1024
    s_xor_b32 s78, s64, 368768
    buffer_load_dwordx4 v73, s[8:11], s78 offen nt lds
    s_add_u32 m0, s65, 2048
    s_xor_b32 s78, s64, 307328
    buffer_load_dwordx4 v73, s[8:11], s78 offen nt lds
    s_add_u32 m0, s65, 3072
    s_xor_b32 s78, s64, 372864
    buffer_load_dwordx4 v73, s[8:11], s78 offen nt lds
    s_waitcnt lgkmcnt(0)
    v_mfma_f32_16x16x32_bf16 v[40:43], v[74:77], v[208:211], v[40:43]
    v_mfma_f32_16x16x32_bf16 v[44:47], v[74:77], v[216:219], v[44:47]
    v_mfma_f32_16x16x32_bf16 v[48:51], v[74:77], v[224:227], v[48:51]
    v_mfma_f32_16x16x32_bf16 v[52:55], v[74:77], v[232:235], v[52:55]
    s_barrier
    v_mov_b32 v34, 151296
    ds_read_b128 v[8:11], v34
    ds_read_b128 v[12:15], v34 offset:16
    v_lshrrev_b32 v38, 2, v0
    v_and_b32 v39, 3, v0
    v_lshlrev_b32 v39, 2, v39
    v_lshl_add_u32 v38, v38, 7, v39
    s_lshl_b32 s70, s63, 3
    s_sub_u32 s70, 2048, s70
    s_add_u32 s70, s70, s89
    v_mov_b32 v39, 1073741824
    v_writelane_b32 v39, s70, 0
    s_add_u32 s73, s45, s59
    s_add_u32 s73, s73, 0
    v_and_b32 v34, 15, v0
    v_lshrrev_b32 v35, 4, v0
    v_mul_u32_u24 v35, 576, v35
    v_lshl_add_u32 v34, v34, 2, v35
    s_add_u32 s70, s88, 1024
    v_add_u32 v34, s70, v34
    v_lshlrev_b32 v35, 3, v0
    v_add_u32 v35, 148480, v35
    s_waitcnt lgkmcnt(0)
    v_max3_f32 v36, v8, v10, v12
    v_max_f32 v36, v36, v14
    v_sub_f32 v8, v8, v36
    v_sub_f32 v10, v10, v36
    v_exp_f32 v8, v8
    v_sub_f32 v12, v12, v36
    v_exp_f32 v10, v10
    v_sub_f32 v14, v14, v36
    v_exp_f32 v12, v12
    v_mul_f32 v37, v8, v9
    v_exp_f32 v14, v14
    v_fmac_f32 v37, v10, v11
    v_fmac_f32 v37, v12, v13
    v_fmac_f32 v37, v14, v15
    buffer_store_dwordx2 v[36:37], v39, s[40:43], s73 offen sc1
    v_mov_b32 v16, -1
    v_mov_b32 v17, -1
    v_mov_b32 v18, -1
    v_mov_b32 v19, -1
    v_lshlrev_b32 v20, 4, v0
    s_lshl_b32 s90, s61, 2
    s_add_u32 s90, s90, s3
    s_mul_i32 s91, s90, 640
    s_add_u32 s91, s91, s58
    s_mov_b32 exec_hi, 0xff
    buffer_store_dwordx4 v[16:19], v20, s[40:43], s91 offen sc1
    buffer_load_dword v72, v20, s[40:43], s91 offen sc1
    s_mov_b32 exec_hi, -1
    s_lshl_b32 s91, s90, 7
    s_add_u32 s91, s91, s58
    s_add_u32 s91, s91, s59
    v_mov_b32 v20, 0
    buffer_load_dword v72, v20, s[40:43], s91 offen sc1
    v_mov_b32 v20, s89
    buffer_load_dword v72, v20, s[40:43], s1 offen sc1
    s_waitcnt vmcnt(13)
    ds_read_b64_tr_b16 v[240:241], v3 offset:12288
    ds_read_b64_tr_b16 v[242:243], v3 offset:13312
    ds_read_b64_tr_b16 v[244:245], v79 offset:12288
    ds_read_b64_tr_b16 v[246:247], v79 offset:13312
    ds_read_b64_tr_b16 v[248:249], v3 offset:12800
    ds_read_b64_tr_b16 v[250:251], v3 offset:13824
    ds_read_b64_tr_b16 v[252:253], v79 offset:12800
    ds_read_b64_tr_b16 v[254:255], v79 offset:13824
    s_and_b32 s70, s69, 5
    s_cmp_eq_u32 s70, 5
    s_cselect_b32 s101, 1, 0
    s_waitcnt lgkmcnt(0)
    v_mfma_f32_16x16x32_bf16 v[56:59], v[74:77], v[240:243], v[56:59]
    v_mfma_f32_16x16x32_bf16 v[60:63], v[74:77], v[244:247], v[60:63]
    v_mfma_f32_16x16x32_bf16 v[64:67], v[74:77], v[248:251], v[64:67]
    v_mfma_f32_16x16x32_bf16 v[68:71], v[74:77], v[252:255], v[68:71]
    s_waitcnt vmcnt(11)
    s_cmp_lg_u32 s101, 0
    s_cbranch_scc1 L_lag_193
    s_waitcnt vmcnt(9)
L_lag_193:
    s_add_u32 m0, s65, 4096
    s_xor_b32 s78, s64, 263168
    buffer_load_dwordx4 v73, s[8:11], s78 offen nt lds
    s_add_u32 m0, s65, 5120
    s_xor_b32 s78, s64, 328704
    buffer_load_dwordx4 v73, s[8:11], s78 offen nt lds
    s_waitcnt vmcnt(11)
    ds_read_b128 v[74:77], v78 offset:832
    ds_read_b64_tr_b16 v[212:213], v3 offset:16384
    ds_read_b64_tr_b16 v[214:215], v3 offset:17408
    ds_read_b64_tr_b16 v[220:221], v79 offset:16384
    ds_read_b64_tr_b16 v[222:223], v79 offset:17408
    ds_read_b64_tr_b16 v[228:229], v3 offset:16896
    ds_read_b64_tr_b16 v[230:231], v3 offset:17920
    ds_read_b64_tr_b16 v[236:237], v79 offset:16896
    ds_read_b64_tr_b16 v[238:239], v79 offset:17920
    s_getpc_b64 s[56:57]
L_pc_194:
    s_lshl_b32 s90, s61, 2
    s_add_u32 s90, s90, s3
    s_lshl_b32 s90, s90, 8
    v_and_b32 v16, 1, v0
    v_lshl_add_u32 v16, v16, 7, s90
    v_min_u32 v16, L_end_slow-L_pc_194-4, v16
    v_mov_b32 v17, s57
    v_add_co_u32 v16, vcc, s56, v16
    s_nop 1
    v_addc_co_u32 v17, vcc, 0, v17, vcc
    global_load_dword v72, v[16:17], off
    s_cmp_lg_u32 s101, 0
    s_cbranch_scc1 L_lag_195
    s_waitcnt vmcnt(10)
L_lag_195:
    s_add_u32 m0, s65, 6144
    s_xor_b32 s78, s64, 267264
    buffer_load_dwordx4 v73, s[8:11], s78 offen nt lds
    s_add_u32 m0, s65, 7168
    s_xor_b32 s78, s64, 332800
    buffer_load_dwordx4 v73, s[8:11], s78 offen nt lds
    s_waitcnt lgkmcnt(0)
    v_mfma_f32_16x16x32_bf16 v[40:43], v[74:77], v[212:215], v[40:43]
    v_mfma_f32_16x16x32_bf16 v[44:47], v[74:77], v[220:223], v[44:47]
    v_mfma_f32_16x16x32_bf16 v[48:51], v[74:77], v[228:231], v[48:51]
    v_mfma_f32_16x16x32_bf16 v[52:55], v[74:77], v[236:239], v[52:55]
    s_waitcnt vmcnt(12)
    s_cmp_lg_u32 s101, 0
    s_cbranch_scc1 L_lag_196
    s_waitcnt vmcnt(10)
L_lag_196:
    s_add_u32 m0, s65, 8192
    s_xor_b32 s78, s64, 263296
    buffer_load_dwordx4 v73, s[8:11], s78 offen nt lds
    s_add_u32 m0, s65, 9216
    s_xor_b32 s78, s64, 328832
    buffer_load_dwordx4 v73, s[8:11], s78 offen nt lds
    s_waitcnt vmcnt(12)
    ds_read_b64_tr_b16 v[16:17], v3 offset:0
    ds_read_b64_tr_b16 v[18:19], v3 offset:1024
    ds_read_b64_tr_b16 v[20:21], v79 offset:0
    ds_read_b64_tr_b16 v[22:23], v79 offset:1024
    ds_read_b64_tr_b16 v[24:25], v3 offset:512
    ds_read_b64_tr_b16 v[26:27], v3 offset:1536
    ds_read_b64_tr_b16 v[28:29], v79 offset:512
    ds_read_b64_tr_b16 v[30:31], v79 offset:1536
    s_cmp_lg_u32 s101, 0
    s_cbranch_scc1 L_lag_197
    s_waitcnt vmcnt(5)
L_lag_197:
    s_add_u32 m0, s65, 10240
    s_xor_b32 s78, s64, 267392
    buffer_load_dwordx4 v73, s[8:11], s78 offen nt lds
    s_add_u32 m0, s65, 11264
    s_xor_b32 s78, s64, 332928
    buffer_load_dwordx4 v73, s[8:11], s78 offen nt lds
    s_waitcnt lgkmcnt(0)
    v_mfma_f32_16x16x32_bf16 v[56:59], v[74:77], v[16:19], v[56:59]
    v_mfma_f32_16x16x32_bf16 v[60:63], v[74:77], v[20:23], v[60:63]
    v_mfma_f32_16x16x32_bf16 v[64:67], v[74:77], v[24:27], v[64:67]
    v_mfma_f32_16x16x32_bf16 v[68:71], v[74:77], v[28:31], v[68:71]
    s_waitcnt vmcnt(7)
    s_cmp_lg_u32 s101, 0
    s_cbranch_scc1 L_lag_198
    s_waitcnt vmcnt(4)
L_lag_198:
    s_add_u32 m0, s65, 12288
    s_xor_b32 s78, s64, 304128
    buffer_load_dwordx4 v73, s[8:11], s78 offen nt lds
    s_add_u32 m0, s65, 13312
    s_xor_b32 s78, s64, 369664
    buffer_load_dwordx4 v73, s[8:11], s78 offen nt lds
    s_waitcnt vmcnt(6)
    ds_read_b128 v[74:77], v78 offset:896
    ds_read_b64_tr_b16 v[16:17], v3 offset:4096
    ds_read_b64_tr_b16 v[18:19], v3 offset:5120
    ds_read_b64_tr_b16 v[20:21], v79 offset:4096
    ds_read_b64_tr_b16 v[22:23], v79 offset:5120
    ds_read_b64_tr_b16 v[24:25], v3 offset:4608
    ds_read_b64_tr_b16 v[26:27], v3 offset:5632
    ds_read_b64_tr_b16 v[28:29], v79 offset:4608
    ds_read_b64_tr_b16 v[30:31], v79 offset:5632
    s_lshr_b32 s90, s61, 3
    s_lshl_b32 s90, s90, 1
    s_and_b32 s91, s61, 1
    s_add_u32 s90, s90, s91
    s_xor_b32 s92, s67, 1073741824
    s_lshl_b32 s90, s90, 2
    s_add_u32 s90, s90, s3
    s_mul_i32 s90, s90, 64
    v_min_u32 v32, 63, v0
    v_add_u32 v32, s90, v32
    v_min_u32 v32, 2047, v32
    v_lshrrev_b32 v33, 3, v32
    v_and_b32 v32, 7, v32
    v_lshlrev_b32 v32, 7, v32
    v_lshl_add_u32 v32, v33, 13, v32
    s_lshl_b32 s91, s60, 10
    v_add_u32 v32, s92, v32
    buffer_load_dword v72, v32, s[28:31], s91 offen
    v_and_b32 v32, 7, v0
    v_lshlrev_b32 v32, 4, v32
    v_bfe_u32 v33, v0, 3, 1
    v_lshl_add_u32 v32, v33, 9, v32
    v_lshrrev_b32 v33, 4, v0
    v_lshl_add_u32 v32, v33, 7, v32
    v_lshl_add_u32 v33, v33, 2, v0
    v_and_b32 v33, 7, v33
    v_lshlrev_b32 v33, 3, v33
    s_add_u32 s79, s46, s59
    s_add_u32 s79, s79, 0
    buffer_load_dwordx2 v[36:37], v33, s[40:43], s79 offen offset:2048 sc1
    s_cmp_lg_u32 s101, 0
    s_cbranch_scc1 L_lag_199
    s_waitcnt vmcnt(6)
L_lag_199:
    s_add_u32 m0, s65, 14336
    s_xor_b32 s78, s64, 308224
    buffer_load_dwordx4 v73, s[8:11], s78 offen nt lds
    s_add_u32 m0, s65, 15360
    s_xor_b32 s78, s64, 373760
    buffer_load_dwordx4 v73, s[8:11], s78 offen nt lds
    s_waitcnt lgkmcnt(0)
    v_mfma_f32_16x16x32_bf16 v[40:43], v[74:77], v[16:19], v[40:43]
    v_mfma_f32_16x16x32_bf16 v[44:47], v[74:77], v[20:23], v[44:47]
    v_mfma_f32_16x16x32_bf16 v[48:51], v[74:77], v[24:27], v[48:51]
    v_mfma_f32_16x16x32_bf16 v[52:55], v[74:77], v[28:31], v[52:55]
    s_waitcnt vmcnt(8)
    s_cmp_lg_u32 s101, 0
    s_cbranch_scc1 L_lag_200
    s_waitcnt vmcnt(6)
L_lag_200:
    s_add_u32 m0, s65, 16384
    s_xor_b32 s78, s64, 304256
    buffer_load_dwordx4 v73, s[8:11], s78 offen nt lds
    s_add_u32 m0, s65, 17408
    s_xor_b32 s78, s64, 369792
    buffer_load_dwordx4 v73, s[8:11], s78 offen nt lds
    s_waitcnt vmcnt(8)
    ds_read_b64_tr_b16 v[16:17], v3 offset:8192
    ds_read_b64_tr_b16 v[18:19], v3 offset:9216
    ds_read_b64_tr_b16 v[20:21], v79 offset:8192
    ds_read_b64_tr_b16 v[22:23], v79 offset:9216
    ds_read_b64_tr_b16 v[24:25], v3 offset:8704
    ds_read_b64_tr_b16 v[26:27], v3 offset:9728
    ds_read_b64_tr_b16 v[28:29], v79 offset:8704
    ds_read_b64_tr_b16 v[30:31], v79 offset:9728
    s_cmp_lg_u32 s101, 0
    s_cbranch_scc1 L_lag_201
    s_waitcnt vmcnt(6)
L_lag_201:
    s_add_u32 m0, s65, 18432
    s_xor_b32 s78, s64, 308352
    buffer_load_dwordx4 v73, s[8:11], s78 offen nt lds
    s_add_u32 m0, s65, 19456
    s_xor_b32 s78, s64, 373888
    buffer_load_dwordx4 v73, s[8:11], s78 offen nt lds
    s_waitcnt lgkmcnt(0)
    v_mfma_f32_16x16x32_bf16 v[56:59], v[74:77], v[16:19], v[56:59]
    v_mfma_f32_16x16x32_bf16 v[60:63], v[74:77], v[20:23], v[60:63]
    v_mfma_f32_16x16x32_bf16 v[64:67], v[74:77], v[24:27], v[64:67]
    v_mfma_f32_16x16x32_bf16 v[68:71], v[74:77], v[28:31], v[68:71]
    s_waitcnt vmcnt(4)
    ds_read_b128 v[74:77], v78 offset:960
    ds_read_b64_tr_b16 v[16:17], v3 offset:12288
    ds_read_b64_tr_b16 v[18:19], v3 offset:13312
    ds_read_b64_tr_b16 v[20:21], v79 offset:12288
    ds_read_b64_tr_b16 v[22:23], v79 offset:13312
    ds_read_b64_tr_b16 v[24:25], v3 offset:12800
    ds_read_b64_tr_b16 v[26:27], v3 offset:13824
    ds_read_b64_tr_b16 v[28:29], v79 offset:12800
    ds_read_b64_tr_b16 v[30:31], v79 offset:13824
    v_max_f32_dpp v9, v36, v36 row_ror:1 row_mask:0xf bank_mask:0xf
    s_nop 1
    v_max_f32_dpp v9, v9, v9 row_ror:2 row_mask:0xf bank_mask:0xf
    s_nop 1
    v_max_f32_dpp v9, v9, v9 row_ror:4 row_mask:0xf bank_mask:0xf
    v_sub_f32 v9, v36, v9
    v_exp_f32 v9, v9
    s_nop 0
    v_mul_f32 v11, v9, v37
    s_nop 1
    v_add_f32_dpp v11, v11, v11 row_ror:1 row_mask:0xf bank_mask:0xf
    s_nop 1
    v_add_f32_dpp v11, v11, v11 row_ror:2 row_mask:0xf bank_mask:0xf
    s_nop 1
    v_add_f32_dpp v11, v11, v11 row_ror:4 row_mask:0xf bank_mask:0xf
    v_rcp_f32 v11, v11
    s_nop 0
    v_mul_f32 v9, v9, v11
    s_nop 1
    v_mov_b32_dpp v36, v9 row_newbcast:0 row_mask:0xf bank_mask:0xf
    v_mov_b32_dpp v37, v9 row_newbcast:1 row_mask:0xf bank_mask:0xf
    v_mov_b32_dpp v72, v9 row_newbcast:2 row_mask:0xf bank_mask:0xf
    v_mov_b32_dpp v73, v9 row_newbcast:3 row_mask:0xf bank_mask:0xf
    s_waitcnt lgkmcnt(0)
    v_mfma_f32_16x16x32_bf16 v[40:43], v[74:77], v[16:19], v[40:43]
    v_mfma_f32_16x16x32_bf16 v[44:47], v[74:77], v[20:23], v[44:47]
    v_mfma_f32_16x16x32_bf16 v[48:51], v[74:77], v[24:27], v[48:51]
    v_mfma_f32_16x16x32_bf16 v[52:55], v[74:77], v[28:31], v[52:55]
    s_waitcnt vmcnt(0)
    ds_read_b64_tr_b16 v[16:17], v3 offset:16384
    ds_read_b64_tr_b16 v[18:19], v3 offset:17408
    ds_read_b64_tr_b16 v[20:21], v79 offset:16384
    ds_read_b64_tr_b16 v[22:23], v79 offset:17408
    ds_read_b64_tr_b16 v[24:25], v3 offset:16896
    ds_read_b64_tr_b16 v[26:27], v3 offset:17920
    ds_read_b64_tr_b16 v[28:29], v79 offset:16896
    ds_read_b64_tr_b16 v[30:31], v79 offset:17920
    s_waitcnt lgkmcnt(6)
    v_mfma_f32_16x16x32_bf16 v[56:59], v[74:77], v[16:19], v[56:59]
    s_waitcnt lgkmcnt(4)
    v_mfma_f32_16x16x32_bf16 v[60:63], v[74:77], v[20:23], v[60:63]
    s_waitcnt lgkmcnt(2)
    v_mfma_f32_16x16x32_bf16 v[64:67], v[74:77], v[24:27], v[64:67]
    s_waitcnt lgkmcnt(0)
    v_mfma_f32_16x16x32_bf16 v[68:71], v[74:77], v[28:31], v[68:71]
    ds_write2_b32 v34, v40, v44 offset0:0 offset1:16
    ds_write2_b32 v34, v48, v52 offset0:32 offset1:48
    v_mov_b32 v24, -1
    v_mov_b32 v25, -1
    v_mov_b32 v26, -1
    v_mov_b32 v27, -1
    ds_write2_b32 v34, v56, v60 offset0:64 offset1:80
    v_mov_b32 v28, -1
    ds_write2_b32 v34, v64, v68 offset0:96 offset1:112
    v_mov_b32 v29, -1
    v_mov_b32 v30, -1
    v_mov_b32 v31, -1
    s_cmp_lg_u32 s3, 0
    s_waitcnt lgkmcnt(0)
    s_barrier
    s_cbranch_scc1 L_skip_202
    ds_read_b64 v[16:17], v35
    ds_read_b64 v[18:19], v35 offset:4096
    ds_read_b64 v[20:21], v35 offset:8192
    ds_read_b64 v[22:23], v35 offset:12288
    s_waitcnt lgkmcnt(3)
    v_pk_mul_f32 v[16:17], v[16:17], v[8:9] op_sel_hi:[1,0]
    s_waitcnt lgkmcnt(2)
    v_pk_fma_f32 v[16:17], v[18:19], v[10:11], v[16:17] op_sel_hi:[1,0,1]
    s_waitcnt lgkmcnt(1)
    v_pk_fma_f32 v[16:17], v[20:21], v[12:13], v[16:17] op_sel_hi:[1,0,1]
    s_waitcnt lgkmcnt(0)
    v_pk_fma_f32 v[16:17], v[22:23], v[14:15], v[16:17] op_sel_hi:[1,0,1]
    v_cvt_pk_bf16_f32 v16, v16, v17
    buffer_store_dword v16, v38, s[40:43], s73 offen sc1
L_skip_202:
    s_cmp_ge_u32 s61, 18
    s_cbranch_scc1 L_idle_203
    buffer_load_dwordx4 v[24:27], v32, s[40:43], s79 offen offset:0 sc1
    buffer_load_dwordx4 v[28:31], v32, s[40:43], s79 offen offset:1024 sc1
    v_lshrrev_b32 v18, 5, v0
    s_add_u32 s70, s88, 3584
    v_lshl_add_u32 v78, v0, 2, s70
    s_and_b32 s90, s3, 1
    s_mov_b32 s71, 151040
    v_and_b32 v74, 7, v0
    v_subrev_u32 v18, s90, v18
    v_lshlrev_b32 v74, 4, v74
    v_bfe_u32 v79, v0, 2, 1
    v_mul_i32_i24 v18, 15872, v18
    v_lshl_add_u32 v79, v79, 7, v74
    v_bfe_u32 v75, v0, 4, 1
    v_add_u32 v18, v18, v2
    v_lshl_add_u32 v75, v75, 13, v74
    v_bfe_u32 v8, v0, 3, 1
    v_xor_b32 v19, 32, v18
    v_lshl_add_u32 v75, v8, 11, v75
    v_lshl_add_u32 v74, v8, 8, v74
    ds_read_b64_tr_b16 v[40:41], v18 offset:6144
    v_lshlrev_b32 v8, 12, v8
    v_add3_u32 v79, v79, v8, s71
    ds_read_b64_tr_b16 v[42:43], v18 offset:7168
    s_and_b32 s70, s61, 30
    buffer_load_dwordx4 v[24:27], v32, s[40:43], s79 offen offset:0 sc1
    buffer_load_dwordx4 v[28:31], v32, s[40:43], s79 offen offset:1024 sc1
    s_add_u32 s73, s70, 0
    ds_read_b64_tr_b16 v[44:45], v19 offset:6144
    s_and_b32 s71, s73, -4
    s_add_u32 s73, s73, s71
    ds_read_b64_tr_b16 v[46:47], v19 offset:7168
    s_lshl_b32 s73, s73, 11
    s_add_u32 s73, s73, 901120
    ds_read_b64_tr_b16 v[48:49], v18 offset:8192
    s_and_b32 s71, s61, 1
    s_lshl_b32 s69, s60, 1
    ds_read_b64_tr_b16 v[50:51], v18 offset:9216
    s_add_u32 s69, s69, s71
    s_lshl_b32 s69, s69, 7
    ds_read_b64_tr_b16 v[52:53], v19 offset:8192
    s_add_u32 s73, s73, s69
    s_add_u32 s70, s70, s61
    ds_read_b64_tr_b16 v[54:55], v19 offset:9216
    s_lshl_b32 s70, s70, 7
    s_add_u32 s69, s58, s70
    ds_read_b64_tr_b16 v[56:57], v18 offset:10240
    s_add_u32 s69, s69, s59
    s_add_u32 s69, s69, 8704
    ds_read_b64_tr_b16 v[58:59], v18 offset:11264
    ds_read_b64_tr_b16 v[60:61], v19 offset:10240
    ds_read_b64_tr_b16 v[62:63], v19 offset:11264
    ds_read_b64_tr_b16 v[64:65], v18 offset:12288
    ds_read_b64_tr_b16 v[66:67], v18 offset:13312
    ds_read_b64_tr_b16 v[68:69], v19 offset:12288
    ds_read_b64_tr_b16 v[70:71], v19 offset:13312
    s_mov_b32 s80, 0
L_mlw_205:
    v_cmp_u_f32 vcc, v36, v36
    s_cbranch_vccnz L_mlr_206
    v_bfe_u32 v76, v0, 2, 3
    v_lshlrev_b32 v76, 10, v76
    v_lshrrev_b32 v77, 5, v0
    v_lshl_add_u32 v76, v77, 6, v76
    v_bfe_u32 v77, v0, 4, 1
    v_lshlrev_b32 v77, 1, v77
    v_xor_b32 v77, v0, v77
    v_and_b32 v77, 3, v77
    v_lshl_add_u32 v76, v77, 4, v76
    s_mov_b32 s80, 0
L_spin_207:
    buffer_load_dwordx4 v[24:27], v32, s[40:43], s79 offen offset:0 sc1
    buffer_load_dwordx4 v[28:31], v32, s[40:43], s79 offen offset:1024 sc1
    s_add_u32 s80, s80, 1024
    s_cbranch_scc1 L_abort
    s_waitcnt vmcnt(2)
    v_cmp_u_f32 vcc, v27, v31
    s_cbranch_vccnz L_spin_207
    s_waitcnt lgkmcnt(0)
    v_mfma_f32_16x16x32_bf16 v[16:19], v[24:27], v[48:51], 0
    v_mfma_f32_16x16x32_bf16 v[16:19], v[28:31], v[64:67], v[16:19]
    v_mfma_f32_16x16x32_bf16 v[12:15], v[24:27], v[44:47], 0
    v_mfma_f32_16x16x32_bf16 v[12:15], v[28:31], v[60:63], v[12:15]
    v_mfma_f32_16x16x32_bf16 v[8:11], v[24:27], v[40:43], 0
    v_mfma_f32_16x16x32_bf16 v[8:11], v[28:31], v[56:59], v[8:11]
    v_mfma_f32_16x16x32_bf16 v[20:23], v[24:27], v[52:55], 0
    v_mfma_f32_16x16x32_bf16 v[20:23], v[28:31], v[68:71], v[20:23]
    s_nop 1
    v_pk_mul_f32 v[16:17], v[16:17], v[36:37]
    v_pk_fma_f32 v[16:17], v[18:19], v[72:73], v[16:17]
    v_add_f32 v16, v16, v17
    v_pk_mul_f32 v[12:13], v[12:13], v[36:37]
    v_pk_fma_f32 v[12:13], v[14:15], v[72:73], v[12:13]
    v_add_f32 v12, v12, v13
    v_pk_mul_f32 v[8:9], v[8:9], v[36:37]
    v_pk_fma_f32 v[8:9], v[10:11], v[72:73], v[8:9]
    v_add_f32 v8, v8, v9
    v_permlane32_swap_b32 v16, v12
    v_add_f32 v8, v8, v12
    v_pk_mul_f32 v[20:21], v[20:21], v[36:37]
    v_pk_fma_f32 v[20:21], v[22:23], v[72:73], v[20:21]
    v_add_f32 v20, v20, v21
    v_add_f32 v20, v20, v16
    s_nop 1
    v_permlane16_swap_b32 v8, v20
    v_add_f32 v34, v8, v20
    ds_write_b32 v78, v34
    v_cmp_u_f32 vcc, v34, v34
    s_cbranch_vccnz L_spin_207
    s_cmp_lg_u32 s3, 0
    s_waitcnt lgkmcnt(0)
    s_barrier
    s_cbranch_scc1 L_skip_210
    s_mov_b32 exec_hi, 0
    ds_read_b128 v[8:11], v79
    ds_read_b128 v[12:15], v79 offset:8192
    s_waitcnt vmcnt(0) lgkmcnt(0)
    v_pk_add_f32 v[32:33], v[8:9], v[12:13]
    v_pk_add_f32 v[34:35], v[10:11], v[14:15]
    buffer_store_dwordx4 v[32:35], v75, s[40:43], s73 offen sc1
    s_mov_b64 exec, -1
    s_branch L_skip_210x
L_skip_210:
    s_waitcnt vmcnt(0)
L_skip_210x:
L_join_204:
    s_add_u32 m0, s66, 8192
    s_add_u32 s91, s93, 65536
    buffer_load_dwordx4 v76, s[20:23], s91 offen nt lds
    s_add_u32 m0, s66, 9088
    s_nop 0
    buffer_load_dwordx4 v76, s[20:23], s91 offen offset:128 nt lds
    s_add_u32 m0, s66, 10240
    s_add_u32 s91, s93, 81920
    buffer_load_dwordx4 v76, s[20:23], s91 offen nt lds
    s_add_u32 m0, s66, 11136
    s_nop 0
    buffer_load_dwordx4 v76, s[20:23], s91 offen offset:128 nt lds
    s_add_u32 m0, s66, 12288
    s_add_u32 s91, s93, 98304
    buffer_load_dwordx4 v76, s[20:23], s91 offen nt lds
    s_add_u32 m0, s66, 13184
    s_nop 0
    buffer_load_dwordx4 v76, s[20:23], s91 offen offset:128 nt lds
    s_add_u32 m0, s66, 14336
    s_add_u32 s91, s93, 114688
    buffer_load_dwordx4 v76, s[20:23], s91 offen nt lds
    s_add_u32 m0, s66, 15232
    s_nop 0
    buffer_load_dwordx4 v76, s[20:23], s91 offen offset:128 nt lds
    v_lshrrev_b32 v22, 5, v0
    s_and_b32 s90, s3, 1
    v_subrev_u32 v22, s90, v22
    v_mul_i32_i24 v22, 15872, v22
    v_add_u32 v22, v22, v2
    v_xor_b32 v23, 32, v22
    ds_read_b64_tr_b16 v[36:37], v22 offset:0
    ds_read_b64_tr_b16 v[38:39], v22 offset:1024
    ds_read_b64_tr_b16 v[40:41], v23 offset:0
    ds_read_b64_tr_b16 v[42:43], v23 offset:1024
    ds_read_b64_tr_b16 v[44:45], v22 offset:2048
    ds_read_b64_tr_b16 v[46:47], v22 offset:3072
    ds_read_b64_tr_b16 v[48:49], v23 offset:2048
    ds_read_b64_tr_b16 v[50:51], v23 offset:3072
    ds_read_b64_tr_b16 v[52:53], v22 offset:4096
    ds_read_b64_tr_b16 v[54:55], v22 offset:5120
    ds_read_b64_tr_b16 v[56:57], v23 offset:4096
    ds_read_b64_tr_b16 v[58:59], v23 offset:5120
    s_waitcnt lgkmcnt(0)
    s_barrier
    s_add_u32 s79, s44, 0
    s_cmp_ge_u32 s63, 6
    s_cbranch_scc1 L_qidle_211
    v_lshrrev_b32 v14, 3, v0
    v_lshlrev_b32 v12, 8, v14
    v_and_b32 v13, 7, v0
    v_lshl_add_u32 v12, v13, 4, v12
    s_mul_i32 s70, s63, 3
    s_add_u32 s70, s70, s3
    s_add_u32 s76, s70, 0
    s_and_b32 s71, s76, -4
    s_add_u32 s76, s76, s71
    s_lshl_b32 s76, s76, 11
    s_add_u32 s76, s76, 901120
    s_add_u32 s76, s76, s52
    s_sub_u32 s70, s70, s60
    s_lshl_b32 s70, s70, 8
    s_add_u32 s70, s70, s58
    s_add_u32 s70, s70, s59
    s_add_u32 s70, s70, 8704
    s_sub_u32 s70, s70, s76
    v_add_u32 v12, s76, v12
    s_mov_b32 s76, 0
    s_cmp_eq_u32 s3, 3
    s_cselect_b32 s70, 1073741824, 0
    v_add_u32 v12, s70, v12
    v_lshrrev_b32 v14, 4, v0
    v_lshlrev_b32 v13, 3, v13
    v_lshl_add_u32 v13, v14, 1, v13
    s_lshl_b32 s70, s3, 6
    s_add_u32 s70, s70, 150784
    v_add_u32 v13, s70, v13
    v_lshlrev_b32 v14, 4, v14
    v_and_b32 v15, 3, v0
    v_lshl_add_u32 v14, v15, 6, v14
    v_add_u32 v14, 150784, v14
    v_mov_b32 v24, -1
    v_mov_b32 v25, -1
    v_mov_b32 v26, -1
    v_mov_b32 v27, -1
    v_mov_b32 v28, -1
    v_mov_b32 v29, -1
    v_mov_b32 v30, -1
    v_mov_b32 v31, -1
    s_lshl_b32 s73, s63, 8
    s_add_u32 s73, s73, s79
    buffer_load_dwordx4 v[24:27], v12, s[40:43], s76 offen sc1
    buffer_load_dwordx4 v[28:31], v12, s[40:43], s76 offen offset:128 sc1
    v_bfe_u32 v16, v0, 2, 3
    v_lshlrev_b32 v16, 13, v16
    v_lshrrev_b32 v17, 5, v0
    v_lshl_add_u32 v16, v17, 6, v16
    v_bfe_u32 v17, v0, 4, 1
    v_lshlrev_b32 v17, 1, v17
    v_xor_b32 v17, v0, v17
    v_and_b32 v17, 3, v17
    v_lshl_add_u32 v16, v17, 4, v16
    s_lshl_b32 s90, s63, 2
    s_add_u32 s90, s90, s3
    s_lshl_b32 s90, s90, 9
    s_lshr_b32 s91, s64, 21
    s_add_u32 s90, s90, s91
    s_lshl_b32 s90, s90, 8
    s_add_u32 m0, s66, 0
    s_add_u32 s91, s90, 0
    buffer_load_dwordx4 v16, s[28:31], s91 offen  lds
    s_add_u32 m0, s66, 896
    s_nop 0
    buffer_load_dwordx4 v16, s[28:31], s91 offen offset:128  lds
    s_add_u32 m0, s66, 2048
    s_add_u32 s91, s90, 65536
    buffer_load_dwordx4 v16, s[28:31], s91 offen  lds
    s_add_u32 m0, s66, 2944
    s_nop 0
    buffer_load_dwordx4 v16, s[28:31], s91 offen offset:128  lds
    s_mov_b32 s80, 0
    v_cmp_u_f32 vcc, v27, v31
    s_cbranch_vccz L_go_214
    s_branch L_chk_215
L_spin_213:
    s_waitcnt vmcnt(16)
    buffer_load_dwordx4 v[24:27], v12, s[40:43], s76 offen sc1
    buffer_load_dwordx4 v[28:31], v12, s[40:43], s76 offen offset:128 sc1
    s_add_u32 s80, s80, 1024
    s_cbranch_scc1 L_abort
L_chk_215:
    v_cmp_u_f32 vcc, v27, v31
    s_cbranch_vccz L_go_214
    v_cmp_u_f32 vcc, v27, v31
    s_cbranch_vccz L_go_214
    v_cmp_u_f32 vcc, v27, v31
    s_cbranch_vccz L_go_214
    v_cmp_u_f32 vcc, v27, v31
    s_cbranch_vccz L_go_214
    v_cmp_u_f32 vcc, v27, v31
    s_cbranch_vccz L_go_214
    v_cmp_u_f32 vcc, v27, v31
    s_cbranch_vccz L_go_214
    v_cmp_u_f32 vcc, v27, v31
    s_cbranch_vccz L_go_214
    v_cmp_u_f32 vcc, v27, v31
    s_cbranch_vccz L_go_214
    v_cmp_u_f32 vcc, v27, v31
    s_cbranch_vccz L_go_214
    v_cmp_u_f32 vcc, v27, v31
    s_cbranch_vccnz L_spin_213
L_go_214:
    v_pk_add_f32 v[8:9], v[24:25], v[28:29]
    v_pk_add_f32 v[10:11], v[26:27], v[30:31]
    s_nop 1
    v_permlane32_swap_b32 v8, v10
    v_permlane32_swap_b32 v9, v11
    v_add_f32 v8, v8, v10
    v_add_f32 v9, v9, v11
    s_nop 1
    v_permlane16_swap_b32 v8, v9
    v_add_f32 v8, v8, v9
    s_nop 1
    v_add_f32_dpp v8, v8, v8 row_ror:8 row_mask:0xf bank_mask:0xf
    v_add_f32 v8, v8, v4
    v_cvt_pk_bf16_f32 v9, v8, v8
    ds_write_b16 v13, v9
    v_cmp_u_f32 vcc, v8, v8
    s_cbranch_vccnz L_spin_213
    v_lshlrev_b32 v4, 16, v9
    s_waitcnt lgkmcnt(0)
    s_barrier
    ds_read_b128 v[76:79], v14
    s_waitcnt lgkmcnt(0)
    v_mfma_f32_16x16x32_bf16 v[32:35], v[76:79], v[76:79], 0
    v_mfma_f32_16x16x32_bf16 v[8:11], v[76:79], v[36:39], 0
    v_lshlrev_b32 v36, 4, v0
    v_and_b32 v37, 32, v0
    v_mfma_f32_16x16x32_bf16 v[12:15], v[76:79], v[40:43], 0
    v_lshl_add_u32 v37, v37, 26, v36
    v_mov_b32 v40, -1
    v_mfma_f32_16x16x32_bf16 v[16:19], v[76:79], v[44:47], 0
    v_mov_b32 v41, -1
    v_mov_b32 v42, -1
    v_mfma_f32_16x16x32_bf16 v[20:23], v[76:79], v[48:51], 0
    v_mov_b32 v43, -1
    v_mov_b32 v44, -1
    s_waitcnt vmcnt(0)
    v_mfma_f32_16x16x32_bf16 v[24:27], v[76:79], v[52:55], 0
    v_mov_b32 v45, -1
    v_mov_b32 v46, -1
    v_mfma_f32_16x16x32_bf16 v[28:31], v[76:79], v[56:59], 0
    v_mov_b32 v47, -1
    s_mov_b64 exec, 0xffff
    v_mov_b32_dpp v10, v32 row_newbcast:0 row_mask:0xf bank_mask:0xf
    v_mov_b32_dpp v11, v35 row_newbcast:0 row_mask:0xf bank_mask:0xf
    v_add_f32 v8, v8, v17
    v_add_f32_dpp v10, v33, v10 row_newbcast:1 row_mask:0xf bank_mask:0xf
    v_add_f32_dpp v11, v35, v11 row_newbcast:1 row_mask:0xf bank_mask:0xf
    v_add_f32 v9, v12, v21
    v_add_f32_dpp v10, v34, v10 row_newbcast:2 row_mask:0xf bank_mask:0xf
    v_add_f32_dpp v11, v35, v11 row_newbcast:2 row_mask:0xf bank_mask:0xf
    v_add_f32 v8, v8, v26
    v_add_f32 v9, v9, v30
    buffer_store_dwordx4 v[8:11], v36, s[40:43], s73 offen sc1
    s_mov_b64 exec, -1
L_qjoin_212:
    buffer_load_dwordx4 v[40:43], v36, s[40:43], s79 offen sc1
    buffer_load_dwordx4 v[44:47], v37, s[40:43], s79 offen offset:1024 sc1
    v_and_b32 v26, 7, v0
    v_lshlrev_b32 v26, 6, v26
    v_bfe_u32 v27, v0, 3, 1
    v_lshl_add_u32 v26, v27, 11, v26
    v_lshlrev_b32 v27, 3, v0
    v_and_b32 v27, 32, v27
    v_xor_b32 v27, v0, v27
    v_and_b32 v27, 48, v27
    v_add3_u32 v26, v26, v27, s66
    ds_read_b128 v[60:63], v26 offset:0
    ds_read_b128 v[64:67], v26 offset:512
    ds_read_b128 v[68:71], v26 offset:1024
    ds_read_b128 v[72:75], v26 offset:1536
    v_lshrrev_b32 v22, 4, v0
    v_and_b32 v23, 1, v22
    v_lshlrev_b32 v22, 4, v22
    v_mul_u32_u24 v23, 4080, v23
    v_add_u32 v22, v23, v22
    v_and_b32 v23, 15, v0
    v_lshl_add_u32 v22, v23, 1, v22
    s_lshl_b32 s70, s3, 6
    s_add_u32 s70, s70, 154880
    v_add_u32 v22, s70, v22
    v_lshrrev_b32 v25, 4, v0
    v_lshlrev_b32 v24, 4, v25
    v_add_u32 v24, 154880, v24
    v_lshlrev_b32 v25, 3, v25
    v_and_b32 v21, 1, v0
    v_lshl_add_u32 v21, v21, 13, v25
    s_lshl_b32 s69, s61, 2
    s_add_u32 s69, s69, s3
    s_lshl_b32 s69, s69, 5
    s_and_b32 s77, s60, 6
    s_add_u32 s77, s77, s60
    s_lshl_b32 s77, s77, 12
    s_add_u32 s77, s77, 540672
    s_add_u32 s73, s69, s77
    s_add_u32 s69, s69, s58
    s_add_u32 s69, s69, 64512
    s_sub_u32 s77, s69, s73
    s_sub_u32 s77, s77, s52
    v_bfe_u32 v58, v0, 2, 3
    v_lshlrev_b32 v58, 10, v58
    v_lshrrev_b32 v59, 5, v0
    v_lshl_add_u32 v58, v59, 6, v58
    v_bfe_u32 v59, v0, 4, 1
    v_lshlrev_b32 v59, 1, v59
    v_xor_b32 v59, v0, v59
    v_and_b32 v59, 3, v59
    v_lshl_add_u32 v58, v59, 4, v58
    s_mov_b32 s80, 0
L_spin_219:
    buffer_load_dwordx4 v[40:43], v36, s[40:43], s79 offen sc1
    buffer_load_dwordx4 v[44:47], v37, s[40:43], s79 offen offset:1024 sc1
    s_add_u32 s80, s80, 1024
    s_cbranch_scc1 L_abort
    s_waitcnt vmcnt(2)
    v_cmp_u_f32 vcc, v43, v47
    s_cbranch_vccnz L_spin_219
    v_pk_add_f32 v[12:13], v[40:41], v[44:45]
    v_pk_add_f32 v[14:15], v[42:43], v[46:47]
    s_nop 0
    v_permlane32_swap_b32 v12, v13
    v_permlane32_swap_b32 v14, v15
    v_add_f32 v12, v12, v13
    v_add_f32 v14, v14, v15
    s_nop 1
    v_permlane16_swap_b32 v12, v14
    v_add_f32 v12, v12, v14
    s_nop 0
    v_readlane_b32 s71, v12, 48
    v_readlane_b32 s72, v12, 16
    v_cmp_u_f32 vcc, v12, v12
    v_fma_f32 v13, -s71, v6, v12
    v_cvt_pk_bf16_f32 v13, v13, v13
    ds_write_b16 v22, v13
    s_cbranch_vccnz L_spin_219
    v_mov_b32 v14, 0x3ae38e39
    v_mul_f32 v15, s71, v14
    v_mul_f32 v14, s72, v14
    v_fma_f32 v14, -v15, v15, v14
    v_max_f32 v14, 0, v14
    v_add_f32 v14, 0x3727c5ac, v14
    v_rsq_f32 v14, v14
    s_waitcnt lgkmcnt(0)
    s_barrier
    ds_read_b128 v[28:31], v24 offset:0
    ds_read_b128 v[32:35], v24 offset:64
    ds_read_b128 v[48:51], v24 offset:128
    ds_read_b128 v[52:55], v24 offset:192
    v_mul_f32 v14, 0x3e0293ee, v14
    s_nop 0
    v_readfirstlane_b32 s81, v14
    s_waitcnt lgkmcnt(3)
    v_mfma_f32_16x16x32_bf16 v[8:11], v[60:63], v[28:31], 0
    s_waitcnt lgkmcnt(2)
    v_mfma_f32_16x16x32_bf16 v[8:11], v[64:67], v[32:35], v[8:11]
    s_waitcnt lgkmcnt(1)
    v_mfma_f32_16x16x32_bf16 v[8:11], v[68:71], v[48:51], v[8:11]
    s_waitcnt lgkmcnt(0)
    v_mfma_f32_16x16x32_bf16 v[8:11], v[72:75], v[52:55], v[8:11]
    s_mov_b32 exec_lo, 0x30003
    s_mov_b32 exec_hi, 0x30003
    s_nop 5
    v_mul_f32 v8, s81, v8
    v_mul_f32 v9, s81, v9
    v_mul_f32 v10, s81, v10
    v_mul_f32 v11, s81, v11
    v_cvt_pk_bf16_f32 v78, v8, v9
    v_cvt_pk_bf16_f32 v79, v10, v11
    buffer_store_dwordx2 v[78:79], v21, s[40:43], s73 offen sc1
    s_mov_b64 exec, -1
    s_add_u32 m0, s66, 0
    s_add_u32 s91, s93, 0
    buffer_load_dwordx4 v58, s[20:23], s91 offen  lds
    s_add_u32 m0, s66, 896
    s_nop 0
    buffer_load_dwordx4 v58, s[20:23], s91 offen offset:128  lds
    s_add_u32 m0, s66, 2048
    s_add_u32 s91, s93, 16384
    buffer_load_dwordx4 v58, s[20:23], s91 offen  lds
    s_add_u32 m0, s66, 2944
    s_nop 0
    buffer_load_dwordx4 v58, s[20:23], s91 offen offset:128  lds
    s_add_u32 m0, s66, 4096
    s_add_u32 s91, s93, 32768
    buffer_load_dwordx4 v58, s[20:23], s91 offen  lds
    s_add_u32 m0, s66, 4992
    s_nop 0
    buffer_load_dwordx4 v58, s[20:23], s91 offen offset:128  lds
    s_add_u32 m0, s66, 6144
    s_add_u32 s91, s93, 49152
    buffer_load_dwordx4 v58, s[20:23], s91 offen  lds
    s_add_u32 m0, s66, 7040
    s_nop 0
    buffer_load_dwordx4 v58, s[20:23], s91 offen offset:128  lds
    s_barrier
    v_bfe_u32 v72, v0, 2, 3
    v_lshlrev_b32 v72, 11, v72
    v_lshrrev_b32 v73, 5, v0
    v_lshl_add_u32 v72, v73, 6, v72
    v_bfe_u32 v73, v0, 4, 1
    v_lshlrev_b32 v73, 1, v73
    v_xor_b32 v73, v0, v73
    v_and_b32 v73, 3, v73
    v_lshl_add_u32 v72, v73, 4, v72
    v_and_b32 v74, 0x2000, v72
    v_add_u32 v72, v72, v74
    v_add_u32 v74, 32768, v72
    s_mov_b32 s71, 147456
    v_and_b32 v76, 7, v0
    v_lshlrev_b32 v76, 6, v76
    v_bfe_u32 v77, v0, 3, 1
    v_lshl_add_u32 v76, v77, 11, v76
    v_lshlrev_b32 v77, 3, v0
    v_and_b32 v77, 32, v77
    v_xor_b32 v77, v0, v77
    v_and_b32 v77, 48, v77
    v_add3_u32 v76, v76, v77, s71
    s_lshl_b32 s70, s3, 12
    s_sub_u32 s70, s70, 65536
    v_add_u32 v77, s70, v76
    v_lshlrev_b32 v73, 6, v0
    v_bfe_u32 v75, v0, 1, 3
    v_lshl_add_u32 v73, v75, 2, v73
    v_add_u32 v73, s88, v73
    s_lshl_b32 s76, s86, 10
    s_lshl_b32 s70, s3, 8
    s_add_u32 s76, s76, s70
    s_add_u32 s76, s76, 540672
    s_add_u32 s76, s76, s52
    s_mul_i32 s73, s87, 120
    s_sub_u32 s73, s1, s73
    s_and_b32 s69, s3, 1
    s_lshl_b32 s69, s69, 3
    s_lshr_b32 s71, s3, 1
    s_lshl_b32 s71, s71, 10
    s_add_u32 s69, s69, s71
    s_mov_b32 s80, 0
    s_waitcnt vmcnt(9)
    s_add_u32 m0, s88, 0
    s_nop 0
    buffer_load_dwordx4 v72, s[40:43], s76 offen offset:0 sc1 lds
    s_add_u32 m0, s88, 896
    s_nop 0
    buffer_load_dwordx4 v72, s[40:43], s76 offen offset:128 sc1 lds
    s_add_u32 m0, s88, 2048
    s_nop 0
    buffer_load_dwordx4 v74, s[40:43], s76 offen offset:0 sc1 lds
    s_add_u32 m0, s88, 2944
    s_nop 0
    buffer_load_dwordx4 v74, s[40:43], s76 offen offset:128 sc1 lds
    v_mov_b32 v26, -1
    v_mov_b32 v27, -1
    v_mov_b32 v28, -1
    v_mov_b32 v29, -1
    v_lshlrev_b32 v24, 4, v0
    s_mov_b32 exec_hi, 0
    v_lshrrev_b32 v25, 4, v0
    v_mul_u32_u24 v25, 24320, v25
    v_add3_u32 v24, v24, v25, s67
    s_lshl_b32 s90, s63, 8
    s_add_u32 s90, s90, s44
    s_add_u32 s90, s90, s59
    s_add_u32 s90, s90, 13312
    buffer_store_dwordx4 v[26:29], v24, s[40:43], s90 offen sc1
    s_mov_b32 exec_hi, -1
    s_waitcnt vmcnt(5)
    s_barrier
    ds_read_b128 v[32:35], v77 offset:0
    ds_read_b128 v[36:39], v77 offset:512
    ds_read_b128 v[40:43], v77 offset:1024
    ds_read_b128 v[44:47], v77 offset:1536
    ds_read_b128 v[48:51], v77 offset:16384
    ds_read_b128 v[52:55], v77 offset:16896
    ds_read_b128 v[56:59], v77 offset:17408
    ds_read_b128 v[60:63], v77 offset:17920
    ds_read_b128 v[64:67], v77 offset:32768
    ds_read_b128 v[68:71], v77 offset:33280
    s_mov_b32 s90, s61
    s_lshl_b32 s90, s90, 2
    s_add_u32 s90, s90, s3
    s_mul_i32 s90, s90, 36
    v_min_u32 v78, 35, v0
    v_add_u32 v78, s90, v78
    v_min_u32 v78, 4607, v78
    v_lshlrev_b32 v78, 7, v78
    s_mul_i32 s91, s60, 589824
    v_subrev_u32 v79, 36, v0
    v_ashrrev_i32 v79, 31, v79
    v_bfi_b32 v78, v79, v78, 2.0
    v_mov_b32 v3, v78
    s_mov_b32 s94, s91
    s_branch L_qaa_223x
L_qaa_223:
    s_and_b32 s70, vcc_lo, 0xffff
    s_cbranch_scc0 L_qaa_223s0
    s_add_u32 m0, s88, 0
    s_nop 0
    buffer_load_dwordx4 v72, s[40:43], s76 offen offset:0 sc1 lds
L_qaa_223s0:
    s_and_b32 s70, vcc_lo, 0xffff0000
    s_cbranch_scc0 L_qaa_223s1
    s_add_u32 m0, s88, 896
    s_nop 0
    buffer_load_dwordx4 v72, s[40:43], s76 offen offset:128 sc1 lds
L_qaa_223s1:
    s_and_b32 s70, vcc_hi, 0xffff
    s_cbranch_scc0 L_qaa_223s2
    s_add_u32 m0, s88, 2048
    s_nop 0
    buffer_load_dwordx4 v74, s[40:43], s76 offen offset:0 sc1 lds
L_qaa_223s2:
    s_and_b32 s70, vcc_hi, 0xffff0000
    s_cbranch_scc0 L_qaa_223s3
    s_add_u32 m0, s88, 2944
    s_nop 0
    buffer_load_dwordx4 v74, s[40:43], s76 offen offset:128 sc1 lds
L_qaa_223s3:
L_qaa_223x:
    s_waitcnt vmcnt(0)
    ds_read2_b32 v[78:79], v73 offset0:0 offset1:8
    s_add_u32 s80, s80, 4096
    s_cbranch_scc1 L_abort
    s_waitcnt lgkmcnt(0)
    v_cmp_u_f32 vcc, v78, v79
    s_cbranch_vccnz L_qaa_223
    s_barrier
    ds_read_b128 v[8:11], v76 offset:0
    ds_read_b128 v[12:15], v76 offset:512
    ds_read_b128 v[16:19], v76 offset:1024
    ds_read_b128 v[20:23], v76 offset:1536
    ds_read_b128 v[24:27], v76 offset:4096
    buffer_load_dword v3, v3, s[36:39], s94 offen
    s_waitcnt lgkmcnt(4)
    v_mfma_f32_16x16x32_bf16 v[72:75], v[32:35], v[8:11], 0
    ds_read_b128 v[28:31], v76 offset:4608
    s_waitcnt lgkmcnt(4)
    v_mfma_f32_16x16x32_bf16 v[72:75], v[36:39], v[12:15], v[72:75]
    ds_read_b128 v[8:11], v76 offset:5120
    s_waitcnt lgkmcnt(4)
    v_mfma_f32_16x16x32_bf16 v[72:75], v[40:43], v[16:19], v[72:75]
    ds_read_b128 v[12:15], v76 offset:5632
    ds_read_b128 v[32:35], v77 offset:33792
    s_waitcnt lgkmcnt(5)
    v_mfma_f32_16x16x32_bf16 v[72:75], v[44:47], v[20:23], v[72:75]
    ds_read_b128 v[16:19], v76 offset:8192
    ds_read_b128 v[36:39], v77 offset:34304
    s_waitcnt lgkmcnt(6)
    v_mfma_f32_16x16x32_bf16 v[72:75], v[48:51], v[24:27], v[72:75]
    ds_read_b128 v[20:23], v76 offset:8704
    ds_read_b128 v[40:43], v77 offset:49152
    s_waitcnt lgkmcnt(7)
    v_mfma_f32_16x16x32_bf16 v[72:75], v[52:55], v[28:31], v[72:75]
    ds_read_b128 v[24:27], v76 offset:9216
    ds_read_b128 v[44:47], v77 offset:49664
    s_waitcnt lgkmcnt(8)
    v_mfma_f32_16x16x32_bf16 v[72:75], v[56:59], v[8:11], v[72:75]
    ds_read_b128 v[28:31], v76 offset:9728
    ds_read_b128 v[48:51], v77 offset:50176
    s_waitcnt lgkmcnt(9)
    v_mfma_f32_16x16x32_bf16 v[72:75], v[60:63], v[12:15], v[72:75]
    ds_read_b128 v[8:11], v76 offset:12288
    ds_read_b128 v[52:55], v77 offset:50688
    s_waitcnt lgkmcnt(9)
    v_mfma_f32_16x16x32_bf16 v[72:75], v[64:67], v[16:19], v[72:75]
    ds_read_b128 v[12:15], v76 offset:12800
    v_and_b32 v79, 15, v0
    s_waitcnt lgkmcnt(8)
    v_mfma_f32_16x16x32_bf16 v[72:75], v[68:71], v[20:23], v[72:75]
    ds_read_b128 v[16:19], v76 offset:13312
    v_lshlrev_b32 v79, 4, v79
    s_waitcnt lgkmcnt(7)
    v_mfma_f32_16x16x32_bf16 v[72:75], v[32:35], v[24:27], v[72:75]
    ds_read_b128 v[20:23], v76 offset:13824
    v_add_u32 v79, 147456, v79
    s_waitcnt lgkmcnt(6)
    v_mfma_f32_16x16x32_bf16 v[72:75], v[36:39], v[28:31], v[72:75]
    v_lshrrev_b32 v76, 5, v0
    v_lshlrev_b32 v76, 11, v76
    s_waitcnt lgkmcnt(4)
    v_mfma_f32_16x16x32_bf16 v[72:75], v[40:43], v[8:11], v[72:75]
    v_bfe_u32 v77, v0, 2, 3
    v_lshl_add_u32 v76, v77, 6, v76
    s_waitcnt lgkmcnt(2)
    v_mfma_f32_16x16x32_bf16 v[72:75], v[44:47], v[12:15], v[72:75]
    v_bfe_u32 v77, v0, 4, 1
    v_lshl_add_u32 v76, v77, 5, v76
    s_waitcnt lgkmcnt(1)
    v_mfma_f32_16x16x32_bf16 v[72:75], v[48:51], v[16:19], v[72:75]
    v_and_b32 v77, 3, v0
    v_lshl_add_u32 v76, v77, 3, v76
    s_waitcnt lgkmcnt(0)
    s_waitcnt vmcnt(1)
    s_barrier
    v_mfma_f32_16x16x32_bf16 v[72:75], v[52:55], v[20:23], v[72:75]
    v_add_u32 v76, s66, v76
    v_xor_b32 v77, 32, v76
    v_lshl_add_u32 v40, s3, 2, v79
    v_lshlrev_b32 v43, 4, v0
    v_add_u32 v43, 147456, v43
    v_add_u32 v42, s69, v43
    ds_read_b64_tr_b16 v[56:57], v76 offset:8192
    ds_read_b64_tr_b16 v[58:59], v76 offset:12288
    v_max3_f32 v78, v72, v73, v74
    v_max_f32 v78, v78, v75
    v_mov_b32 v41, v78
    ds_read_b64_tr_b16 v[60:61], v77 offset:8192
    ds_read_b64_tr_b16 v[62:63], v77 offset:12288
    v_permlane16_swap_b32 v78, v41
    v_max_f32 v78, v78, v41
    v_mov_b32 v41, v78
    ds_read_b64_tr_b16 v[64:65], v76 offset:512
    s_nop 0
    v_permlane32_swap_b32 v78, v41
    v_max_f32 v78, v78, v41
    ds_write_b32 v40, v78
    v_lshl_add_u32 v40, s3, 2, v43
    ds_read_b64_tr_b16 v[66:67], v76 offset:4608
    ds_read_b64_tr_b16 v[68:69], v77 offset:512
    ds_read_b64_tr_b16 v[70:71], v77 offset:4608
    ds_read_b64_tr_b16 v[16:17], v76 offset:8704
    s_waitcnt lgkmcnt(4)
    s_barrier
    ds_read_b128 v[44:47], v79
    ds_read_b64_tr_b16 v[18:19], v76 offset:12800
    ds_read_b64_tr_b16 v[20:21], v77 offset:8704
    ds_read_b64_tr_b16 v[22:23], v77 offset:12800
    ds_read_b64_tr_b16 v[48:49], v76 offset:0
    ds_read_b64_tr_b16 v[50:51], v76 offset:4096
    ds_read_b64_tr_b16 v[52:53], v77 offset:0
    s_waitcnt lgkmcnt(6)
    v_max3_f32 v78, v44, v45, v46
    v_max_f32 v78, v78, v47
    v_ceil_f32 v78, v78
    v_sub_f32 v72, v72, v78
    v_sub_f32 v73, v73, v78
    v_exp_f32 v72, v72
    v_pk_add_f32 v[46:47], v[44:45], v[46:47]
    v_exp_f32 v73, v73
    v_cmp_u_f32 vcc, v46, v47
    v_sub_f32 v74, v74, v78
    v_sub_f32 v75, v75, v78
    v_exp_f32 v74, v74
    v_exp_f32 v75, v75
    s_cbranch_vccnz L_redo_224
    v_cvt_pk_bf16_f32 v44, v72, v73
    v_cvt_pk_bf16_f32 v45, v74, v75
    ds_write_b64 v42, v[44:45] offset:1024
    v_pk_add_f32 v[72:73], v[72:73], v[74:75]
    v_add_f32 v72, v72, v73
    ds_write_b32 v40, v72 offset:3072
    ds_read_b64_tr_b16 v[54:55], v77 offset:4096
    ds_read_b64_tr_b16 v[24:25], v76 offset:1024
    ds_read_b64_tr_b16 v[26:27], v76 offset:5120
    s_waitcnt lgkmcnt(3)
    s_barrier
    ds_read_b128 v[8:11], v43 offset:1024
    ds_read_b128 v[12:15], v43 offset:2048
    ds_read_b128 v[72:75], v43 offset:3072
    ds_read_b64_tr_b16 v[28:29], v77 offset:1024
    ds_read_b64_tr_b16 v[30:31], v77 offset:5120
    ds_read_b64_tr_b16 v[32:33], v76 offset:9216
    ds_read_b64_tr_b16 v[34:35], v76 offset:13312
    ds_read_b64_tr_b16 v[36:37], v77 offset:9216
    ds_read_b64_tr_b16 v[38:39], v77 offset:13312
    s_waitcnt lgkmcnt(8)
    v_mfma_f32_16x16x32_bf16 v[40:43], v[8:11], v[48:51], 0
    v_mfma_f32_16x16x32_bf16 v[44:47], v[8:11], v[52:55], 0
    s_waitcnt lgkmcnt(6)
    v_mfma_f32_16x16x32_bf16 v[40:43], v[12:15], v[56:59], v[40:43]
    v_pk_add_f32 v[72:73], v[72:73], v[74:75]
    v_and_b32 v74, 15, v0
    v_add_f32 v79, v72, v73
    v_mfma_f32_16x16x32_bf16 v[44:47], v[12:15], v[60:63], v[44:47]
    v_lshlrev_b32 v75, 7, v74
    v_mov_b32 v72, v79
    v_lshlrev_b32 v74, 3, v74
    v_mfma_f32_16x16x32_bf16 v[48:51], v[8:11], v[64:67], 0
    v_lshrrev_b32 v73, 4, v0
    v_permlane16_swap_b32 v79, v72
    v_add_f32 v79, v79, v72
    v_mfma_f32_16x16x32_bf16 v[52:55], v[8:11], v[68:71], 0
    v_lshl_add_u32 v74, v73, 12, v74
    v_mov_b32 v72, v79
    v_lshl_add_u32 v75, v73, 28, v75
    v_mfma_f32_16x16x32_bf16 v[48:51], v[12:15], v[16:19], v[48:51]
    ds_read_b64_tr_b16 v[16:17], v76 offset:1536
    ds_read_b64_tr_b16 v[18:19], v76 offset:5632
    v_add_u32 v75, s89, v75
    v_mfma_f32_16x16x32_bf16 v[52:55], v[12:15], v[20:23], v[52:55]
    ds_read_b64_tr_b16 v[20:21], v77 offset:1536
    ds_read_b64_tr_b16 v[22:23], v77 offset:5632
    v_permlane32_swap_b32 v79, v72
    v_mfma_f32_16x16x32_bf16 v[56:59], v[8:11], v[24:27], 0
    ds_read_b64_tr_b16 v[24:25], v76 offset:9728
    ds_read_b64_tr_b16 v[26:27], v76 offset:13824
    v_add_f32 v79, v79, v72
    s_waitcnt lgkmcnt(6)
    v_mfma_f32_16x16x32_bf16 v[60:63], v[8:11], v[28:31], 0
    ds_read_b64_tr_b16 v[28:29], v77 offset:9728
    ds_read_b64_tr_b16 v[30:31], v77 offset:13824
    v_and_b32 v72, 32, v0
    v_lshl_add_u32 v74, v72, 8, v74
    v_mfma_f32_16x16x32_bf16 v[56:59], v[12:15], v[32:35], v[56:59]
    v_cvt_pk_bf16_f32 v44, v40, v44
    v_cvt_pk_bf16_f32 v40, v41, v45
    v_mfma_f32_16x16x32_bf16 v[60:63], v[12:15], v[36:39], v[60:63]
    v_cvt_pk_bf16_f32 v45, v48, v52
    buffer_store_dwordx2 v[44:45], v74, s[40:43], s47 offen offset:0 sc1
    s_waitcnt lgkmcnt(6)
    v_mfma_f32_16x16x32_bf16 v[64:67], v[8:11], v[16:19], 0
    buffer_store_dwordx2 v[78:79], v75, s[40:43], s73 offen sc1
    v_cvt_pk_bf16_f32 v41, v49, v53
    buffer_store_dwordx2 v[40:41], v74, s[40:43], s47 offen offset:1024 sc1
    s_waitcnt lgkmcnt(4)
    v_mfma_f32_16x16x32_bf16 v[68:71], v[8:11], v[20:23], 0
    v_cvt_pk_bf16_f32 v46, v42, v46
    v_cvt_pk_bf16_f32 v42, v43, v47
    s_waitcnt lgkmcnt(2)
    v_mfma_f32_16x16x32_bf16 v[64:67], v[12:15], v[24:27], v[64:67]
    v_cvt_pk_bf16_f32 v47, v50, v54
    buffer_store_dwordx2 v[46:47], v74, s[40:43], s47 offen offset:2048 sc1
    s_waitcnt lgkmcnt(0)
    v_mfma_f32_16x16x32_bf16 v[68:71], v[12:15], v[28:31], v[68:71]
    v_cvt_pk_bf16_f32 v43, v51, v55
    buffer_store_dwordx2 v[42:43], v74, s[40:43], s47 offen offset:3072 sc1
    v_cvt_pk_bf16_f32 v60, v56, v60
    v_cvt_pk_bf16_f32 v56, v57, v61
    v_cvt_pk_bf16_f32 v62, v58, v62
    v_cvt_pk_bf16_f32 v58, v59, v63
    v_and_b32 v72, 3, v0
    v_lshlrev_b32 v72, 3, v72
    v_cvt_pk_bf16_f32 v61, v64, v68
    buffer_store_dwordx2 v[60:61], v74, s[40:43], s47 offen offset:128 sc1
    v_cvt_pk_bf16_f32 v57, v65, v69
    buffer_store_dwordx2 v[56:57], v74, s[40:43], s47 offen offset:1152 sc1
    v_cvt_pk_bf16_f32 v63, v66, v70
    buffer_store_dwordx2 v[62:63], v74, s[40:43], s47 offen offset:2176 sc1
    v_cvt_pk_bf16_f32 v59, v67, v71
    buffer_store_dwordx2 v[58:59], v74, s[40:43], s47 offen offset:3200 sc1
    v_lshl_add_u32 v73, v73, 5, v72
    v_mov_b32 v32, -1
    v_mov_b32 v33, -1
    buffer_load_dwordx2 v[32:33], v73, s[40:43], s1 offen sc1
    v_lshrrev_b32 v77, 4, v0
    v_and_b32 v76, 15, v0
    v_lshlrev_b32 v72, 4, v76
    v_lshl_add_u32 v72, v77, 17, v72
    s_add_u32 s95, s0, 32768
    s_add_u32 s96, s0, 65536
    s_add_u32 s97, s0, 98304
    v_and_b32 v78, 1, v76
    v_lshlrev_b32 v78, 4, v78
    v_mov_b32 v79, 0xffff
    v_lshlrev_b32 v78, v78, v79
    v_lshrrev_b32 v79, 1, v76
    v_cmp_eq_u32 vcc, 0, v79
    s_nop 1
    v_cndmask_b32 v64, 0, v78, vcc
    v_cmp_eq_u32 vcc, 1, v79
    s_nop 1
    v_cndmask_b32 v65, 0, v78, vcc
    v_cmp_eq_u32 vcc, 2, v79
    s_nop 1
    v_cndmask_b32 v66, 0, v78, vcc
    v_cmp_eq_u32 vcc, 3, v79
    s_nop 1
    v_cndmask_b32 v67, 0, v78, vcc
    s_lshl_b32 s71, s87, 1
    s_add_u32 s71, s71, s86
    s_and_b32 s72, s71, 15
    s_lshl_b32 s73, s72, 14
    s_lshl_b32 s70, s3, 11
    s_add_u32 s73, s73, s70
    s_and_b32 s70, s71, 8
    s_add_u32 s72, s72, s70
    s_lshl_b32 s72, s72, 10
    s_lshl_b32 s70, s55, 7
    s_add_u32 s70, s70, s54
    s_add_u32 s73, s73, s70
    s_add_u32 s73, s73, 606208
    s_add_u32 s72, s72, s70
    s_add_u32 s72, s72, 868352
    s_mov_b32 s74, 10
    v_and_b32 v74, 7, v0
    v_lshlrev_b32 v74, 4, v74
    v_lshl_add_u32 v74, v77, 3, v74
    v_bfe_u32 v75, v0, 3, 1
    v_lshl_add_u32 v74, v75, s74, v74
    v_and_b32 v75, 32, v0
    v_lshl_add_u32 v74, v75, 26, v74
    v_mov_b32 v75, 1073741824
    v_writelane_b32 v75, s89, 0
    s_mov_b32 s80, 0
L_spin_225:
    buffer_load_dwordx2 v[32:33], v73, s[40:43], s1 offen sc1
    s_add_u32 s80, s80, 1024
    s_cbranch_scc1 L_abort
    s_waitcnt vmcnt(1)
    v_cmp_u_f32 vcc, v32, v33
    s_cbranch_vccnz L_spin_225
    buffer_load_dwordx4 v[8:11], v72, s[40:43], s0 offen sc1
    buffer_load_dwordx4 v[12:15], v72, s[40:43], s95 offen sc1
    buffer_load_dwordx4 v[16:19], v72, s[40:43], s96 offen sc1
    buffer_load_dwordx4 v[20:23], v72, s[40:43], s97 offen sc1
    v_max_f32_dpp v44, v32, v32 quad_perm:[1,0,3,2] row_mask:0xf bank_mask:0xf
    s_nop 1
    v_max_f32_dpp v44, v44, v44 quad_perm:[2,3,0,1] row_mask:0xf bank_mask:0xf
    v_mov_b32 v45, v44
    s_nop 1
    v_permlane16_swap_b32 v44, v45
    v_max_f32 v44, v44, v45
    v_mov_b32 v45, v44
    s_nop 1
    v_permlane32_swap_b32 v44, v45
    v_max_f32 v44, v44, v45
    v_sub_f32 v40, v32, v44
    v_exp_f32 v40, v40
    s_nop 0
    v_cvt_pk_bf16_f32 v42, v40, v40
    v_mul_f32 v45, v40, v33
    s_nop 0
    v_and_b32_dpp v48, v42, v64 quad_perm:[0,0,0,0] row_mask:0xf bank_mask:0xf
    v_and_b32_dpp v49, v42, v65 quad_perm:[0,0,0,0] row_mask:0xf bank_mask:0xf
    v_and_b32_dpp v50, v42, v66 quad_perm:[0,0,0,0] row_mask:0xf bank_mask:0xf
    v_add_f32_dpp v45, v45, v45 quad_perm:[1,0,3,2] row_mask:0xf bank_mask:0xf
    v_and_b32_dpp v51, v42, v67 quad_perm:[0,0,0,0] row_mask:0xf bank_mask:0xf
    s_nop 0
    v_add_f32_dpp v45, v45, v45 quad_perm:[2,3,0,1] row_mask:0xf bank_mask:0xf
    v_and_b32_dpp v52, v42, v64 quad_perm:[1,1,1,1] row_mask:0xf bank_mask:0xf
    v_mov_b32 v46, v45
    v_and_b32_dpp v53, v42, v65 quad_perm:[1,1,1,1] row_mask:0xf bank_mask:0xf
    s_nop 0
    v_permlane16_swap_b32 v45, v46
    v_and_b32_dpp v54, v42, v66 quad_perm:[1,1,1,1] row_mask:0xf bank_mask:0xf
    v_add_f32 v45, v45, v46
    v_and_b32_dpp v55, v42, v67 quad_perm:[1,1,1,1] row_mask:0xf bank_mask:0xf
    v_mov_b32 v46, v45
    v_and_b32_dpp v56, v42, v64 quad_perm:[2,2,2,2] row_mask:0xf bank_mask:0xf
    s_nop 0
    v_permlane32_swap_b32 v45, v46
    v_and_b32_dpp v57, v42, v65 quad_perm:[2,2,2,2] row_mask:0xf bank_mask:0xf
    v_add_f32 v45, v45, v46
    v_and_b32_dpp v58, v42, v66 quad_perm:[2,2,2,2] row_mask:0xf bank_mask:0xf
    v_and_b32_dpp v59, v42, v67 quad_perm:[2,2,2,2] row_mask:0xf bank_mask:0xf
    buffer_store_dwordx2 v[44:45], v75, s[40:43], s72 offen sc1
    v_and_b32_dpp v60, v42, v64 quad_perm:[3,3,3,3] row_mask:0xf bank_mask:0xf
    v_and_b32_dpp v61, v42, v65 quad_perm:[3,3,3,3] row_mask:0xf bank_mask:0xf
    v_and_b32_dpp v62, v42, v66 quad_perm:[3,3,3,3] row_mask:0xf bank_mask:0xf
    v_and_b32_dpp v63, v42, v67 quad_perm:[3,3,3,3] row_mask:0xf bank_mask:0xf
    s_mov_b32 s80, 0
L_paw_228:
    s_waitcnt vmcnt(4)
    v_mfma_f32_16x16x32_bf16 v[68:71], v[48:51], v[8:11], 0
    s_waitcnt vmcnt(3)
    v_mfma_f32_16x16x32_bf16 v[68:71], v[52:55], v[12:15], v[68:71]
    s_waitcnt vmcnt(2)
    v_mfma_f32_16x16x32_bf16 v[68:71], v[56:59], v[16:19], v[68:71]
    s_waitcnt vmcnt(1)
    v_mfma_f32_16x16x32_bf16 v[68:71], v[60:63], v[20:23], v[68:71]
    s_nop 7
    v_cmp_u_f32 vcc, v68, v68
    v_cvt_pk_bf16_f32 v46, v68, v69
    v_cvt_pk_bf16_f32 v47, v70, v71
    s_cbranch_vccnz L_retry_229
    buffer_store_dwordx2 v[46:47], v74, s[40:43], s73 offen sc1
    v_bfe_u32 v76, v0, 2, 3
    v_lshlrev_b32 v76, 7, v76
    v_lshrrev_b32 v77, 5, v0
    v_lshl_add_u32 v76, v77, 6, v76
    v_bfe_u32 v77, v0, 4, 1
    v_lshlrev_b32 v77, 1, v77
    v_xor_b32 v77, v0, v77
    v_and_b32 v77, 3, v77
    v_lshl_add_u32 v76, v77, 4, v76
    v_bfe_u32 v78, v0, 2, 3
    v_lshlrev_b32 v77, 7, v78
    s_and_b32 s77, s62, 15
    s_lshl_b32 s76, s77, 4
    s_add_u32 s76, s76, s63
    s_lshl_b32 s76, s76, 10
    s_add_u32 s76, s76, s53
    s_add_u32 s76, s76, 606208
    s_and_b32 s70, s62, 8
    s_add_u32 s77, s77, s70
    s_lshl_b32 s77, s77, 10
    s_add_u32 s77, s77, s53
    s_add_u32 s77, s77, 868352
    v_mov_b32 v64, -1
    v_mov_b32 v65, -1
    v_mov_b32 v66, -1
    v_mov_b32 v67, -1
    v_mov_b32 v68, -1
    v_mov_b32 v69, -1
    s_barrier
    v_lshrrev_b32 v8, 4, v0
    v_bfe_u32 v9, v0, 2, 2
    v_lshlrev_b32 v8, 1, v8
    v_lshl_add_u32 v8, v9, 4, v8
    v_mul_u32_u24 v8, 8192, v8
    v_bfe_u32 v9, v0, 4, 1
    v_lshlrev_b32 v9, 1, v9
    v_xor_b32 v9, v0, v9
    v_and_b32 v9, 3, v9
    v_lshl_add_u32 v8, v9, 4, v8
    s_lshl_b32 s90, s63, 18
    s_sub_u32 s90, s98, s90
    s_add_u32 m0, s88, 0
    s_add_u32 s91, s90, 0
    buffer_load_dwordx4 v8, s[32:35], s91 offen  lds
    s_add_u32 m0, s88, 1024
    s_add_u32 s91, s90, 8192
    buffer_load_dwordx4 v8, s[32:35], s91 offen  lds
    s_add_u32 m0, s88, 2048
    s_add_u32 s91, s90, 65536
    buffer_load_dwordx4 v8, s[32:35], s91 offen  lds
    s_add_u32 m0, s88, 3072
    s_add_u32 s91, s90, 73728
    buffer_load_dwordx4 v8, s[32:35], s91 offen  lds
    v_lshrrev_b32 v8, 4, v0
    v_bfe_u32 v9, v0, 2, 2
    v_lshl_add_u32 v8, v8, 3, v9
    v_mul_u32_u24 v8, 1152, v8
    v_bfe_u32 v9, v0, 4, 1
    v_lshlrev_b32 v9, 1, v9
    v_xor_b32 v9, v0, v9
    v_and_b32 v9, 3, v9
    v_lshl_add_u32 v8, v9, 4, v8
    v_add_u32 v8, s68, v8
    s_add_u32 m0, s66, 0
    s_add_u32 s91, s99, 0
    buffer_load_dwordx4 v8, s[36:39], s91 offen  lds
    s_add_u32 m0, s66, 1024
    s_add_u32 s91, s99, 4608
    buffer_load_dwordx4 v8, s[36:39], s91 offen  lds
    s_add_u32 m0, s66, 2048
    s_add_u32 s91, s99, 36864
    buffer_load_dwordx4 v8, s[36:39], s91 offen  lds
    s_add_u32 m0, s66, 3072
    s_add_u32 s91, s99, 41472
    buffer_load_dwordx4 v8, s[36:39], s91 offen  lds
    buffer_load_dwordx2 v[68:69], v77, s[40:43], s77 offen sc1
    buffer_load_dwordx4 v[64:67], v76, s[40:43], s76 offen sc1
    v_lshrrev_b32 v16, 4, v0
    v_bfe_u32 v17, v0, 2, 2
    v_lshl_add_u32 v16, v16, 3, v17
    v_mul_u32_u24 v16, 1152, v16
    v_bfe_u32 v17, v0, 4, 1
    v_lshlrev_b32 v17, 1, v17
    v_xor_b32 v17, v0, v17
    v_and_b32 v17, 3, v17
    v_lshl_add_u32 v16, v17, 4, v16
    v_add_u32 v16, s68, v16
    s_add_u32 m0, s66, 4096
    s_add_u32 s91, s99, 73728
    buffer_load_dwordx4 v16, s[36:39], s91 offen  lds
    s_add_u32 m0, s66, 5120
    s_add_u32 s91, s99, 78336
    buffer_load_dwordx4 v16, s[36:39], s91 offen  lds
    s_add_u32 m0, s66, 6144
    s_add_u32 s91, s99, 110592
    buffer_load_dwordx4 v16, s[36:39], s91 offen  lds
    s_add_u32 m0, s66, 7168
    s_add_u32 s91, s99, 115200
    buffer_load_dwordx4 v16, s[36:39], s91 offen  lds
    v_and_b32 v74, 7, v0
    v_lshlrev_b32 v74, 6, v74
    v_lshlrev_b32 v75, 3, v0
    v_and_b32 v75, 32, v75
    v_xor_b32 v75, v0, v75
    v_and_b32 v75, 48, v75
    v_add3_u32 v74, v74, v75, s88
    v_lshrrev_b32 v78, 3, v0
    v_and_b32 v79, 7, v0
    v_lshlrev_b32 v79, 1, v79
    v_lshl_add_u32 v78, v78, 7, v79
    s_lshl_b32 s70, s3, 9
    s_add_u32 s73, s45, s70
    s_add_u32 s73, s73, 24576
    s_sub_u32 s70, s88, s66
    v_add_u32 v70, s70, v2
    v_add_u32 v71, s70, v7
    v_lshl_add_u32 v75, v0, 4, s88
    v_and_b32 v32, 7, v0
    v_lshlrev_b32 v32, 4, v32
    v_bfe_u32 v33, v0, 3, 1
    v_lshl_add_u32 v32, v33, 9, v32
    v_lshrrev_b32 v33, 4, v0
    v_lshl_add_u32 v32, v33, 7, v32
    s_add_u32 s79, s46, 24576
    v_mov_b32 v24, -1
    v_mov_b32 v25, -1
    v_mov_b32 v26, -1
    v_mov_b32 v27, -1
    v_mov_b32 v28, -1
    v_mov_b32 v29, -1
    v_mov_b32 v30, -1
    v_mov_b32 v31, -1
    s_waitcnt vmcnt(10)
    ds_read_b64_tr_b16 v[40:41], v70 offset:0
    ds_read_b64_tr_b16 v[42:43], v70 offset:1024
    ds_read_b64_tr_b16 v[44:45], v71 offset:0
    ds_read_b64_tr_b16 v[46:47], v71 offset:1024
    ds_read_b64_tr_b16 v[48:49], v70 offset:2048
    ds_read_b64_tr_b16 v[50:51], v70 offset:3072
    ds_read_b64_tr_b16 v[52:53], v71 offset:2048
    ds_read_b64_tr_b16 v[54:55], v71 offset:3072
    s_mov_b32 s80, 0
    v_cmp_u_f32 vcc, v68, v69
    s_cbranch_vccz L_go_231
    s_branch L_chk_232
L_spin_230:
    s_waitcnt vmcnt(16)
    buffer_load_dwordx2 v[68:69], v77, s[40:43], s77 offen sc1
    buffer_load_dwordx4 v[64:67], v76, s[40:43], s76 offen sc1
    s_add_u32 s80, s80, 1024
    s_cbranch_scc1 L_abort
L_chk_232:
    v_cmp_u_f32 vcc, v68, v69
    s_cbranch_vccz L_go_231
    v_cmp_u_f32 vcc, v68, v69
    s_cbranch_vccz L_go_231
    v_cmp_u_f32 vcc, v68, v69
    s_cbranch_vccz L_go_231
    v_cmp_u_f32 vcc, v68, v69
    s_cbranch_vccz L_go_231
    v_cmp_u_f32 vcc, v68, v69
    s_cbranch_vccz L_go_231
    v_cmp_u_f32 vcc, v68, v69
    s_cbranch_vccz L_go_231
    v_cmp_u_f32 vcc, v68, v69
    s_cbranch_vccz L_go_231
    v_cmp_u_f32 vcc, v68, v69
    s_cbranch_vccz L_go_231
    v_cmp_u_f32 vcc, v68, v69
    s_cbranch_vccz L_go_231
    v_cmp_u_f32 vcc, v68, v69
    s_cbranch_vccnz L_spin_230
L_go_231:
    s_mov_b32 s80, 0
    v_cmp_u_f32 vcc, v64, v67
    s_cbranch_vccz L_go_234
    s_branch L_chk_235
L_spin_233:
    s_waitcnt vmcnt(8)
    buffer_load_dwordx4 v[64:67], v76, s[40:43], s76 offen sc1
    s_add_u32 s80, s80, 1024
    s_cbranch_scc1 L_abort
L_chk_235:
    v_cmp_u_f32 vcc, v64, v67
    s_cbranch_vccz L_go_234
    v_cmp_u_f32 vcc, v64, v67
    s_cbranch_vccz L_go_234
    v_cmp_u_f32 vcc, v64, v67
    s_cbranch_vccz L_go_234
    v_cmp_u_f32 vcc, v64, v67
    s_cbranch_vccz L_go_234
    v_cmp_u_f32 vcc, v64, v67
    s_cbranch_vccz L_go_234
    v_cmp_u_f32 vcc, v64, v67
    s_cbranch_vccz L_go_234
    v_cmp_u_f32 vcc, v64, v67
    s_cbranch_vccz L_go_234
    v_cmp_u_f32 vcc, v64, v67
    s_cbranch_vccz L_go_234
    v_cmp_u_f32 vcc, v64, v67
    s_cbranch_vccz L_go_234
    v_cmp_u_f32 vcc, v64, v67
    s_cbranch_vccnz L_spin_233
L_go_234:
    ds_write_b128 v75, v[64:67]
    ds_read_b128 v[16:19], v74
    ds_read_b128 v[20:23], v74 offset:512
    v_max_f32_dpp v12, v68, v68 row_ror:4 row_mask:0xf bank_mask:0xf
    s_nop 1
    v_max_f32_dpp v12, v12, v12 row_ror:8 row_mask:0xf bank_mask:0xf
    v_mov_b32 v13, v12
    s_nop 1
    v_permlane16_swap_b32 v12, v13
    v_max_f32 v12, v12, v13
    v_sub_f32 v12, v68, v12
    v_exp_f32 v12, v12
    s_nop 0
    v_mul_f32 v13, v12, v69
    v_mov_b32_dpp v8, v12 row_newbcast:0 row_mask:0xf bank_mask:0xf
    v_mov_b32_dpp v9, v12 row_newbcast:4 row_mask:0xf bank_mask:0xf
    v_mov_b32_dpp v10, v12 row_newbcast:8 row_mask:0xf bank_mask:0xf
    v_mov_b32_dpp v11, v12 row_newbcast:12 row_mask:0xf bank_mask:0xf
    s_waitcnt lgkmcnt(0)
    v_mfma_f32_16x16x32_bf16 v[56:59], v[16:19], v[40:43], 0
    v_add_f32_dpp v13, v13, v13 row_ror:4 row_mask:0xf bank_mask:0xf
    v_mfma_f32_16x16x32_bf16 v[60:63], v[16:19], v[44:47], 0
    s_nop 0
    v_add_f32_dpp v13, v13, v13 row_ror:8 row_mask:0xf bank_mask:0xf
    v_mfma_f32_16x16x32_bf16 v[56:59], v[20:23], v[48:51], v[56:59]
    v_mov_b32 v12, v13
    v_mfma_f32_16x16x32_bf16 v[60:63], v[20:23], v[52:55], v[60:63]
    s_nop 0
    v_permlane16_swap_b32 v13, v12
    v_add_f32 v13, v13, v12
    v_rcp_f32 v13, v13
    s_nop 0
    v_pk_mul_f32 v[36:37], v[8:9], v[12:13] op_sel:[0,1]
    v_pk_mul_f32 v[38:39], v[10:11], v[12:13] op_sel:[0,1]
    v_pk_mul_f32 v[56:57], v[56:57], v[36:37]
    v_pk_mul_f32 v[60:61], v[60:61], v[36:37]
    v_pk_fma_f32 v[56:57], v[58:59], v[38:39], v[56:57]
    v_pk_fma_f32 v[60:61], v[62:63], v[38:39], v[60:61]
    v_add_f32 v14, v56, v57
    v_add_f32 v15, v60, v61
    s_nop 1
    v_permlane16_swap_b32 v14, v15
    v_add_f32 v14, v14, v15
    v_cmp_u_f32 vcc, v14, v14
    s_cbranch_vccnz L_spin_233
    v_mov_b32_dpp v15, v14 quad_perm:[1,1,3,3] row_mask:0xf bank_mask:0xf
    s_mov_b64 exec, 0x55555555
    v_cvt_pk_bf16_f32 v15, v14, v15
    buffer_store_dword v15, v78, s[40:43], s73 offen sc1
    s_mov_b64 exec, -1
    s_cmp_ge_u32 s61, 18
    s_cbranch_scc1 L_idle_236
    buffer_load_dwordx4 v[24:27], v32, s[40:43], s79 offen offset:0 sc1
    buffer_load_dwordx4 v[28:31], v32, s[40:43], s79 offen offset:1024 sc1
    s_waitcnt vmcnt(3)
    ds_read_b64_tr_b16 v[40:41], v2 offset:0
    s_add_u32 s70, s88, 3584
    v_lshl_add_u32 v78, v0, 2, s70
    ds_read_b64_tr_b16 v[42:43], v2 offset:1024
    s_mov_b32 s71, 151040
    v_and_b32 v74, 7, v0
    ds_read_b64_tr_b16 v[44:45], v7 offset:0
    v_lshlrev_b32 v74, 4, v74
    v_bfe_u32 v79, v0, 2, 1
    ds_read_b64_tr_b16 v[46:47], v7 offset:1024
    v_lshl_add_u32 v79, v79, 7, v74
    v_bfe_u32 v75, v0, 4, 1
    ds_read_b64_tr_b16 v[48:49], v2 offset:2048
    v_lshl_add_u32 v75, v75, 13, v74
    v_bfe_u32 v8, v0, 3, 1
    ds_read_b64_tr_b16 v[50:51], v2 offset:3072
    v_lshl_add_u32 v75, v8, 11, v75
    v_lshl_add_u32 v74, v8, 8, v74
    ds_read_b64_tr_b16 v[52:53], v7 offset:2048
    v_lshlrev_b32 v8, 12, v8
    v_add3_u32 v79, v79, v8, s71
    ds_read_b64_tr_b16 v[54:55], v7 offset:3072
    s_and_b32 s70, s61, 30
    buffer_load_dwordx4 v[24:27], v32, s[40:43], s79 offen offset:0 sc1
    buffer_load_dwordx4 v[28:31], v32, s[40:43], s79 offen offset:1024 sc1
    s_add_u32 s73, s70, 18
    ds_read_b64_tr_b16 v[56:57], v2 offset:4096
    s_and_b32 s71, s73, -4
    s_add_u32 s73, s73, s71
    ds_read_b64_tr_b16 v[58:59], v2 offset:5120
    s_lshl_b32 s73, s73, 11
    s_add_u32 s73, s73, 901120
    ds_read_b64_tr_b16 v[60:61], v7 offset:4096
    s_and_b32 s71, s61, 1
    s_lshl_b32 s69, s60, 1
    ds_read_b64_tr_b16 v[62:63], v7 offset:5120
    s_add_u32 s69, s69, s71
    s_lshl_b32 s69, s69, 7
    ds_read_b64_tr_b16 v[64:65], v2 offset:6144
    s_add_u32 s73, s73, s69
    s_add_u32 s70, s70, s61
    ds_read_b64_tr_b16 v[66:67], v2 offset:7168
    s_lshl_b32 s70, s70, 7
    s_add_u32 s69, s58, s70
    ds_read_b64_tr_b16 v[68:69], v7 offset:6144
    s_add_u32 s69, s69, 50688
    ds_read_b64_tr_b16 v[70:71], v7 offset:7168
    v_bfe_u32 v76, v0, 4, 1
    v_bfe_u32 v77, v0, 2, 2
    v_lshl_add_u32 v76, v76, 3, v77
    v_mul_u32_u24 v76, 8192, v76
    v_lshrrev_b32 v77, 5, v0
    v_lshl_add_u32 v76, v77, 6, v76
    v_bfe_u32 v77, v0, 4, 1
    v_lshlrev_b32 v77, 1, v77
    v_xor_b32 v77, v0, v77
    v_and_b32 v77, 3, v77
    v_lshl_add_u32 v76, v77, 4, v76
    s_and_b32 s90, s3, 1
    s_mul_i32 s90, s90, 131008
    s_add_u32 s90, s90, s67
    v_add_u32 v76, s90, v76
    s_mov_b32 s80, 0
L_spin_238:
    buffer_load_dwordx4 v[24:27], v32, s[40:43], s79 offen offset:0 sc1
    buffer_load_dwordx4 v[28:31], v32, s[40:43], s79 offen offset:1024 sc1
    s_add_u32 s80, s80, 1024
    s_cbranch_scc1 L_abort
    s_waitcnt vmcnt(2)
    v_cmp_u_f32 vcc, v27, v31
    s_cbranch_vccnz L_spin_238
    s_waitcnt lgkmcnt(0)
    v_mfma_f32_16x16x32_bf16 v[16:19], v[24:27], v[48:51], 0
    v_mfma_f32_16x16x32_bf16 v[16:19], v[28:31], v[64:67], v[16:19]
    v_mfma_f32_16x16x32_bf16 v[12:15], v[24:27], v[44:47], 0
    v_mfma_f32_16x16x32_bf16 v[12:15], v[28:31], v[60:63], v[12:15]
    v_mfma_f32_16x16x32_bf16 v[8:11], v[24:27], v[40:43], 0
    v_mfma_f32_16x16x32_bf16 v[8:11], v[28:31], v[56:59], v[8:11]
    v_mfma_f32_16x16x32_bf16 v[20:23], v[24:27], v[52:55], 0
    v_mfma_f32_16x16x32_bf16 v[20:23], v[28:31], v[68:71], v[20:23]
    s_nop 1
    v_pk_add_f32 v[16:17], v[16:17], v[18:19]
    v_add_f32 v16, v16, v17
    v_pk_add_f32 v[12:13], v[12:13], v[14:15]
    v_add_f32 v12, v12, v13
    v_pk_add_f32 v[8:9], v[8:9], v[10:11]
    v_add_f32 v8, v8, v9
    v_permlane32_swap_b32 v16, v12
    v_add_f32 v8, v8, v12
    v_pk_add_f32 v[20:21], v[20:21], v[22:23]
    v_add_f32 v20, v20, v21
    v_add_f32 v20, v20, v16
    s_nop 1
    v_permlane16_swap_b32 v8, v20
    v_add_f32 v34, v8, v20
    ds_write_b32 v78, v34
    v_cmp_u_f32 vcc, v34, v34
    s_cbranch_vccnz L_spin_238
    s_cmp_lg_u32 s3, 0
    s_waitcnt lgkmcnt(0)
    s_barrier
    s_cbranch_scc1 L_skip_241
    s_mov_b32 exec_hi, 0
    ds_read_b128 v[8:11], v79
    ds_read_b128 v[12:15], v79 offset:8192
    s_waitcnt vmcnt(0) lgkmcnt(0)
    v_pk_add_f32 v[32:33], v[8:9], v[12:13]
    v_pk_add_f32 v[34:35], v[10:11], v[14:15]
    buffer_store_dwordx4 v[32:35], v75, s[40:43], s73 offen sc1
    s_mov_b64 exec, -1
    s_branch L_skip_241x
L_skip_241:
    s_waitcnt vmcnt(0)
L_skip_241x:
L_join_237:
    s_add_u32 m0, s66, 0
    s_add_u32 s91, s98, 0
    buffer_load_dwordx4 v76, s[12:15], s91 offen nt lds
    s_add_u32 m0, s66, 1024
    s_add_u32 s91, s98, 32768
    buffer_load_dwordx4 v76, s[12:15], s91 offen nt lds
    s_add_u32 m0, s66, 2048
    s_add_u32 s91, s98, 262144
    buffer_load_dwordx4 v76, s[12:15], s91 offen nt lds
    s_add_u32 m0, s66, 3072
    s_add_u32 s91, s98, 294912
    buffer_load_dwordx4 v76, s[12:15], s91 offen nt lds
    s_add_u32 m0, s66, 4096
    s_add_u32 s91, s98, 524288
    buffer_load_dwordx4 v76, s[12:15], s91 offen nt lds
    s_add_u32 m0, s66, 5120
    s_add_u32 s91, s98, 557056
    buffer_load_dwordx4 v76, s[12:15], s91 offen nt lds
    v_mov_b32 v18, -1
    v_mov_b32 v19, -1
    v_mov_b32 v20, -1
    v_mov_b32 v21, -1
    v_and_b32 v16, 15, v0
    v_lshlrev_b32 v16, 4, v16
    v_lshrrev_b32 v17, 4, v0
    v_lshl_add_u32 v16, v17, 17, v16
    s_add_u32 s91, s0, 0
    buffer_store_dwordx4 v[18:21], v16, s[40:43], s91 offen sc1
    s_add_u32 s91, s0, 32768
    buffer_store_dwordx4 v[18:21], v16, s[40:43], s91 offen sc1
    s_add_u32 s91, s0, 65536
    buffer_store_dwordx4 v[18:21], v16, s[40:43], s91 offen sc1
    s_add_u32 s91, s0, 98304
    buffer_store_dwordx4 v[18:21], v16, s[40:43], s91 offen sc1
    v_and_b32 v16, 31, v0
    v_lshl_add_u32 v16, v16, 2, s89
    buffer_store_dword v18, v16, s[40:43], s1 offen sc1
    s_add_u32 s79, s44, s59
    s_add_u32 s79, s79, 37888
    s_cmp_ge_u32 s63, 6
    s_cbranch_scc1 L_qidle_242
    v_lshrrev_b32 v14, 3, v0
    v_lshlrev_b32 v12, 8, v14
    v_and_b32 v13, 7, v0
    v_lshl_add_u32 v12, v13, 4, v12
    s_mul_i32 s70, s63, 3
    s_add_u32 s70, s70, s3
    s_add_u32 s76, s70, 18
    s_and_b32 s71, s76, -4
    s_add_u32 s76, s76, s71
    s_lshl_b32 s76, s76, 11
    s_add_u32 s76, s76, 901120
    s_add_u32 s76, s76, s52
    s_sub_u32 s70, s70, s60
    s_lshl_b32 s70, s70, 8
    s_add_u32 s70, s70, s58
    s_add_u32 s70, s70, 50688
    s_sub_u32 s70, s70, s76
    s_cmp_eq_u32 s3, 3
    s_cselect_b32 s70, 1073741824, 0
    v_add_u32 v12, s70, v12
    v_lshrrev_b32 v14, 4, v0
    v_lshlrev_b32 v13, 3, v13
    v_lshl_add_u32 v13, v14, 1, v13
    s_lshl_b32 s70, s3, 6
    s_add_u32 s70, s70, 150784
    v_add_u32 v13, s70, v13
    v_lshlrev_b32 v14, 4, v14
    v_and_b32 v15, 3, v0
    v_lshl_add_u32 v14, v15, 6, v14
    v_add_u32 v14, 150784, v14
    v_mov_b32 v24, -1
    v_mov_b32 v25, -1
    v_mov_b32 v26, -1
    v_mov_b32 v27, -1
    v_mov_b32 v28, -1
    v_mov_b32 v29, -1
    v_mov_b32 v30, -1
    v_mov_b32 v31, -1
    s_lshl_b32 s73, s63, 8
    s_add_u32 s73, s73, s79
    buffer_load_dwordx4 v[24:27], v12, s[40:43], s76 offen sc1
    buffer_load_dwordx4 v[28:31], v12, s[40:43], s76 offen offset:128 sc1
    v_bfe_u32 v72, v0, 2, 3
    v_lshlrev_b32 v72, 10, v72
    v_lshrrev_b32 v60, 5, v0
    v_lshl_add_u32 v72, v60, 6, v72
    v_bfe_u32 v60, v0, 4, 1
    v_lshlrev_b32 v60, 1, v60
    v_xor_b32 v60, v0, v60
    v_and_b32 v60, 3, v60
    v_lshl_add_u32 v72, v60, 4, v72
    v_bfe_u32 v73, v0, 4, 1
    v_bfe_u32 v60, v0, 2, 2
    v_lshl_add_u32 v73, v73, 3, v60
    v_mul_u32_u24 v73, 1152, v73
    v_lshrrev_b32 v60, 5, v0
    v_lshl_add_u32 v73, v60, 6, v73
    v_bfe_u32 v60, v0, 4, 1
    v_lshlrev_b32 v60, 1, v60
    v_xor_b32 v60, v0, v60
    v_and_b32 v60, 3, v60
    v_lshl_add_u32 v73, v60, 4, v73
    s_and_b32 s90, s3, 1
    s_mul_i32 s90, s90, 18368
    s_add_u32 s90, s90, s68
    v_add_u32 v73, s90, v73
    v_lshrrev_b32 v74, 5, v0
    v_lshlrev_b32 v74, 11, v74
    v_bfe_u32 v75, v0, 2, 3
    v_lshl_add_u32 v74, v75, 6, v74
    v_bfe_u32 v75, v0, 4, 1
    v_lshl_add_u32 v74, v75, 5, v74
    v_and_b32 v75, 3, v0
    v_lshl_add_u32 v74, v75, 3, v74
    v_add_u32 v74, s65, v74
    v_xor_b32 v75, 32, v74
    v_mov_b64 v[60:61], 0
    v_mov_b64 v[62:63], 0
    v_mov_b64 v[64:65], 0
    v_mov_b64 v[66:67], 0
    v_mov_b64 v[68:69], 0
    v_mov_b64 v[70:71], 0
    s_waitcnt vmcnt(7)
    s_barrier
    v_lshrrev_b32 v22, 5, v0
    s_and_b32 s90, s3, 1
    v_subrev_u32 v22, s90, v22
    v_mul_i32_i24 v22, 15872, v22
    v_add_u32 v22, v22, v2
    v_xor_b32 v23, 32, v22
    ds_read_b64_tr_b16 v[36:37], v22 offset:0
    ds_read_b64_tr_b16 v[38:39], v22 offset:1024
    ds_read_b64_tr_b16 v[40:41], v23 offset:0
    ds_read_b64_tr_b16 v[42:43], v23 offset:1024
    ds_read_b64_tr_b16 v[44:45], v22 offset:2048
    ds_read_b64_tr_b16 v[46:47], v22 offset:3072
    ds_read_b64_tr_b16 v[48:49], v23 offset:2048
    ds_read_b64_tr_b16 v[50:51], v23 offset:3072
    ds_read_b64_tr_b16 v[52:53], v22 offset:4096
    ds_read_b64_tr_b16 v[54:55], v22 offset:5120
    ds_read_b64_tr_b16 v[56:57], v23 offset:4096
    ds_read_b64_tr_b16 v[58:59], v23 offset:5120
    s_mov_b32 s80, 0
    v_cmp_u_f32 vcc, v27, v31
    s_cbranch_vccz L_go_245
    s_branch L_chk_246
L_spin_244:
    s_waitcnt vmcnt(16)
    buffer_load_dwordx4 v[24:27], v12, s[40:43], s76 offen sc1
    buffer_load_dwordx4 v[28:31], v12, s[40:43], s76 offen offset:128 sc1
    s_add_u32 s80, s80, 1024
    s_cbranch_scc1 L_abort
L_chk_246:
    v_cmp_u_f32 vcc, v27, v31
    s_cbranch_vccz L_go_245
    v_cmp_u_f32 vcc, v27, v31
    s_cbranch_vccz L_go_245
    v_cmp_u_f32 vcc, v27, v31
    s_cbranch_vccz L_go_245
    v_cmp_u_f32 vcc, v27, v31
    s_cbranch_vccz L_go_245
    v_cmp_u_f32 vcc, v27, v31
    s_cbranch_vccz L_go_245
    v_cmp_u_f32 vcc, v27, v31
    s_cbranch_vccz L_go_245
    v_cmp_u_f32 vcc, v27, v31
    s_cbranch_vccz L_go_245
    v_cmp_u_f32 vcc, v27, v31
    s_cbranch_vccz L_go_245
    v_cmp_u_f32 vcc, v27, v31
    s_cbranch_vccz L_go_245
    v_cmp_u_f32 vcc, v27, v31
    s_cbranch_vccnz L_spin_244
L_go_245:
    v_pk_add_f32 v[8:9], v[24:25], v[28:29]
    v_pk_add_f32 v[10:11], v[26:27], v[30:31]
    s_nop 1
    v_permlane32_swap_b32 v8, v10
    v_permlane32_swap_b32 v9, v11
    v_add_f32 v8, v8, v10
    v_add_f32 v9, v9, v11
    s_nop 1
    v_permlane16_swap_b32 v8, v9
    v_add_f32 v8, v8, v9
    s_nop 1
    v_add_f32_dpp v8, v8, v8 row_ror:8 row_mask:0xf bank_mask:0xf
    v_add_f32 v8, v8, v4
    v_cvt_pk_bf16_f32 v9, v8, v8
    ds_write_b16 v13, v9
    v_cmp_u_f32 vcc, v8, v8
    s_cbranch_vccnz L_spin_244
    v_lshlrev_b32 v4, 16, v9
    s_waitcnt lgkmcnt(0)
    s_barrier
    ds_read_b128 v[76:79], v14
    s_waitcnt lgkmcnt(0)
    v_mfma_f32_16x16x32_bf16 v[32:35], v[76:79], v[76:79], 0
    v_mfma_f32_16x16x32_bf16 v[8:11], v[76:79], v[36:39], 0
    v_lshlrev_b32 v36, 4, v0
    v_and_b32 v37, 32, v0
    v_mfma_f32_16x16x32_bf16 v[12:15], v[76:79], v[40:43], 0
    v_lshl_add_u32 v37, v37, 26, v36
    v_mov_b32 v40, -1
    v_mfma_f32_16x16x32_bf16 v[16:19], v[76:79], v[44:47], 0
    v_mov_b32 v41, -1
    v_mov_b32 v42, -1
    v_mfma_f32_16x16x32_bf16 v[20:23], v[76:79], v[48:51], 0
    v_mov_b32 v43, -1
    v_mov_b32 v44, -1
    s_waitcnt vmcnt(0)
    v_mfma_f32_16x16x32_bf16 v[24:27], v[76:79], v[52:55], 0
    v_mov_b32 v45, -1
    v_mov_b32 v46, -1
    v_mfma_f32_16x16x32_bf16 v[28:31], v[76:79], v[56:59], 0
    v_mov_b32 v47, -1
    s_mov_b64 exec, 0xffff
    v_mov_b32_dpp v10, v32 row_newbcast:0 row_mask:0xf bank_mask:0xf
    v_mov_b32_dpp v11, v35 row_newbcast:0 row_mask:0xf bank_mask:0xf
    v_add_f32 v8, v8, v17
    v_add_f32_dpp v10, v33, v10 row_newbcast:1 row_mask:0xf bank_mask:0xf
    v_add_f32_dpp v11, v35, v11 row_newbcast:1 row_mask:0xf bank_mask:0xf
    v_add_f32 v9, v12, v21
    v_add_f32_dpp v10, v34, v10 row_newbcast:2 row_mask:0xf bank_mask:0xf
    v_add_f32_dpp v11, v35, v11 row_newbcast:2 row_mask:0xf bank_mask:0xf
    v_add_f32 v8, v8, v26
    v_add_f32 v9, v9, v30
    buffer_store_dwordx4 v[8:11], v36, s[40:43], s73 offen sc1
    s_mov_b64 exec, -1
L_qjoin_243:
    buffer_load_dwordx4 v[40:43], v36, s[40:43], s79 offen sc1
    buffer_load_dwordx4 v[44:47], v37, s[40:43], s79 offen offset:1024 sc1
    v_lshrrev_b32 v12, 4, v0
    v_and_b32 v13, 1, v12
    v_lshlrev_b32 v12, 4, v12
    v_mul_u32_u24 v13, 4080, v13
    v_bfe_u32 v14, v0, 1, 1
    v_lshl_add_u32 v12, v14, 4, v12
    v_and_b32 v15, 12, v0
    v_add3_u32 v12, v12, v13, v15
    v_and_b32 v13, 1, v0
    s_lshl_b32 s70, s3, 6
    s_add_u32 s70, s70, 154880
    v_lshl_add_u32 v12, v13, 1, v12
    v_add_u32 v8, s70, v12
    v_lshlrev_b32 v9, 4, v13
    v_lshl_add_u32 v9, v14, 6, v9
    v_bfe_u32 v14, v0, 4, 1
    v_lshl_add_u32 v9, v14, 5, v9
    v_lshrrev_b32 v14, 5, v0
    v_lshl_add_u32 v9, v14, 7, v9
    v_add_u32 v9, 154880, v9
    v_mul_u32_u24 v76, 0xaaaa, v13
    v_add_u32 v76, 0x4444, v76
    s_sub_u32 s70, s65, s66
    v_add_u32 v2, s70, v2
    v_add_u32 v7, s70, v7
    v_mov_b64 v[16:17], 0
    v_mov_b64 v[18:19], 0
    v_mov_b64 v[20:21], 0
    v_mov_b64 v[22:23], 0
    v_mov_b64 v[24:25], 0
    v_mov_b64 v[26:27], 0
    v_mov_b64 v[28:29], 0
    v_mov_b64 v[30:31], 0
    v_mov_b64 v[56:57], 0
    v_mov_b64 v[58:59], 0
    s_mov_b32 s80, 0
L_spin_250:
    buffer_load_dwordx4 v[40:43], v36, s[40:43], s79 offen sc1
    buffer_load_dwordx4 v[44:47], v37, s[40:43], s79 offen offset:1024 sc1
    s_add_u32 s80, s80, 1024
    s_cbranch_scc1 L_abort
    s_waitcnt vmcnt(2)
    v_cmp_u_f32 vcc, v43, v47
    s_cbranch_vccnz L_spin_250
    v_pk_add_f32 v[12:13], v[40:41], v[44:45]
    v_pk_add_f32 v[14:15], v[42:43], v[46:47]
    s_nop 0
    v_permlane32_swap_b32 v12, v13
    v_permlane32_swap_b32 v14, v15
    v_add_f32 v12, v12, v13
    v_add_f32 v14, v14, v15
    s_nop 1
    v_permlane16_swap_b32 v12, v14
    v_add_f32 v12, v12, v14
    s_nop 0
    v_readlane_b32 s71, v12, 48
    v_readlane_b32 s72, v12, 16
    v_cmp_u_f32 vcc, v12, v12
    v_fma_f32 v13, -s71, v5, v12
    v_cvt_pk_bf16_f32 v13, v13, v13
    ds_write_b16 v8, v13
    s_cbranch_vccnz L_spin_250
    v_mov_b32 v14, 0x3ae38e39
    v_mul_f32 v15, s71, v14
    v_mul_f32 v14, s72, v14
    v_fma_f32 v14, -v15, v15, v14
    v_max_f32 v14, 0, v14
    v_add_f32 v14, 0x3727c5ac, v14
    v_rsq_f32 v14, v14
    s_waitcnt lgkmcnt(0)
    s_barrier
    s_mov_b32 exec_lo, 0x000f000f
    s_mov_b32 exec_hi, 0x000f000f
    ds_read_b128 v[56:59], v9
    s_lshl_b64 exec, exec, 4
    ds_read_b128 v[60:63], v9
    s_lshl_b64 exec, exec, 4
    ds_read_b128 v[64:67], v9
    s_lshl_b64 exec, exec, 4
    ds_read_b128 v[68:71], v9
    s_mov_b64 exec, -1
    v_mul_f32 v14, 0x3e0293ee, v14
    s_nop 0
    v_readfirstlane_b32 s81, v14
    s_waitcnt lgkmcnt(3)
    v_smfmac_f32_16x16x64_bf16 v[16:19], v[56:59], a[0:7], v76
    s_add_u32 m0, s66, 0
    s_waitcnt lgkmcnt(2)
    v_smfmac_f32_16x16x64_bf16 v[16:19], v[60:63], a[64:71], v76
    s_add_u32 s91, s93, 0
    s_waitcnt lgkmcnt(1)
    v_smfmac_f32_16x16x64_bf16 v[16:19], v[64:67], a[128:135], v76
    buffer_load_dwordx4 v72, s[20:23], s91 offen nt lds
    ds_read_b64_tr_b16 a[0:1], v74 offset:0
    s_waitcnt lgkmcnt(1)
    v_smfmac_f32_16x16x64_bf16 v[16:19], v[68:71], a[192:199], v76
    s_add_u32 m0, s66, 896
    ds_read_b64_tr_b16 a[2:3], v74 offset:1024
    v_smfmac_f32_16x16x64_bf16 v[20:23], v[56:59], a[32:39], v76
    ds_read_b64_tr_b16 a[4:5], v75 offset:0
    v_smfmac_f32_16x16x64_bf16 v[20:23], v[60:63], a[96:103], v76
    buffer_load_dwordx4 v72, s[20:23], s91 offen offset:128 nt lds
    ds_read_b64_tr_b16 a[6:7], v75 offset:1024
    v_smfmac_f32_16x16x64_bf16 v[20:23], v[64:67], a[160:167], v76
    s_add_u32 m0, s66, 2048
    ds_read_b64_tr_b16 a[64:65], v74 offset:512
    v_add_f32 v16, v16, v17
    v_add_f32 v18, v18, v19
    v_smfmac_f32_16x16x64_bf16 v[20:23], v[68:71], a[224:231], v76
    s_add_u32 s91, s93, 16384
    ds_read_b64_tr_b16 a[66:67], v74 offset:1536
    v_add_f32_dpp v32, v18, v16 row_ror:8 row_mask:0xf bank_mask:0x3
    v_smfmac_f32_16x16x64_bf16 v[24:27], v[56:59], a[8:15], v76
    buffer_load_dwordx4 v72, s[20:23], s91 offen nt lds
    ds_read_b64_tr_b16 a[68:69], v75 offset:512
    v_mov_b64 v[16:17], 0
    v_smfmac_f32_16x16x64_bf16 v[24:27], v[60:63], a[72:79], v76
    s_add_u32 m0, s66, 2944
    ds_read_b64_tr_b16 a[70:71], v75 offset:1536
    v_mov_b64 v[18:19], 0
    v_smfmac_f32_16x16x64_bf16 v[24:27], v[64:67], a[136:143], v76
    ds_read_b64_tr_b16 a[128:129], v74 offset:4096
    v_add_f32 v20, v20, v21
    v_add_f32 v22, v22, v23
    v_smfmac_f32_16x16x64_bf16 v[24:27], v[68:71], a[200:207], v76
    buffer_load_dwordx4 v72, s[20:23], s91 offen offset:128 nt lds
    ds_read_b64_tr_b16 a[130:131], v74 offset:5120
    v_add_f32_dpp v32, v20, v22 row_ror:8 row_mask:0xf bank_mask:0xc
    v_smfmac_f32_16x16x64_bf16 v[28:31], v[56:59], a[40:47], v76
    ds_read_b64_tr_b16 a[192:193], v75 offset:4096
    v_mov_b64 v[20:21], 0
    v_smfmac_f32_16x16x64_bf16 v[28:31], v[60:63], a[104:111], v76
    ds_read_b64_tr_b16 a[194:195], v75 offset:5120
    v_mov_b64 v[22:23], 0
    v_smfmac_f32_16x16x64_bf16 v[28:31], v[64:67], a[168:175], v76
    s_waitcnt lgkmcnt(4)
    ds_read_b64_tr_b16 a[32:33], v74 offset:4608
    v_add_f32 v24, v24, v25
    v_add_f32 v26, v26, v27
    v_smfmac_f32_16x16x64_bf16 v[28:31], v[68:71], a[232:239], v76
    s_add_u32 m0, s65, 0
    ds_read_b64_tr_b16 a[34:35], v74 offset:5632
    v_add_f32_dpp v33, v26, v24 row_ror:8 row_mask:0xf bank_mask:0x3
    v_smfmac_f32_16x16x64_bf16 v[16:19], v[56:59], a[16:23], v76
    s_add_u32 s91, s99, 0
    ds_read_b64_tr_b16 a[96:97], v75 offset:4608
    v_mov_b64 v[24:25], 0
    v_smfmac_f32_16x16x64_bf16 v[16:19], v[60:63], a[80:87], v76
    buffer_load_dwordx4 v73, s[16:19], s91 offen nt lds
    ds_read_b64_tr_b16 a[98:99], v75 offset:5632
    v_mov_b64 v[26:27], 0
    v_smfmac_f32_16x16x64_bf16 v[16:19], v[64:67], a[144:151], v76
    s_add_u32 m0, s65, 1024
    ds_read_b64_tr_b16 a[160:161], v74 offset:8192
    v_add_f32 v28, v28, v29
    v_add_f32 v30, v30, v31
    v_smfmac_f32_16x16x64_bf16 v[16:19], v[68:71], a[208:215], v76
    s_add_u32 s91, s99, 4608
    ds_read_b64_tr_b16 a[162:163], v74 offset:9216
    v_add_f32_dpp v33, v28, v30 row_ror:8 row_mask:0xf bank_mask:0xc
    v_smfmac_f32_16x16x64_bf16 v[20:23], v[56:59], a[48:55], v76
    buffer_load_dwordx4 v73, s[16:19], s91 offen nt lds
    ds_read_b64_tr_b16 a[224:225], v75 offset:8192
    v_mov_b64 v[28:29], 0
    v_smfmac_f32_16x16x64_bf16 v[20:23], v[60:63], a[112:119], v76
    s_add_u32 m0, s65, 2048
    ds_read_b64_tr_b16 a[226:227], v75 offset:9216
    v_mov_b64 v[30:31], 0
    v_smfmac_f32_16x16x64_bf16 v[20:23], v[64:67], a[176:183], v76
    s_add_u32 s91, s99, 36864
    ds_read_b64_tr_b16 a[8:9], v74 offset:8704
    v_add_f32 v16, v16, v17
    v_smfmac_f32_16x16x64_bf16 v[20:23], v[68:71], a[240:247], v76
    buffer_load_dwordx4 v73, s[16:19], s91 offen nt lds
    ds_read_b64_tr_b16 a[10:11], v74 offset:9728
    v_add_f32 v18, v18, v19
    v_smfmac_f32_16x16x64_bf16 v[24:27], v[56:59], a[24:31], v76
    s_add_u32 m0, s65, 3072
    ds_read_b64_tr_b16 a[72:73], v75 offset:8704
    v_add_f32_dpp v34, v18, v16 row_ror:8 row_mask:0xf bank_mask:0x3
    v_smfmac_f32_16x16x64_bf16 v[24:27], v[60:63], a[88:95], v76
    s_add_u32 s91, s99, 41472
    ds_read_b64_tr_b16 a[74:75], v75 offset:9728
    v_smfmac_f32_16x16x64_bf16 v[24:27], v[64:67], a[152:159], v76
    buffer_load_dwordx4 v73, s[16:19], s91 offen nt lds
    ds_read_b64_tr_b16 a[132:133], v74 offset:12288
    v_add_f32 v20, v20, v21
    v_smfmac_f32_16x16x64_bf16 v[24:27], v[68:71], a[216:223], v76
    s_waitcnt lgkmcnt(9)
    ds_read_b64_tr_b16 a[134:135], v74 offset:13312
    v_add_f32 v22, v22, v23
    v_smfmac_f32_16x16x64_bf16 v[28:31], v[56:59], a[56:63], v76
    s_add_u32 m0, s65, 4096
    ds_read_b64_tr_b16 a[196:197], v75 offset:12288
    v_add_f32_dpp v34, v20, v22 row_ror:8 row_mask:0xf bank_mask:0xc
    v_smfmac_f32_16x16x64_bf16 v[28:31], v[60:63], a[120:127], v76
    s_add_u32 s91, s99, 73728
    ds_read_b64_tr_b16 a[198:199], v75 offset:13312
    v_smfmac_f32_16x16x64_bf16 v[28:31], v[64:67], a[184:191], v76
    buffer_load_dwordx4 v73, s[16:19], s91 offen nt lds
    ds_read_b64_tr_b16 a[36:37], v74 offset:12800
    v_add_f32 v24, v24, v25
    v_smfmac_f32_16x16x64_bf16 v[28:31], v[68:71], a[248:255], v76
    s_add_u32 m0, s65, 5120
    ds_read_b64_tr_b16 a[38:39], v74 offset:13824
    v_add_f32 v26, v26, v27
    s_nop 1
    v_add_f32_dpp v35, v26, v24 row_ror:8 row_mask:0xf bank_mask:0x3
    s_waitcnt vmcnt(9)
    v_mov_b64 v[40:41], 0
    v_mov_b64 v[42:43], 0
    v_mov_b64 v[44:45], 0
    v_mov_b64 v[46:47], 0
    v_mov_b64 v[48:49], 0
    v_mov_b64 v[50:51], 0
    v_add_f32 v28, v28, v29
    v_add_f32 v30, v30, v31
    s_nop 1
    v_add_f32_dpp v35, v28, v30 row_ror:8 row_mask:0xf bank_mask:0xc
    v_max3_f32 v36, v32, v33, v34
    v_max_f32 v36, v36, v35
    v_mul_f32 v32, s81, v32
    v_mul_f32 v33, s81, v33
    v_max_f32_dpp v36, v36, v36 quad_perm:[1,0,3,2] row_mask:0xf bank_mask:0xf
    v_mul_f32 v34, s81, v34
    v_mul_f32 v35, s81, v35
    v_max_f32_dpp v36, v36, v36 quad_perm:[2,3,0,1] row_mask:0xf bank_mask:0xf
    v_lshl_add_u32 v38, v0, 2, s88
    v_and_b32 v79, 1, v0
    v_max_f32_dpp v36, v36, v36 row_half_mirror row_mask:0xf bank_mask:0xf
    v_mul_u32_u24 v79, 288, v79
    v_lshrrev_b32 v77, 4, v0
    v_max_f32_dpp v36, v36, v36 row_mirror row_mask:0xf bank_mask:0xf
    v_add_u32 v79, s88, v79
    v_lshl_add_u32 v78, v77, 4, v79
    v_max_f32_dpp v36, v36, v36 row_bcast:15 row_mask:0xa bank_mask:0xf
    v_mov_b64 v[52:53], 0
    v_mov_b64 v[54:55], 0
    v_max_f32_dpp v36, v36, v36 row_bcast:31 row_mask:0xc bank_mask:0xf
    v_mul_f32 v36, s81, v36
    v_lshl_add_u32 v79, v77, 3, v79
    v_readlane_b32 s75, v36, 63
    v_mov_b64 v[56:57], 0
    v_mov_b64 v[58:59], 0
    v_subrev_f32 v32, s75, v32
    v_subrev_f32 v33, s75, v33
    v_exp_f32 v32, v32
    v_exp_f32 v33, v33
    v_subrev_f32 v34, s75, v34
    v_subrev_f32 v35, s75, v35
    v_exp_f32 v34, v34
    v_exp_f32 v35, v35
    v_cvt_pk_bf16_f32 v36, v32, v33
    v_cvt_pk_bf16_f32 v37, v34, v35
    ds_write2_b32 v38, v36, v37 offset0:112 offset1:184
    ds_read_b128 v[16:19], v78 offset:448
    ds_read_b128 v[20:23], v78 offset:512
    ds_read_b128 v[24:27], v78 offset:576
    ds_read_b128 v[28:31], v78 offset:640
    v_add_f32 v32, v32, v33
    v_add_f32 v34, v34, v35
    v_add_f32 v33, v32, v34
    v_mov_b32 v32, s75
    s_lshl_b32 s70, s3, 3
    v_add_f32_dpp v33, v33, v33 quad_perm:[1,0,3,2] row_mask:0xf bank_mask:0xf
    s_add_u32 s70, s70, 151296
    v_mov_b32 v34, s70
    v_add_f32_dpp v33, v33, v33 quad_perm:[2,3,0,1] row_mask:0xf bank_mask:0xf
    v_mov_b64 v[60:61], 0
    v_mov_b64 v[62:63], 0
    v_mov_b64 v[64:65], 0
    v_mov_b64 v[66:67], 0
    v_mov_b64 v[68:69], 0
    v_mov_b64 v[70:71], 0
    s_waitcnt lgkmcnt(3)
    v_smfmac_f32_16x16x64_bf16 v[40:43], v[16:19], v[80:87], v76
    s_add_u32 s91, s99, 78336
    ds_read_b64_tr_b16 a[100:101], v75 offset:12800
    v_add_f32_dpp v33, v33, v33 row_half_mirror row_mask:0xf bank_mask:0xf
    v_lshrrev_b32 v38, 2, v0
    v_smfmac_f32_16x16x64_bf16 v[44:47], v[16:19], v[88:95], v76
    buffer_load_dwordx4 v73, s[16:19], s91 offen nt lds
    ds_read_b64_tr_b16 a[102:103], v75 offset:13824
    v_add_f32_dpp v33, v33, v33 row_mirror row_mask:0xf bank_mask:0xf
    v_and_b32 v39, 3, v0
    v_smfmac_f32_16x16x64_bf16 v[48:51], v[16:19], v[96:103], v76
    s_add_u32 m0, s65, 6144
    ds_read_b64_tr_b16 a[164:165], v74 offset:16384
    v_add_f32_dpp v33, v33, v33 row_bcast:15 row_mask:0xa bank_mask:0xf
    v_lshlrev_b32 v39, 2, v39
    v_smfmac_f32_16x16x64_bf16 v[52:55], v[16:19], v[104:111], v76
    s_add_u32 s91, s99, 110592
    ds_read_b64_tr_b16 a[166:167], v74 offset:17408
    v_add_f32_dpp v33, v33, v33 row_bcast:31 row_mask:0xc bank_mask:0xf
    v_lshl_add_u32 v38, v38, 7, v39
    v_smfmac_f32_16x16x64_bf16 v[56:59], v[16:19], v[112:119], v76
    buffer_load_dwordx4 v73, s[16:19], s91 offen nt lds
    ds_read_b64_tr_b16 a[228:229], v75 offset:16384
    s_lshl_b32 s70, s63, 3
    s_sub_u32 s70, 2048, s70
    s_add_u32 s70, s70, s89
    v_mov_b32 v39, 1073741824
    v_readlane_b32 s71, v33, 63
    v_smfmac_f32_16x16x64_bf16 v[60:63], v[16:19], v[120:127], v76
    s_add_u32 m0, s65, 7168
    ds_read_b64_tr_b16 a[230:231], v75 offset:17408
    v_writelane_b32 v39, s70, 0
    s_add_u32 s73, s45, 33280
    v_mov_b32 v33, s71
    v_smfmac_f32_16x16x64_bf16 v[64:67], v[16:19], v[128:135], v76
    s_add_u32 s91, s99, 115200
    ds_read_b64_tr_b16 a[12:13], v74 offset:16896
    ds_write_b64 v34, v[32:33]
    v_mov_b32 v34, 151296
    v_smfmac_f32_16x16x64_bf16 v[68:71], v[16:19], v[136:143], v76
    buffer_load_dwordx4 v73, s[16:19], s91 offen nt lds
    ds_read_b64_tr_b16 a[14:15], v74 offset:17920
    v_and_b32 v32, 7, v0
    s_waitcnt lgkmcnt(11)
    v_smfmac_f32_16x16x64_bf16 v[40:43], v[20:23], v[144:151], v76
    s_add_u32 m0, s66, 4096
    ds_read_b64_tr_b16 a[76:77], v75 offset:16896
    v_lshlrev_b32 v32, 4, v32
    v_smfmac_f32_16x16x64_bf16 v[44:47], v[20:23], v[152:159], v76
    s_add_u32 s91, s93, 32768
    ds_read_b64_tr_b16 a[78:79], v75 offset:17920
    v_bfe_u32 v33, v0, 3, 1
    v_smfmac_f32_16x16x64_bf16 v[48:51], v[20:23], v[160:167], v76
    s_waitcnt lgkmcnt(3)
    s_barrier
    ds_read_b128 v[8:11], v34
    ds_read_b128 v[12:15], v34 offset:16
    v_smfmac_f32_16x16x64_bf16 v[52:55], v[20:23], v[168:175], v76
    buffer_load_dwordx4 v72, s[20:23], s91 offen nt lds
    ds_read_b64 v[16:17], v79 offset:576
    v_lshl_add_u32 v32, v33, 9, v32
    v_smfmac_f32_16x16x64_bf16 v[56:59], v[20:23], v[176:183], v76
    s_add_u32 m0, s66, 4992
    ds_read_b64 v[18:19], v79 offset:608
    v_lshrrev_b32 v33, 4, v0
    v_smfmac_f32_16x16x64_bf16 v[60:63], v[20:23], v[184:191], v76
    v_lshl_add_u32 v32, v33, 7, v32
    v_smfmac_f32_16x16x64_bf16 v[64:67], v[20:23], v[192:199], v76
    buffer_load_dwordx4 v72, s[20:23], s91 offen offset:128 nt lds
    s_waitcnt lgkmcnt(2)
    v_max3_f32 v36, v8, v10, v12
    v_max_f32 v36, v36, v14
    v_smfmac_f32_16x16x64_bf16 v[68:71], v[20:23], v[200:207], v76
    s_add_u32 m0, s66, 6144
    v_sub_f32 v8, v8, v36
    v_sub_f32 v10, v10, v36
    v_smfmac_f32_16x16x64_bf16 v[40:43], v[24:27], v[208:215], v76
    s_add_u32 s91, s93, 49152
    v_exp_f32 v8, v8
    v_sub_f32 v12, v12, v36
    v_smfmac_f32_16x16x64_bf16 v[44:47], v[24:27], v[216:223], v76
    buffer_load_dwordx4 v72, s[20:23], s91 offen nt lds
    v_exp_f32 v10, v10
    v_sub_f32 v14, v14, v36
    v_smfmac_f32_16x16x64_bf16 v[48:51], v[24:27], v[224:231], v76
    s_add_u32 m0, s66, 7040
    v_exp_f32 v12, v12
    v_mul_f32 v37, v8, v9
    v_smfmac_f32_16x16x64_bf16 v[52:55], v[24:27], v[232:239], v76
    v_exp_f32 v14, v14
    v_fmac_f32 v37, v10, v11
    v_smfmac_f32_16x16x64_bf16 v[40:43], v[28:31], a[128:135], v76
    buffer_load_dwordx4 v72, s[20:23], s91 offen offset:128 nt lds
    v_fmac_f32 v37, v12, v13
    v_smfmac_f32_16x16x64_bf16 v[44:47], v[28:31], a[192:199], v76
    v_fmac_f32 v37, v14, v15
    v_smfmac_f32_16x16x64_bf16 v[48:51], v[28:31], a[32:39], v76
    buffer_store_dwordx2 v[36:37], v39, s[40:43], s73 offen sc1
    v_smfmac_f32_16x16x64_bf16 v[52:55], v[28:31], a[96:103], v76
    v_lshl_add_u32 v33, v33, 2, v0
    v_smfmac_f32_16x16x64_bf16 v[56:59], v[28:31], a[160:167], v76
    v_and_b32 v33, 7, v33
    v_smfmac_f32_16x16x64_bf16 v[60:63], v[28:31], a[224:231], v76
    v_lshlrev_b32 v33, 3, v33
    v_smfmac_f32_16x16x64_bf16 v[64:67], v[28:31], a[8:15], v76
    s_add_u32 s79, s46, 33280
    v_and_b32 v34, 15, v0
    v_smfmac_f32_16x16x64_bf16 v[68:71], v[28:31], a[72:79], v76
    v_lshrrev_b32 v35, 4, v0
    s_waitcnt lgkmcnt(0)
    v_smfmac_f32_16x16x32_bf16 v[56:59], v[16:17], v[240:243], v76
    v_mul_u32_u24 v35, 576, v35
    v_smfmac_f32_16x16x32_bf16 v[60:63], v[16:17], v[244:247], v76
    v_lshl_add_u32 v34, v34, 2, v35
    v_smfmac_f32_16x16x32_bf16 v[64:67], v[16:17], v[248:251], v76
    s_add_u32 s70, s88, 1024
    v_add_u32 v34, s70, v34
    v_lshlrev_b32 v35, 3, v0
    v_smfmac_f32_16x16x32_bf16 v[68:71], v[16:17], v[252:255], v76
    v_add_u32 v35, 148480, v35
    v_add_f32 v40, v40, v41
    v_smfmac_f32_16x16x32_bf16 v[56:59], v[18:19], a[0:3], v76
    v_add_f32 v44, v44, v45
    v_smfmac_f32_16x16x32_bf16 v[60:63], v[18:19], a[4:7], v76
    v_add_f32 v48, v48, v49
    v_smfmac_f32_16x16x32_bf16 v[64:67], v[18:19], a[64:67], v76
    v_add_f32 v52, v52, v53
    v_smfmac_f32_16x16x32_bf16 v[68:71], v[18:19], a[68:71], v76
    ds_write2_b32 v34, v40, v44 offset0:0 offset1:16
    ds_write2_b32 v34, v48, v52 offset0:32 offset1:48
    v_mov_b32 v24, -1
    v_mov_b32 v25, -1
    v_mov_b32 v26, -1
    v_add_f32 v56, v56, v57
    v_add_f32 v60, v60, v61
    ds_write2_b32 v34, v56, v60 offset0:64 offset1:80
    v_add_f32 v64, v64, v65
    v_add_f32 v68, v68, v69
    ds_write2_b32 v34, v64, v68 offset0:96 offset1:112
    v_mov_b32 v27, -1
    v_mov_b32 v28, -1
    v_mov_b32 v29, -1
    v_mov_b32 v30, -1
    v_mov_b32 v31, -1
    v_mov_b32 v72, -1
    v_mov_b32 v73, -1
    s_waitcnt vmcnt(5)
    s_cmp_lg_u32 s3, 0
    s_waitcnt lgkmcnt(0)
    s_barrier
    s_cbranch_scc1 L_skip_253
    ds_read_b64 v[16:17], v35
    ds_read_b64 v[18:19], v35 offset:4096
    ds_read_b64 v[20:21], v35 offset:8192
    ds_read_b64 v[22:23], v35 offset:12288
    s_waitcnt lgkmcnt(3)
    v_pk_mul_f32 v[16:17], v[16:17], v[8:9] op_sel_hi:[1,0]
    s_waitcnt lgkmcnt(2)
    v_pk_fma_f32 v[16:17], v[18:19], v[10:11], v[16:17] op_sel_hi:[1,0,1]
    s_waitcnt lgkmcnt(1)
    v_pk_fma_f32 v[16:17], v[20:21], v[12:13], v[16:17] op_sel_hi:[1,0,1]
    s_waitcnt lgkmcnt(0)
    v_pk_fma_f32 v[16:17], v[22:23], v[14:15], v[16:17] op_sel_hi:[1,0,1]
    v_cvt_pk_bf16_f32 v16, v16, v17
    buffer_store_dword v16, v38, s[40:43], s73 offen sc1
L_skip_253:
    s_cmp_ge_u32 s61, 18
    s_cbranch_scc1 L_idle_254
    buffer_load_dwordx2 v[72:73], v33, s[40:43], s79 offen offset:2048 sc1
    buffer_load_dwordx4 v[24:27], v32, s[40:43], s79 offen offset:0 sc1
    buffer_load_dwordx4 v[28:31], v32, s[40:43], s79 offen offset:1024 sc1
    v_lshrrev_b32 v18, 5, v0
    s_add_u32 s70, s88, 3584
    v_lshl_add_u32 v78, v0, 2, s70
    s_and_b32 s90, s3, 1
    s_mov_b32 s71, 151040
    v_and_b32 v74, 7, v0
    v_subrev_u32 v18, s90, v18
    v_lshlrev_b32 v74, 4, v74
    v_bfe_u32 v79, v0, 2, 1
    v_mul_i32_i24 v18, 19968, v18
    v_lshl_add_u32 v79, v79, 7, v74
    v_bfe_u32 v75, v0, 4, 1
    v_add_u32 v18, v18, v2
    v_lshl_add_u32 v75, v75, 13, v74
    v_bfe_u32 v8, v0, 3, 1
    v_xor_b32 v19, 32, v18
    v_lshl_add_u32 v75, v8, 11, v75
    v_lshl_add_u32 v74, v8, 8, v74
    ds_read_b64_tr_b16 v[40:41], v18 offset:0
    v_lshlrev_b32 v8, 12, v8
    v_add3_u32 v79, v79, v8, s71
    ds_read_b64_tr_b16 v[42:43], v18 offset:1024
    s_and_b32 s70, s61, 30
    buffer_load_dwordx2 v[72:73], v33, s[40:43], s79 offen offset:2048 sc1
    buffer_load_dwordx4 v[24:27], v32, s[40:43], s79 offen offset:0 sc1
    buffer_load_dwordx4 v[28:31], v32, s[40:43], s79 offen offset:1024 sc1
    s_add_u32 s73, s70, 36
    ds_read_b64_tr_b16 v[44:45], v19 offset:0
    s_and_b32 s71, s73, -4
    s_add_u32 s73, s73, s71
    ds_read_b64_tr_b16 v[46:47], v19 offset:1024
    s_lshl_b32 s73, s73, 11
    s_add_u32 s73, s73, 901120
    ds_read_b64_tr_b16 v[48:49], v18 offset:2048
    s_and_b32 s71, s61, 1
    s_lshl_b32 s69, s60, 1
    ds_read_b64_tr_b16 v[50:51], v18 offset:3072
    s_add_u32 s69, s69, s71
    s_lshl_b32 s69, s69, 7
    ds_read_b64_tr_b16 v[52:53], v19 offset:2048
    s_add_u32 s73, s73, s69
    s_add_u32 s70, s70, s61
    ds_read_b64_tr_b16 v[54:55], v19 offset:3072
    s_lshl_b32 s70, s70, 7
    s_add_u32 s69, s58, s70
    ds_read_b64_tr_b16 v[56:57], v18 offset:4096
    s_add_u32 s69, s69, 55296
    ds_read_b64_tr_b16 v[58:59], v18 offset:5120
    ds_read_b64_tr_b16 v[60:61], v19 offset:4096
    ds_read_b64_tr_b16 v[62:63], v19 offset:5120
    ds_read_b64_tr_b16 v[64:65], v18 offset:6144
    ds_read_b64_tr_b16 v[66:67], v18 offset:7168
    ds_read_b64_tr_b16 v[68:69], v19 offset:6144
    ds_read_b64_tr_b16 v[70:71], v19 offset:7168
    s_waitcnt vmcnt(7)
    v_bfe_u32 v208, v0, 4, 1
    v_bfe_u32 v209, v0, 2, 2
    v_lshl_add_u32 v208, v208, 3, v209
    v_mul_u32_u24 v208, 8192, v208
    v_lshrrev_b32 v209, 5, v0
    v_lshl_add_u32 v208, v209, 6, v208
    v_bfe_u32 v209, v0, 4, 1
    v_lshlrev_b32 v209, 1, v209
    v_xor_b32 v209, v0, v209
    v_and_b32 v209, 3, v209
    v_lshl_add_u32 v208, v209, 4, v208
    s_and_b32 s90, s3, 1
    s_mul_i32 s90, s90, 131008
    s_add_u32 s90, s90, s67
    v_add_u32 v208, s90, v208
    s_mov_b32 s80, 0
L_spin_256:
    buffer_load_dwordx4 v[24:27], v32, s[40:43], s79 offen offset:0 sc1
    buffer_load_dwordx4 v[28:31], v32, s[40:43], s79 offen offset:1024 sc1
    s_add_u32 s80, s80, 1024
    s_cbranch_scc1 L_abort
    s_waitcnt vmcnt(2)
    v_cmp_u_f32 vcc, v27, v31
    s_cbranch_vccnz L_spin_256
    s_waitcnt lgkmcnt(0)
    v_mov_b64 v[76:77], v[72:73]
    v_mfma_f32_16x16x32_bf16 v[16:19], v[24:27], v[48:51], 0
    s_nop 0
    v_max_f32_dpp v34, v76, v76 row_ror:1 row_mask:0xf bank_mask:0xf
    v_mfma_f32_16x16x32_bf16 v[16:19], v[28:31], v[64:67], v[16:19]
    s_nop 0
    v_max_f32_dpp v34, v34, v34 row_ror:2 row_mask:0xf bank_mask:0xf
    v_mfma_f32_16x16x32_bf16 v[12:15], v[24:27], v[44:47], 0
    s_nop 0
    v_max_f32_dpp v34, v34, v34 row_ror:4 row_mask:0xf bank_mask:0xf
    v_sub_f32 v34, v76, v34
    v_mfma_f32_16x16x32_bf16 v[12:15], v[28:31], v[60:63], v[12:15]
    v_exp_f32 v34, v34
    v_mfma_f32_16x16x32_bf16 v[8:11], v[24:27], v[40:43], 0
    v_mul_f32 v35, v34, v77
    v_mfma_f32_16x16x32_bf16 v[8:11], v[28:31], v[56:59], v[8:11]
    v_mov_b32_dpp v36, v34 row_newbcast:0 row_mask:0xf bank_mask:0xf
    v_mov_b32_dpp v37, v34 row_newbcast:1 row_mask:0xf bank_mask:0xf
    v_mfma_f32_16x16x32_bf16 v[20:23], v[24:27], v[52:55], 0
    v_mov_b32_dpp v38, v34 row_newbcast:2 row_mask:0xf bank_mask:0xf
    v_mov_b32_dpp v39, v34 row_newbcast:3 row_mask:0xf bank_mask:0xf
    v_mfma_f32_16x16x32_bf16 v[20:23], v[28:31], v[68:71], v[20:23]
    v_add_f32_dpp v35, v35, v35 row_ror:1 row_mask:0xf bank_mask:0xf
    v_pk_mul_f32 v[16:17], v[16:17], v[36:37]
    v_pk_fma_f32 v[16:17], v[18:19], v[38:39], v[16:17]
    v_add_f32 v16, v16, v17
    v_add_f32_dpp v35, v35, v35 row_ror:2 row_mask:0xf bank_mask:0xf
    v_pk_mul_f32 v[12:13], v[12:13], v[36:37]
    v_pk_fma_f32 v[12:13], v[14:15], v[38:39], v[12:13]
    v_add_f32 v12, v12, v13
    v_add_f32_dpp v35, v35, v35 row_ror:4 row_mask:0xf bank_mask:0xf
    v_pk_mul_f32 v[8:9], v[8:9], v[36:37]
    v_pk_fma_f32 v[8:9], v[10:11], v[38:39], v[8:9]
    v_add_f32 v8, v8, v9
    v_permlane32_swap_b32 v16, v12
    v_rcp_f32 v35, v35
    v_add_f32 v8, v8, v12
    v_pk_mul_f32 v[20:21], v[20:21], v[36:37]
    v_pk_fma_f32 v[20:21], v[22:23], v[38:39], v[20:21]
    v_add_f32 v20, v20, v21
    v_add_f32 v20, v20, v16
    s_nop 1
    v_permlane16_swap_b32 v8, v20
    v_add_f32 v34, v8, v20
    v_mul_f32 v34, v34, v35
    ds_write_b32 v78, v34
    v_cmp_u_f32 vcc, v34, v34
    s_cbranch_vccnz L_mlagain_259
    s_cmp_lg_u32 s3, 0
    s_waitcnt lgkmcnt(0)
    s_barrier
    s_cbranch_scc1 L_skip_260
    s_mov_b32 exec_hi, 0
    ds_read_b128 v[8:11], v79
    ds_read_b128 v[12:15], v79 offset:8192
    s_waitcnt vmcnt(0) lgkmcnt(0)
    v_pk_add_f32 v[32:33], v[8:9], v[12:13]
    v_pk_add_f32 v[34:35], v[10:11], v[14:15]
    buffer_store_dwordx4 v[32:35], v75, s[40:43], s73 offen sc1
    s_mov_b64 exec, -1
    s_branch L_skip_260x
L_skip_260:
    s_waitcnt vmcnt(0)
L_skip_260x:
L_join_255:
    s_add_u32 m0, s65, 8192
    s_add_u32 s91, s98, 0
    buffer_load_dwordx4 v208, s[24:27], s91 offen nt lds
    s_add_u32 m0, s65, 9216
    s_add_u32 s91, s98, 32768
    buffer_load_dwordx4 v208, s[24:27], s91 offen nt lds
    s_add_u32 m0, s65, 10240
    s_add_u32 s91, s98, 262144
    buffer_load_dwordx4 v208, s[24:27], s91 offen nt lds
    s_add_u32 m0, s65, 11264
    s_add_u32 s91, s98, 294912
    buffer_load_dwordx4 v208, s[24:27], s91 offen nt lds
    s_add_u32 m0, s65, 12288
    s_add_u32 s91, s98, 524288
    buffer_load_dwordx4 v208, s[24:27], s91 offen nt lds
    s_add_u32 m0, s65, 13312
    s_add_u32 s91, s98, 557056
    buffer_load_dwordx4 v208, s[24:27], s91 offen nt lds
    v_bfe_u32 v16, v0, 2, 3
    v_lshlrev_b32 v16, 13, v16
    v_lshrrev_b32 v17, 5, v0
    v_lshl_add_u32 v16, v17, 6, v16
    v_bfe_u32 v17, v0, 4, 1
    v_lshlrev_b32 v17, 1, v17
    v_xor_b32 v17, v0, v17
    v_and_b32 v17, 3, v17
    v_lshl_add_u32 v16, v17, 4, v16
    s_lshl_b32 s90, s63, 2
    s_add_u32 s90, s90, s3
    s_lshl_b32 s90, s90, 9
    s_lshr_b32 s91, s64, 21
    s_add_u32 s90, s90, s91
    s_lshl_b32 s90, s90, 8
    s_add_u32 m0, s65, 16384
    s_add_u32 s91, s90, 0
    buffer_load_dwordx4 v16, s[28:31], s91 offen nt lds
    s_add_u32 m0, s65, 17280
    s_nop 0
    buffer_load_dwordx4 v16, s[28:31], s91 offen offset:128 nt lds
    s_add_u32 m0, s65, 18432
    s_add_u32 s91, s90, 65536
    buffer_load_dwordx4 v16, s[28:31], s91 offen nt lds
    s_add_u32 m0, s65, 19328
    s_nop 0
    buffer_load_dwordx4 v16, s[28:31], s91 offen offset:128 nt lds
    s_add_u32 s79, s44, s59
    s_add_u32 s79, s79, 13312
    s_cmp_ge_u32 s63, 6
    s_cbranch_scc1 L_qidle_261
    v_lshrrev_b32 v14, 3, v0
    v_lshlrev_b32 v12, 8, v14
    v_and_b32 v13, 7, v0
    v_lshl_add_u32 v12, v13, 4, v12
    s_mul_i32 s70, s63, 3
    s_add_u32 s70, s70, s3
    s_add_u32 s76, s70, 36
    s_and_b32 s71, s76, -4
    s_add_u32 s76, s76, s71
    s_lshl_b32 s76, s76, 11
    s_add_u32 s76, s76, 901120
    s_add_u32 s76, s76, s52
    s_sub_u32 s70, s70, s60
    s_lshl_b32 s70, s70, 8
    s_add_u32 s70, s70, s58
    s_add_u32 s70, s70, 55296
    s_sub_u32 s70, s70, s76
    s_cmp_eq_u32 s3, 3
    s_cselect_b32 s70, 1073741824, 0
    v_add_u32 v12, s70, v12
    v_lshrrev_b32 v14, 4, v0
    v_lshlrev_b32 v13, 3, v13
    v_lshl_add_u32 v13, v14, 1, v13
    s_lshl_b32 s70, s3, 6
    s_add_u32 s70, s70, 150784
    v_add_u32 v13, s70, v13
    v_lshlrev_b32 v14, 4, v14
    v_and_b32 v15, 3, v0
    v_lshl_add_u32 v14, v15, 6, v14
    v_add_u32 v14, 150784, v14
    v_mov_b32 v24, -1
    v_mov_b32 v25, -1
    v_mov_b32 v26, -1
    v_mov_b32 v27, -1
    v_mov_b32 v28, -1
    v_mov_b32 v29, -1
    v_mov_b32 v30, -1
    v_mov_b32 v31, -1
    s_lshl_b32 s73, s63, 8
    s_add_u32 s73, s73, s79
    buffer_load_dwordx4 v[24:27], v12, s[40:43], s76 offen sc1
    buffer_load_dwordx4 v[28:31], v12, s[40:43], s76 offen offset:128 sc1
    s_waitcnt vmcnt(6)
    s_barrier
    v_lshrrev_b32 v22, 5, v0
    s_and_b32 s90, s3, 1
    v_subrev_u32 v22, s90, v22
    v_mul_i32_i24 v22, 19968, v22
    v_add_u32 v22, v22, v2
    v_xor_b32 v23, 32, v22
    ds_read_b64_tr_b16 v[36:37], v22 offset:8192
    ds_read_b64_tr_b16 v[38:39], v22 offset:9216
    ds_read_b64_tr_b16 v[40:41], v23 offset:8192
    ds_read_b64_tr_b16 v[42:43], v23 offset:9216
    ds_read_b64_tr_b16 v[44:45], v22 offset:10240
    ds_read_b64_tr_b16 v[46:47], v22 offset:11264
    ds_read_b64_tr_b16 v[48:49], v23 offset:10240
    ds_read_b64_tr_b16 v[50:51], v23 offset:11264
    ds_read_b64_tr_b16 v[52:53], v22 offset:12288
    ds_read_b64_tr_b16 v[54:55], v22 offset:13312
    ds_read_b64_tr_b16 v[56:57], v23 offset:12288
    ds_read_b64_tr_b16 v[58:59], v23 offset:13312
    s_mov_b32 s80, 0
    v_cmp_u_f32 vcc, v27, v31
    s_cbranch_vccz L_go_264
    s_branch L_chk_265
L_spin_263:
    s_waitcnt vmcnt(16)
    buffer_load_dwordx4 v[24:27], v12, s[40:43], s76 offen sc1
    buffer_load_dwordx4 v[28:31], v12, s[40:43], s76 offen offset:128 sc1
    s_add_u32 s80, s80, 1024
    s_cbranch_scc1 L_abort
L_chk_265:
    v_cmp_u_f32 vcc, v27, v31
    s_cbranch_vccz L_go_264
    v_cmp_u_f32 vcc, v27, v31
    s_cbranch_vccz L_go_264
    v_cmp_u_f32 vcc, v27, v31
    s_cbranch_vccz L_go_264
    v_cmp_u_f32 vcc, v27, v31
    s_cbranch_vccz L_go_264
    v_cmp_u_f32 vcc, v27, v31
    s_cbranch_vccz L_go_264
    v_cmp_u_f32 vcc, v27, v31
    s_cbranch_vccz L_go_264
    v_cmp_u_f32 vcc, v27, v31
    s_cbranch_vccz L_go_264
    v_cmp_u_f32 vcc, v27, v31
    s_cbranch_vccz L_go_264
    v_cmp_u_f32 vcc, v27, v31
    s_cbranch_vccz L_go_264
    v_cmp_u_f32 vcc, v27, v31
    s_cbranch_vccnz L_spin_263
L_go_264:
    v_pk_add_f32 v[8:9], v[24:25], v[28:29]
    v_pk_add_f32 v[10:11], v[26:27], v[30:31]
    s_nop 1
    v_permlane32_swap_b32 v8, v10
    v_permlane32_swap_b32 v9, v11
    v_add_f32 v8, v8, v10
    v_add_f32 v9, v9, v11
    s_nop 1
    v_permlane16_swap_b32 v8, v9
    v_add_f32 v8, v8, v9
    s_nop 1
    v_add_f32_dpp v8, v8, v8 row_ror:8 row_mask:0xf bank_mask:0xf
    v_add_f32 v8, v8, v4
    v_cvt_pk_bf16_f32 v9, v8, v8
    ds_write_b16 v13, v9
    v_cmp_u_f32 vcc, v8, v8
    s_cbranch_vccnz L_spin_263
    v_lshlrev_b32 v4, 16, v9
    s_waitcnt lgkmcnt(0)
    s_barrier
    ds_read_b128 v[76:79], v14
    s_waitcnt lgkmcnt(0)
    v_mfma_f32_16x16x32_bf16 v[32:35], v[76:79], v[76:79], 0
    v_mfma_f32_16x16x32_bf16 v[8:11], v[76:79], v[36:39], 0
    v_lshlrev_b32 v36, 4, v0
    v_and_b32 v37, 32, v0
    v_mfma_f32_16x16x32_bf16 v[12:15], v[76:79], v[40:43], 0
    v_lshl_add_u32 v37, v37, 26, v36
    v_mov_b32 v40, -1
    v_mfma_f32_16x16x32_bf16 v[16:19], v[76:79], v[44:47], 0
    v_mov_b32 v41, -1
    v_mov_b32 v42, -1
    v_mfma_f32_16x16x32_bf16 v[20:23], v[76:79], v[48:51], 0
    v_mov_b32 v43, -1
    v_mov_b32 v44, -1
    s_waitcnt vmcnt(0)
    v_mfma_f32_16x16x32_bf16 v[24:27], v[76:79], v[52:55], 0
    v_mov_b32 v45, -1
    v_mov_b32 v46, -1
    v_mfma_f32_16x16x32_bf16 v[28:31], v[76:79], v[56:59], 0
    v_mov_b32 v47, -1
    s_mov_b64 exec, 0xffff
    v_mov_b32_dpp v10, v32 row_newbcast:0 row_mask:0xf bank_mask:0xf
    v_mov_b32_dpp v11, v35 row_newbcast:0 row_mask:0xf bank_mask:0xf
    v_add_f32 v8, v8, v17
    v_add_f32_dpp v10, v33, v10 row_newbcast:1 row_mask:0xf bank_mask:0xf
    v_add_f32_dpp v11, v35, v11 row_newbcast:1 row_mask:0xf bank_mask:0xf
    v_add_f32 v9, v12, v21
    v_add_f32_dpp v10, v34, v10 row_newbcast:2 row_mask:0xf bank_mask:0xf
    v_add_f32_dpp v11, v35, v11 row_newbcast:2 row_mask:0xf bank_mask:0xf
    v_add_f32 v8, v8, v26
    v_add_f32 v9, v9, v30
    buffer_store_dwordx4 v[8:11], v36, s[40:43], s73 offen sc1
    s_mov_b64 exec, -1
L_qjoin_262:
    buffer_load_dwordx4 v[40:43], v36, s[40:43], s79 offen sc1
    buffer_load_dwordx4 v[44:47], v37, s[40:43], s79 offen offset:1024 sc1
    v_and_b32 v26, 7, v0
    v_lshlrev_b32 v26, 6, v26
    v_bfe_u32 v27, v0, 3, 1
    v_lshl_add_u32 v26, v27, 11, v26
    v_lshlrev_b32 v27, 3, v0
    v_and_b32 v27, 32, v27
    v_xor_b32 v27, v0, v27
    v_and_b32 v27, 48, v27
    v_add3_u32 v26, v26, v27, s65
    ds_read_b128 v[60:63], v26 offset:16384
    ds_read_b128 v[64:67], v26 offset:16896
    ds_read_b128 v[68:71], v26 offset:17408
    ds_read_b128 v[72:75], v26 offset:17920
    v_lshrrev_b32 v22, 4, v0
    v_and_b32 v23, 1, v22
    v_lshlrev_b32 v22, 4, v22
    v_mul_u32_u24 v23, 4080, v23
    v_add_u32 v22, v23, v22
    v_and_b32 v23, 15, v0
    v_lshl_add_u32 v22, v23, 1, v22
    s_lshl_b32 s70, s3, 6
    s_add_u32 s70, s70, 154880
    v_add_u32 v22, s70, v22
    v_lshrrev_b32 v25, 4, v0
    v_lshlrev_b32 v24, 4, v25
    v_add_u32 v24, 154880, v24
    v_lshlrev_b32 v25, 3, v25
    v_and_b32 v21, 1, v0
    v_lshl_add_u32 v21, v21, 13, v25
    s_lshl_b32 s69, s61, 2
    s_add_u32 s69, s69, s3
    s_lshl_b32 s69, s69, 5
    s_and_b32 s77, s60, 6
    s_add_u32 s77, s77, s60
    s_lshl_b32 s77, s77, 12
    s_add_u32 s77, s77, 1196032
    s_add_u32 s73, s69, s77
    s_add_u32 s69, s69, s58
    s_add_u32 s69, s69, 68608
    s_sub_u32 s77, s69, s73
    s_sub_u32 s77, s77, s52
    s_mov_b32 s80, 0
L_spin_269:
    buffer_load_dwordx4 v[40:43], v36, s[40:43], s79 offen sc1
    buffer_load_dwordx4 v[44:47], v37, s[40:43], s79 offen offset:1024 sc1
    s_add_u32 s80, s80, 1024
    s_cbranch_scc1 L_abort
    s_waitcnt vmcnt(2)
    v_cmp_u_f32 vcc, v43, v47
    s_cbranch_vccnz L_spin_269
    v_pk_add_f32 v[12:13], v[40:41], v[44:45]
    v_pk_add_f32 v[14:15], v[42:43], v[46:47]
    s_nop 0
    v_permlane32_swap_b32 v12, v13
    v_permlane32_swap_b32 v14, v15
    v_add_f32 v12, v12, v13
    v_add_f32 v14, v14, v15
    s_nop 1
    v_permlane16_swap_b32 v12, v14
    v_add_f32 v12, v12, v14
    s_nop 0
    v_readlane_b32 s71, v12, 48
    v_readlane_b32 s72, v12, 16
    v_cmp_u_f32 vcc, v12, v12
    v_fma_f32 v13, -s71, v6, v12
    v_cvt_pk_bf16_f32 v13, v13, v13
    ds_write_b16 v22, v13
    s_cbranch_vccnz L_spin_269
    v_mov_b32 v14, 0x3ae38e39
    v_mul_f32 v15, s71, v14
    v_mul_f32 v14, s72, v14
    v_fma_f32 v14, -v15, v15, v14
    v_max_f32 v14, 0, v14
    v_add_f32 v14, 0x3727c5ac, v14
    v_rsq_f32 v14, v14
    s_waitcnt lgkmcnt(0)
    s_barrier
    ds_read_b128 v[28:31], v24 offset:0
    ds_read_b128 v[32:35], v24 offset:64
    ds_read_b128 v[48:51], v24 offset:128
    ds_read_b128 v[52:55], v24 offset:192
    v_mul_f32 v14, 0x3e0293ee, v14
    s_nop 0
    v_readfirstlane_b32 s81, v14
    s_waitcnt lgkmcnt(3)
    v_mfma_f32_16x16x32_bf16 v[8:11], v[60:63], v[28:31], 0
    s_waitcnt lgkmcnt(2)
    v_mfma_f32_16x16x32_bf16 v[8:11], v[64:67], v[32:35], v[8:11]
    s_waitcnt lgkmcnt(1)
    v_mfma_f32_16x16x32_bf16 v[8:11], v[68:71], v[48:51], v[8:11]
    s_waitcnt lgkmcnt(0)
    v_mfma_f32_16x16x32_bf16 v[8:11], v[72:75], v[52:55], v[8:11]
    s_mov_b32 exec_lo, 0x30003
    s_mov_b32 exec_hi, 0x30003
    s_nop 5
    v_mul_f32 v8, s81, v8
    v_mul_f32 v9, s81, v9
    v_mul_f32 v10, s81, v10
    v_mul_f32 v11, s81, v11
    v_cvt_pk_bf16_f32 v78, v8, v9
    v_cvt_pk_bf16_f32 v79, v10, v11
    buffer_store_dwordx2 v[78:79], v21, s[40:43], s73 offen sc1
    s_mov_b64 exec, -1
    s_barrier
    v_lshrrev_b32 v24, 4, v0
    v_bfe_u32 v25, v0, 2, 2
    v_lshl_add_u32 v24, v24, 3, v25
    v_mul_u32_u24 v24, 1152, v24
    v_bfe_u32 v25, v0, 4, 1
    v_lshlrev_b32 v25, 1, v25
    v_xor_b32 v25, v0, v25
    v_and_b32 v25, 3, v25
    v_lshl_add_u32 v24, v25, 4, v24
    v_add_u32 v24, s68, v24
    s_add_u32 m0, s65, 0
    s_add_u32 s91, s99, 0
    buffer_load_dwordx4 v24, s[36:39], s91 offen  lds
    s_add_u32 m0, s65, 1024
    s_add_u32 s91, s99, 4608
    buffer_load_dwordx4 v24, s[36:39], s91 offen  lds
    s_add_u32 m0, s65, 2048
    s_add_u32 s91, s99, 36864
    buffer_load_dwordx4 v24, s[36:39], s91 offen  lds
    s_add_u32 m0, s65, 3072
    s_add_u32 s91, s99, 41472
    buffer_load_dwordx4 v24, s[36:39], s91 offen  lds
    s_add_u32 m0, s65, 4096
    s_add_u32 s91, s99, 73728
    buffer_load_dwordx4 v24, s[36:39], s91 offen  lds
    s_add_u32 m0, s65, 5120
    s_add_u32 s91, s99, 78336
    buffer_load_dwordx4 v24, s[36:39], s91 offen  lds
    v_bfe_u32 v72, v0, 2, 3
    v_lshlrev_b32 v72, 11, v72
    v_lshrrev_b32 v73, 5, v0
    v_lshl_add_u32 v72, v73, 6, v72
    v_bfe_u32 v73, v0, 4, 1
    v_lshlrev_b32 v73, 1, v73
    v_xor_b32 v73, v0, v73
    v_and_b32 v73, 3, v73
    v_lshl_add_u32 v72, v73, 4, v72
    v_and_b32 v74, 0x2000, v72
    v_add_u32 v72, v72, v74
    v_add_u32 v74, 32768, v72
    s_mov_b32 s71, 147456
    v_and_b32 v76, 7, v0
    v_lshlrev_b32 v76, 6, v76
    v_bfe_u32 v77, v0, 3, 1
    v_lshl_add_u32 v76, v77, 11, v76
    v_lshlrev_b32 v77, 3, v0
    v_and_b32 v77, 32, v77
    v_xor_b32 v77, v0, v77
    v_and_b32 v77, 48, v77
    v_add3_u32 v76, v76, v77, s71
    s_lshl_b32 s70, s3, 12
    s_sub_u32 s70, s70, 65536
    v_add_u32 v77, s70, v76
    v_lshlrev_b32 v73, 6, v0
    v_bfe_u32 v75, v0, 1, 3
    v_lshl_add_u32 v73, v75, 2, v73
    v_add_u32 v73, s88, v73
    s_lshl_b32 s76, s86, 10
    s_lshl_b32 s70, s3, 8
    s_add_u32 s76, s76, s70
    s_add_u32 s76, s76, 1196032
    s_add_u32 s76, s76, s52
    s_mul_i32 s73, s87, 120
    s_sub_u32 s73, s1, s73
    s_and_b32 s69, s3, 1
    s_lshl_b32 s69, s69, 3
    s_lshr_b32 s71, s3, 1
    s_lshl_b32 s71, s71, 10
    s_add_u32 s69, s69, s71
    s_mov_b32 s80, 0
    s_waitcnt vmcnt(7)
    v_lshrrev_b32 v208, 5, v0
    v_lshlrev_b32 v208, 11, v208
    v_bfe_u32 v209, v0, 2, 3
    v_lshl_add_u32 v208, v209, 6, v208
    v_bfe_u32 v209, v0, 4, 1
    v_lshl_add_u32 v208, v209, 5, v208
    v_and_b32 v209, 3, v0
    v_lshl_add_u32 v208, v209, 3, v208
    v_add_u32 v208, s66, v208
    v_xor_b32 v209, 32, v208
    ds_read_b64_tr_b16 v[144:145], v208 offset:0
    ds_read_b64_tr_b16 v[146:147], v208 offset:4096
    ds_read_b64_tr_b16 v[148:149], v209 offset:0
    ds_read_b64_tr_b16 v[150:151], v209 offset:4096
    ds_read_b64_tr_b16 v[152:153], v208 offset:8192
    ds_read_b64_tr_b16 v[154:155], v208 offset:12288
    ds_read_b64_tr_b16 v[156:157], v209 offset:8192
    ds_read_b64_tr_b16 v[158:159], v209 offset:12288
    ds_read_b64_tr_b16 v[160:161], v208 offset:512
    ds_read_b64_tr_b16 v[162:163], v208 offset:4608
    ds_read_b64_tr_b16 v[164:165], v209 offset:512
    ds_read_b64_tr_b16 v[166:167], v209 offset:4608
    ds_read_b64_tr_b16 v[168:169], v208 offset:8704
    ds_read_b64_tr_b16 v[170:171], v208 offset:12800
    ds_read_b64_tr_b16 v[172:173], v209 offset:8704
    ds_read_b64_tr_b16 v[174:175], v209 offset:12800
    ds_read_b64_tr_b16 v[176:177], v208 offset:1024
    ds_read_b64_tr_b16 v[178:179], v208 offset:5120
    ds_read_b64_tr_b16 v[180:181], v209 offset:1024
    ds_read_b64_tr_b16 v[182:183], v209 offset:5120
    ds_read_b64_tr_b16 v[184:185], v208 offset:9216
    ds_read_b64_tr_b16 v[186:187], v208 offset:13312
    ds_read_b64_tr_b16 v[188:189], v209 offset:9216
    ds_read_b64_tr_b16 v[190:191], v209 offset:13312
    ds_read_b64_tr_b16 v[192:193], v208 offset:1536
    ds_read_b64_tr_b16 v[194:195], v208 offset:5632
    ds_read_b64_tr_b16 v[196:197], v209 offset:1536
    ds_read_b64_tr_b16 v[198:199], v209 offset:5632
    ds_read_b64_tr_b16 v[200:201], v208 offset:9728
    ds_read_b64_tr_b16 v[202:203], v208 offset:13824
    ds_read_b64_tr_b16 v[204:205], v209 offset:9728
    ds_read_b64_tr_b16 v[206:207], v209 offset:13824
    s_add_u32 m0, s88, 0
    s_nop 0
    buffer_load_dwordx4 v72, s[40:43], s76 offen offset:0 sc1 lds
    s_add_u32 m0, s88, 896
    s_nop 0
    buffer_load_dwordx4 v72, s[40:43], s76 offen offset:128 sc1 lds
    s_add_u32 m0, s88, 2048
    s_nop 0
    buffer_load_dwordx4 v74, s[40:43], s76 offen offset:0 sc1 lds
    s_add_u32 m0, s88, 2944
    s_nop 0
    buffer_load_dwordx4 v74, s[40:43], s76 offen offset:128 sc1 lds
    ds_read_b128 v[80:83], v77 offset:0
    ds_read_b128 v[84:87], v77 offset:512
    ds_read_b128 v[88:91], v77 offset:1024
    ds_read_b128 v[92:95], v77 offset:1536
    ds_read_b128 v[96:99], v77 offset:16384
    ds_read_b128 v[100:103], v77 offset:16896
    ds_read_b128 v[104:107], v77 offset:17408
    ds_read_b128 v[108:111], v77 offset:17920
    ds_read_b128 v[112:115], v77 offset:32768
    ds_read_b128 v[116:119], v77 offset:33280
    ds_read_b128 v[120:123], v77 offset:33792
    ds_read_b128 v[124:127], v77 offset:34304
    ds_read_b128 v[128:131], v77 offset:49152
    ds_read_b128 v[132:135], v77 offset:49664
    ds_read_b128 v[136:139], v77 offset:50176
    ds_read_b128 v[140:143], v77 offset:50688
    s_branch L_qaa_273x
L_qaa_273:
    s_and_b32 s70, vcc_lo, 0xffff
    s_cbranch_scc0 L_qaa_273s0
    s_add_u32 m0, s88, 0
    s_nop 0
    buffer_load_dwordx4 v72, s[40:43], s76 offen offset:0 sc1 lds
L_qaa_273s0:
    s_and_b32 s70, vcc_lo, 0xffff0000
    s_cbranch_scc0 L_qaa_273s1
    s_add_u32 m0, s88, 896
    s_nop 0
    buffer_load_dwordx4 v72, s[40:43], s76 offen offset:128 sc1 lds
L_qaa_273s1:
    s_and_b32 s70, vcc_hi, 0xffff
    s_cbranch_scc0 L_qaa_273s2
    s_add_u32 m0, s88, 2048
    s_nop 0
    buffer_load_dwordx4 v74, s[40:43], s76 offen offset:0 sc1 lds
L_qaa_273s2:
    s_and_b32 s70, vcc_hi, 0xffff0000
    s_cbranch_scc0 L_qaa_273s3
    s_add_u32 m0, s88, 2944
    s_nop 0
    buffer_load_dwordx4 v74, s[40:43], s76 offen offset:128 sc1 lds
L_qaa_273s3:
L_qaa_273x:
    s_waitcnt vmcnt(0)
    ds_read2_b32 v[78:79], v73 offset0:0 offset1:8
    s_add_u32 s80, s80, 4096
    s_cbranch_scc1 L_abort
    s_waitcnt lgkmcnt(0)
    v_cmp_u_f32 vcc, v78, v79
    s_cbranch_vccnz L_qaa_273
    s_barrier
    ds_read_b128 v[8:11], v76 offset:0
    ds_read_b128 v[12:15], v76 offset:512
    ds_read_b128 v[16:19], v76 offset:1024
    ds_read_b128 v[20:23], v76 offset:1536
    ds_read_b128 v[24:27], v76 offset:4096
    s_waitcnt lgkmcnt(4)
    v_mfma_f32_16x16x32_bf16 v[72:75], v[80:83], v[8:11], 0
    ds_read_b128 v[28:31], v76 offset:4608
    s_waitcnt lgkmcnt(4)
    v_mfma_f32_16x16x32_bf16 v[72:75], v[84:87], v[12:15], v[72:75]
    ds_read_b128 v[32:35], v76 offset:5120
    s_waitcnt lgkmcnt(4)
    v_mfma_f32_16x16x32_bf16 v[72:75], v[88:91], v[16:19], v[72:75]
    ds_read_b128 v[36:39], v76 offset:5632
    s_waitcnt lgkmcnt(4)
    v_mfma_f32_16x16x32_bf16 v[72:75], v[92:95], v[20:23], v[72:75]
    ds_read_b128 v[40:43], v76 offset:8192
    s_waitcnt lgkmcnt(4)
    v_mfma_f32_16x16x32_bf16 v[72:75], v[96:99], v[24:27], v[72:75]
    ds_read_b128 v[44:47], v76 offset:8704
    s_waitcnt lgkmcnt(4)
    v_mfma_f32_16x16x32_bf16 v[72:75], v[100:103], v[28:31], v[72:75]
    ds_read_b128 v[48:51], v76 offset:9216
    s_waitcnt lgkmcnt(4)
    v_mfma_f32_16x16x32_bf16 v[72:75], v[104:107], v[32:35], v[72:75]
    ds_read_b128 v[52:55], v76 offset:9728
    s_waitcnt lgkmcnt(4)
    v_mfma_f32_16x16x32_bf16 v[72:75], v[108:111], v[36:39], v[72:75]
    ds_read_b128 v[56:59], v76 offset:12288
    s_waitcnt lgkmcnt(4)
    v_mfma_f32_16x16x32_bf16 v[72:75], v[112:115], v[40:43], v[72:75]
    ds_read_b128 v[60:63], v76 offset:12800
    v_and_b32 v79, 15, v0
    s_waitcnt lgkmcnt(4)
    v_mfma_f32_16x16x32_bf16 v[72:75], v[116:119], v[44:47], v[72:75]
    ds_read_b128 v[64:67], v76 offset:13312
    v_lshlrev_b32 v79, 4, v79
    s_waitcnt lgkmcnt(4)
    v_mfma_f32_16x16x32_bf16 v[72:75], v[120:123], v[48:51], v[72:75]
    ds_read_b128 v[68:71], v76 offset:13824
    v_add_u32 v79, 147456, v79
    s_waitcnt lgkmcnt(4)
    v_mfma_f32_16x16x32_bf16 v[72:75], v[124:127], v[52:55], v[72:75]
    s_waitcnt lgkmcnt(3)
    v_mfma_f32_16x16x32_bf16 v[72:75], v[128:131], v[56:59], v[72:75]
    s_waitcnt lgkmcnt(2)
    v_mfma_f32_16x16x32_bf16 v[72:75], v[132:135], v[60:63], v[72:75]
    s_waitcnt lgkmcnt(1)
    v_mfma_f32_16x16x32_bf16 v[72:75], v[136:139], v[64:67], v[72:75]
    s_waitcnt lgkmcnt(0)
    s_waitcnt vmcnt(0)
    s_barrier
    v_mfma_f32_16x16x32_bf16 v[72:75], v[140:143], v[68:71], v[72:75]
    v_lshl_add_u32 v40, s3, 2, v79
    v_lshlrev_b32 v43, 4, v0
    v_add_u32 v43, 147456, v43
    v_add_u32 v42, s69, v43
    s_nop 3
    v_max3_f32 v78, v72, v73, v74
    v_max_f32 v78, v78, v75
    v_mov_b32 v41, v78
    s_nop 1
    v_permlane16_swap_b32 v78, v41
    v_max_f32 v78, v78, v41
    v_mov_b32 v41, v78
    s_nop 1
    v_permlane32_swap_b32 v78, v41
    v_max_f32 v78, v78, v41
    ds_write_b32 v40, v78
    v_lshl_add_u32 v40, s3, 2, v43
    s_waitcnt lgkmcnt(0)
    s_barrier
    ds_read_b128 v[44:47], v79
    s_waitcnt lgkmcnt(0)
    v_max3_f32 v78, v44, v45, v46
    v_max_f32 v78, v78, v47
    v_ceil_f32 v78, v78
    v_sub_f32 v72, v72, v78
    v_sub_f32 v73, v73, v78
    v_exp_f32 v72, v72
    v_pk_add_f32 v[46:47], v[44:45], v[46:47]
    v_exp_f32 v73, v73
    v_cmp_u_f32 vcc, v46, v47
    v_sub_f32 v74, v74, v78
    v_sub_f32 v75, v75, v78
    v_exp_f32 v74, v74
    v_exp_f32 v75, v75
    s_cbranch_vccnz L_redo_274
    v_cvt_pk_bf16_f32 v44, v72, v73
    v_cvt_pk_bf16_f32 v45, v74, v75
    ds_write_b64 v42, v[44:45] offset:1024
    v_pk_add_f32 v[72:73], v[72:73], v[74:75]
    v_add_f32 v72, v72, v73
    ds_write_b32 v40, v72 offset:3072
    s_waitcnt lgkmcnt(0)
    s_barrier
    ds_read_b128 v[8:11], v43 offset:1024
    ds_read_b128 v[12:15], v43 offset:2048
    ds_read_b128 v[72:75], v43 offset:3072
    s_waitcnt lgkmcnt(2)
    v_mfma_f32_16x16x32_bf16 v[40:43], v[8:11], v[144:147], 0
    v_mfma_f32_16x16x32_bf16 v[44:47], v[8:11], v[148:151], 0
    s_waitcnt lgkmcnt(0)
    v_mfma_f32_16x16x32_bf16 v[40:43], v[12:15], v[152:155], v[40:43]
    v_pk_add_f32 v[72:73], v[72:73], v[74:75]
    v_and_b32 v74, 15, v0
    v_add_f32 v79, v72, v73
    v_mfma_f32_16x16x32_bf16 v[44:47], v[12:15], v[156:159], v[44:47]
    v_lshlrev_b32 v75, 7, v74
    v_mov_b32 v72, v79
    v_lshlrev_b32 v74, 3, v74
    v_mfma_f32_16x16x32_bf16 v[48:51], v[8:11], v[160:163], 0
    v_lshrrev_b32 v73, 4, v0
    v_permlane16_swap_b32 v79, v72
    v_add_f32 v79, v79, v72
    v_mfma_f32_16x16x32_bf16 v[52:55], v[8:11], v[164:167], 0
    v_lshl_add_u32 v74, v73, 12, v74
    v_mov_b32 v72, v79
    v_lshl_add_u32 v75, v73, 28, v75
    v_mfma_f32_16x16x32_bf16 v[48:51], v[12:15], v[168:171], v[48:51]
    v_add_u32 v75, s89, v75
    v_mfma_f32_16x16x32_bf16 v[52:55], v[12:15], v[172:175], v[52:55]
    v_permlane32_swap_b32 v79, v72
    v_mfma_f32_16x16x32_bf16 v[56:59], v[8:11], v[176:179], 0
    v_add_f32 v79, v79, v72
    v_mfma_f32_16x16x32_bf16 v[60:63], v[8:11], v[180:183], 0
    v_and_b32 v72, 32, v0
    v_lshl_add_u32 v74, v72, 8, v74
    v_mfma_f32_16x16x32_bf16 v[56:59], v[12:15], v[184:187], v[56:59]
    v_cvt_pk_bf16_f32 v44, v40, v44
    v_cvt_pk_bf16_f32 v40, v41, v45
    v_mfma_f32_16x16x32_bf16 v[60:63], v[12:15], v[188:191], v[60:63]
    v_cvt_pk_bf16_f32 v45, v48, v52
    buffer_store_dwordx2 v[44:45], v74, s[40:43], s47 offen offset:0 sc1
    v_mfma_f32_16x16x32_bf16 v[64:67], v[8:11], v[192:195], 0
    buffer_store_dwordx2 v[78:79], v75, s[40:43], s73 offen sc1
    v_cvt_pk_bf16_f32 v41, v49, v53
    buffer_store_dwordx2 v[40:41], v74, s[40:43], s47 offen offset:1024 sc1
    v_mfma_f32_16x16x32_bf16 v[68:71], v[8:11], v[196:199], 0
    v_cvt_pk_bf16_f32 v46, v42, v46
    v_cvt_pk_bf16_f32 v42, v43, v47
    v_mfma_f32_16x16x32_bf16 v[64:67], v[12:15], v[200:203], v[64:67]
    v_cvt_pk_bf16_f32 v47, v50, v54
    buffer_store_dwordx2 v[46:47], v74, s[40:43], s47 offen offset:2048 sc1
    v_mfma_f32_16x16x32_bf16 v[68:71], v[12:15], v[204:207], v[68:71]
    v_cvt_pk_bf16_f32 v43, v51, v55
    buffer_store_dwordx2 v[42:43], v74, s[40:43], s47 offen offset:3072 sc1
    v_cvt_pk_bf16_f32 v60, v56, v60
    v_cvt_pk_bf16_f32 v56, v57, v61
    v_cvt_pk_bf16_f32 v62, v58, v62
    v_cvt_pk_bf16_f32 v58, v59, v63
    v_and_b32 v72, 3, v0
    v_lshlrev_b32 v72, 3, v72
    v_cvt_pk_bf16_f32 v61, v64, v68
    buffer_store_dwordx2 v[60:61], v74, s[40:43], s47 offen offset:128 sc1
    v_cvt_pk_bf16_f32 v57, v65, v69
    buffer_store_dwordx2 v[56:57], v74, s[40:43], s47 offen offset:1152 sc1
    v_cvt_pk_bf16_f32 v63, v66, v70
    buffer_store_dwordx2 v[62:63], v74, s[40:43], s47 offen offset:2176 sc1
    v_cvt_pk_bf16_f32 v59, v67, v71
    buffer_store_dwordx2 v[58:59], v74, s[40:43], s47 offen offset:3200 sc1
    v_lshl_add_u32 v73, v73, 5, v72
    v_mov_b32 v32, -1
    v_mov_b32 v33, -1
    buffer_load_dwordx2 v[32:33], v73, s[40:43], s1 offen sc1
    v_lshrrev_b32 v77, 4, v0
    v_and_b32 v76, 15, v0
    v_lshlrev_b32 v72, 4, v76
    v_lshl_add_u32 v72, v77, 17, v72
    s_add_u32 s95, s0, 32768
    s_add_u32 s96, s0, 65536
    s_add_u32 s97, s0, 98304
    v_and_b32 v78, 1, v76
    v_lshlrev_b32 v78, 4, v78
    v_mov_b32 v79, 0xffff
    v_lshlrev_b32 v78, v78, v79
    v_lshrrev_b32 v79, 1, v76
    v_cmp_eq_u32 vcc, 0, v79
    s_nop 1
    v_cndmask_b32 v64, 0, v78, vcc
    v_cmp_eq_u32 vcc, 1, v79
    s_nop 1
    v_cndmask_b32 v65, 0, v78, vcc
    v_cmp_eq_u32 vcc, 2, v79
    s_nop 1
    v_cndmask_b32 v66, 0, v78, vcc
    v_cmp_eq_u32 vcc, 3, v79
    s_nop 1
    v_cndmask_b32 v67, 0, v78, vcc
    s_lshl_b32 s71, s87, 1
    s_add_u32 s71, s71, s86
    s_and_b32 s72, s71, 15
    s_lshl_b32 s73, s72, 14
    s_lshl_b32 s70, s3, 11
    s_add_u32 s73, s73, s70
    s_and_b32 s70, s71, 8
    s_add_u32 s72, s72, s70
    s_lshl_b32 s72, s72, 10
    s_lshl_b32 s70, s55, 7
    s_add_u32 s70, s70, s54
    s_add_u32 s73, s73, s70
    s_add_u32 s73, s73, 1261568
    s_add_u32 s72, s72, s70
    s_add_u32 s72, s72, 1523712
    s_mov_b32 s74, 10
    v_and_b32 v74, 7, v0
    v_lshlrev_b32 v74, 4, v74
    v_lshl_add_u32 v74, v77, 3, v74
    v_bfe_u32 v75, v0, 3, 1
    v_lshl_add_u32 v74, v75, s74, v74
    v_and_b32 v75, 32, v0
    v_lshl_add_u32 v74, v75, 26, v74
    v_mov_b32 v75, 1073741824
    v_writelane_b32 v75, s89, 0
    s_mov_b32 s80, 0
L_spin_275:
    buffer_load_dwordx2 v[32:33], v73, s[40:43], s1 offen sc1
    s_add_u32 s80, s80, 1024
    s_cbranch_scc1 L_abort
    s_waitcnt vmcnt(1)
    v_cmp_u_f32 vcc, v32, v33
    s_cbranch_vccnz L_spin_275
    v_max_f32_dpp v44, v32, v32 quad_perm:[1,0,3,2] row_mask:0xf bank_mask:0xf
    s_nop 1
    v_max_f32_dpp v44, v44, v44 quad_perm:[2,3,0,1] row_mask:0xf bank_mask:0xf
    v_mov_b32 v45, v44
    s_nop 1
    v_permlane16_swap_b32 v44, v45
    v_max_f32 v44, v44, v45
    v_mov_b32 v45, v44
    s_nop 1
    v_permlane32_swap_b32 v44, v45
    v_max_f32 v44, v44, v45
    v_sub_f32 v40, v32, v44
    v_exp_f32 v40, v40
    s_nop 0
    v_cvt_pk_bf16_f32 v42, v40, v40
    v_mul_f32 v45, v40, v33
    buffer_load_dwordx4 v[8:11], v72, s[40:43], s0 offen sc1
    buffer_load_dwordx4 v[12:15], v72, s[40:43], s95 offen sc1
    buffer_load_dwordx4 v[16:19], v72, s[40:43], s96 offen sc1
    buffer_load_dwordx4 v[20:23], v72, s[40:43], s97 offen sc1
    v_and_b32_dpp v48, v42, v64 quad_perm:[0,0,0,0] row_mask:0xf bank_mask:0xf
    v_and_b32_dpp v49, v42, v65 quad_perm:[0,0,0,0] row_mask:0xf bank_mask:0xf
    v_and_b32_dpp v50, v42, v66 quad_perm:[0,0,0,0] row_mask:0xf bank_mask:0xf
    v_add_f32_dpp v45, v45, v45 quad_perm:[1,0,3,2] row_mask:0xf bank_mask:0xf
    v_and_b32_dpp v51, v42, v67 quad_perm:[0,0,0,0] row_mask:0xf bank_mask:0xf
    s_nop 0
    v_add_f32_dpp v45, v45, v45 quad_perm:[2,3,0,1] row_mask:0xf bank_mask:0xf
    v_and_b32_dpp v52, v42, v64 quad_perm:[1,1,1,1] row_mask:0xf bank_mask:0xf
    v_mov_b32 v46, v45
    v_and_b32_dpp v53, v42, v65 quad_perm:[1,1,1,1] row_mask:0xf bank_mask:0xf
    s_nop 0
    v_permlane16_swap_b32 v45, v46
    v_and_b32_dpp v54, v42, v66 quad_perm:[1,1,1,1] row_mask:0xf bank_mask:0xf
    v_add_f32 v45, v45, v46
    v_and_b32_dpp v55, v42, v67 quad_perm:[1,1,1,1] row_mask:0xf bank_mask:0xf
    v_mov_b32 v46, v45
    v_and_b32_dpp v56, v42, v64 quad_perm:[2,2,2,2] row_mask:0xf bank_mask:0xf
    s_nop 0
    v_permlane32_swap_b32 v45, v46
    v_and_b32_dpp v57, v42, v65 quad_perm:[2,2,2,2] row_mask:0xf bank_mask:0xf
    v_add_f32 v45, v45, v46
    v_and_b32_dpp v58, v42, v66 quad_perm:[2,2,2,2] row_mask:0xf bank_mask:0xf
    v_and_b32_dpp v59, v42, v67 quad_perm:[2,2,2,2] row_mask:0xf bank_mask:0xf
    buffer_store_dwordx2 v[44:45], v75, s[40:43], s72 offen sc1
    v_and_b32_dpp v60, v42, v64 quad_perm:[3,3,3,3] row_mask:0xf bank_mask:0xf
    v_and_b32_dpp v61, v42, v65 quad_perm:[3,3,3,3] row_mask:0xf bank_mask:0xf
    v_and_b32_dpp v62, v42, v66 quad_perm:[3,3,3,3] row_mask:0xf bank_mask:0xf
    v_and_b32_dpp v63, v42, v67 quad_perm:[3,3,3,3] row_mask:0xf bank_mask:0xf
    s_mov_b32 s80, 0
L_paw_278:
    s_waitcnt vmcnt(4)
    v_mfma_f32_16x16x32_bf16 v[68:71], v[48:51], v[8:11], 0
    s_waitcnt vmcnt(3)
    v_mfma_f32_16x16x32_bf16 v[68:71], v[52:55], v[12:15], v[68:71]
    s_waitcnt vmcnt(2)
    v_mfma_f32_16x16x32_bf16 v[68:71], v[56:59], v[16:19], v[68:71]
    s_waitcnt vmcnt(1)
    v_mfma_f32_16x16x32_bf16 v[68:71], v[60:63], v[20:23], v[68:71]
    s_nop 7
    v_cmp_u_f32 vcc, v68, v68
    v_cvt_pk_bf16_f32 v46, v68, v69
    v_cvt_pk_bf16_f32 v47, v70, v71
    s_cbranch_vccnz L_retry_279
    buffer_store_dwordx2 v[46:47], v74, s[40:43], s73 offen sc1
    v_bfe_u32 v76, v0, 2, 3
    v_lshlrev_b32 v76, 7, v76
    v_lshrrev_b32 v77, 5, v0
    v_lshl_add_u32 v76, v77, 6, v76
    v_bfe_u32 v77, v0, 4, 1
    v_lshlrev_b32 v77, 1, v77
    v_xor_b32 v77, v0, v77
    v_and_b32 v77, 3, v77
    v_lshl_add_u32 v76, v77, 4, v76
    v_bfe_u32 v78, v0, 2, 3
    v_lshlrev_b32 v77, 7, v78
    s_and_b32 s77, s62, 15
    s_lshl_b32 s76, s77, 4
    s_add_u32 s76, s76, s63
    s_lshl_b32 s76, s76, 10
    s_add_u32 s76, s76, s53
    s_add_u32 s76, s76, 1261568
    s_and_b32 s70, s62, 8
    s_add_u32 s77, s77, s70
    s_lshl_b32 s77, s77, 10
    s_add_u32 s77, s77, s53
    s_add_u32 s77, s77, 1523712
    v_mov_b32 v64, -1
    v_mov_b32 v65, -1
    v_mov_b32 v66, -1
    v_mov_b32 v67, -1
    v_mov_b32 v68, -1
    v_mov_b32 v69, -1
    s_barrier
    v_lshrrev_b32 v8, 4, v0
    v_bfe_u32 v9, v0, 2, 2
    v_lshlrev_b32 v8, 1, v8
    v_lshl_add_u32 v8, v9, 4, v8
    v_mul_u32_u24 v8, 8192, v8
    v_bfe_u32 v9, v0, 4, 1
    v_lshlrev_b32 v9, 1, v9
    v_xor_b32 v9, v0, v9
    v_and_b32 v9, 3, v9
    v_lshl_add_u32 v8, v9, 4, v8
    s_lshl_b32 s90, s63, 18
    s_sub_u32 s90, s98, s90
    s_add_u32 m0, s88, 0
    s_add_u32 s91, s90, 0
    buffer_load_dwordx4 v8, s[32:35], s91 offen  lds
    s_add_u32 m0, s88, 1024
    s_add_u32 s91, s90, 8192
    buffer_load_dwordx4 v8, s[32:35], s91 offen  lds
    s_add_u32 m0, s88, 2048
    s_add_u32 s91, s90, 65536
    buffer_load_dwordx4 v8, s[32:35], s91 offen  lds
    s_add_u32 m0, s88, 3072
    s_add_u32 s91, s90, 73728
    buffer_load_dwordx4 v8, s[32:35], s91 offen  lds
    v_lshrrev_b32 v8, 4, v0
    v_bfe_u32 v9, v0, 2, 2
    v_lshl_add_u32 v8, v8, 3, v9
    v_mul_u32_u24 v8, 1152, v8
    v_bfe_u32 v9, v0, 4, 1
    v_lshlrev_b32 v9, 1, v9
    v_xor_b32 v9, v0, v9
    v_and_b32 v9, 3, v9
    v_lshl_add_u32 v8, v9, 4, v8
    v_add_u32 v8, s68, v8
    s_add_u32 m0, s65, 6144
    s_add_u32 s91, s99, 110592
    buffer_load_dwordx4 v8, s[36:39], s91 offen  lds
    s_add_u32 m0, s65, 7168
    s_add_u32 s91, s99, 115200
    buffer_load_dwordx4 v8, s[36:39], s91 offen  lds
    buffer_load_dwordx2 v[68:69], v77, s[40:43], s77 offen sc1
    buffer_load_dwordx4 v[64:67], v76, s[40:43], s76 offen sc1
    v_and_b32 v74, 7, v0
    v_lshlrev_b32 v74, 6, v74
    v_lshlrev_b32 v75, 3, v0
    v_and_b32 v75, 32, v75
    v_xor_b32 v75, v0, v75
    v_and_b32 v75, 48, v75
    v_add3_u32 v74, v74, v75, s88
    v_lshrrev_b32 v78, 3, v0
    v_and_b32 v79, 7, v0
    v_lshlrev_b32 v79, 1, v79
    v_lshl_add_u32 v78, v78, 7, v79
    s_lshl_b32 s70, s3, 9
    s_add_u32 s73, s45, s70
    s_add_u32 s73, s73, 41984
    s_sub_u32 s70, s88, s65
    v_add_u32 v70, s70, v2
    v_add_u32 v71, s70, v7
    v_lshl_add_u32 v75, v0, 4, s88
    v_and_b32 v32, 7, v0
    v_lshlrev_b32 v32, 4, v32
    v_bfe_u32 v33, v0, 3, 1
    v_lshl_add_u32 v32, v33, 9, v32
    v_lshrrev_b32 v33, 4, v0
    v_lshl_add_u32 v32, v33, 7, v32
    s_add_u32 s79, s46, 41984
    v_mov_b32 v24, -1
    v_mov_b32 v25, -1
    v_mov_b32 v26, -1
    v_mov_b32 v27, -1
    v_mov_b32 v28, -1
    v_mov_b32 v29, -1
    v_mov_b32 v30, -1
    v_mov_b32 v31, -1
    s_waitcnt vmcnt(4)
    ds_read_b64_tr_b16 v[40:41], v70 offset:0
    ds_read_b64_tr_b16 v[42:43], v70 offset:1024
    ds_read_b64_tr_b16 v[44:45], v71 offset:0
    ds_read_b64_tr_b16 v[46:47], v71 offset:1024
    ds_read_b64_tr_b16 v[48:49], v70 offset:2048
    ds_read_b64_tr_b16 v[50:51], v70 offset:3072
    ds_read_b64_tr_b16 v[52:53], v71 offset:2048
    ds_read_b64_tr_b16 v[54:55], v71 offset:3072
    s_mov_b32 s80, 0
    v_cmp_u_f32 vcc, v68, v69
    s_cbranch_vccz L_go_281
    s_branch L_chk_282
L_spin_280:
    s_waitcnt vmcnt(16)
    buffer_load_dwordx2 v[68:69], v77, s[40:43], s77 offen sc1
    buffer_load_dwordx4 v[64:67], v76, s[40:43], s76 offen sc1
    s_add_u32 s80, s80, 1024
    s_cbranch_scc1 L_abort
L_chk_282:
    v_cmp_u_f32 vcc, v68, v69
    s_cbranch_vccz L_go_281
    v_cmp_u_f32 vcc, v68, v69
    s_cbranch_vccz L_go_281
    v_cmp_u_f32 vcc, v68, v69
    s_cbranch_vccz L_go_281
    v_cmp_u_f32 vcc, v68, v69
    s_cbranch_vccz L_go_281
    v_cmp_u_f32 vcc, v68, v69
    s_cbranch_vccz L_go_281
    v_cmp_u_f32 vcc, v68, v69
    s_cbranch_vccz L_go_281
    v_cmp_u_f32 vcc, v68, v69
    s_cbranch_vccz L_go_281
    v_cmp_u_f32 vcc, v68, v69
    s_cbranch_vccz L_go_281
    v_cmp_u_f32 vcc, v68, v69
    s_cbranch_vccz L_go_281
    v_cmp_u_f32 vcc, v68, v69
    s_cbranch_vccnz L_spin_280
L_go_281:
    s_mov_b32 s80, 0
    v_cmp_u_f32 vcc, v64, v67
    s_cbranch_vccz L_go_284
    s_branch L_chk_285
L_spin_283:
    s_waitcnt vmcnt(8)
    buffer_load_dwordx4 v[64:67], v76, s[40:43], s76 offen sc1
    s_add_u32 s80, s80, 1024
    s_cbranch_scc1 L_abort
L_chk_285:
    v_cmp_u_f32 vcc, v64, v67
    s_cbranch_vccz L_go_284
    v_cmp_u_f32 vcc, v64, v67
    s_cbranch_vccz L_go_284
    v_cmp_u_f32 vcc, v64, v67
    s_cbranch_vccz L_go_284
    v_cmp_u_f32 vcc, v64, v67
    s_cbranch_vccz L_go_284
    v_cmp_u_f32 vcc, v64, v67
    s_cbranch_vccz L_go_284
    v_cmp_u_f32 vcc, v64, v67
    s_cbranch_vccz L_go_284
    v_cmp_u_f32 vcc, v64, v67
    s_cbranch_vccz L_go_284
    v_cmp_u_f32 vcc, v64, v67
    s_cbranch_vccz L_go_284
    v_cmp_u_f32 vcc, v64, v67
    s_cbranch_vccz L_go_284
    v_cmp_u_f32 vcc, v64, v67
    s_cbranch_vccnz L_spin_283
L_go_284:
    ds_write_b128 v75, v[64:67]
    ds_read_b128 v[16:19], v74
    ds_read_b128 v[20:23], v74 offset:512
    v_max_f32_dpp v12, v68, v68 row_ror:4 row_mask:0xf bank_mask:0xf
    s_nop 1
    v_max_f32_dpp v12, v12, v12 row_ror:8 row_mask:0xf bank_mask:0xf
    v_mov_b32 v13, v12
    s_nop 1
    v_permlane16_swap_b32 v12, v13
    v_max_f32 v12, v12, v13
    v_sub_f32 v12, v68, v12
    v_exp_f32 v12, v12
    s_nop 0
    v_mul_f32 v13, v12, v69
    v_mov_b32_dpp v8, v12 row_newbcast:0 row_mask:0xf bank_mask:0xf
    v_mov_b32_dpp v9, v12 row_newbcast:4 row_mask:0xf bank_mask:0xf
    v_mov_b32_dpp v10, v12 row_newbcast:8 row_mask:0xf bank_mask:0xf
    v_mov_b32_dpp v11, v12 row_newbcast:12 row_mask:0xf bank_mask:0xf
    s_waitcnt lgkmcnt(0)
    v_mfma_f32_16x16x32_bf16 v[56:59], v[16:19], v[40:43], 0
    v_add_f32_dpp v13, v13, v13 row_ror:4 row_mask:0xf bank_mask:0xf
    v_mfma_f32_16x16x32_bf16 v[60:63], v[16:19], v[44:47], 0
    s_nop 0
    v_add_f32_dpp v13, v13, v13 row_ror:8 row_mask:0xf bank_mask:0xf
    v_mfma_f32_16x16x32_bf16 v[56:59], v[20:23], v[48:51], v[56:59]
    v_mov_b32 v12, v13
    v_mfma_f32_16x16x32_bf16 v[60:63], v[20:23], v[52:55], v[60:63]
    s_nop 0
    v_permlane16_swap_b32 v13, v12
    v_add_f32 v13, v13, v12
    v_rcp_f32 v13, v13
    s_nop 0
    v_pk_mul_f32 v[36:37], v[8:9], v[12:13] op_sel:[0,1]
    v_pk_mul_f32 v[38:39], v[10:11], v[12:13] op_sel:[0,1]
    v_pk_mul_f32 v[56:57], v[56:57], v[36:37]
    v_pk_mul_f32 v[60:61], v[60:61], v[36:37]
    v_pk_fma_f32 v[56:57], v[58:59], v[38:39], v[56:57]
    v_pk_fma_f32 v[60:61], v[62:63], v[38:39], v[60:61]
    v_add_f32 v14, v56, v57
    v_add_f32 v15, v60, v61
    s_nop 1
    v_permlane16_swap_b32 v14, v15
    v_add_f32 v14, v14, v15
    v_cmp_u_f32 vcc, v14, v14
    s_cbranch_vccnz L_spin_283
    v_mov_b32_dpp v15, v14 quad_perm:[1,1,3,3] row_mask:0xf bank_mask:0xf
    s_mov_b64 exec, 0x55555555
    v_cvt_pk_bf16_f32 v15, v14, v15
    buffer_store_dword v15, v78, s[40:43], s73 offen sc1
    s_mov_b64 exec, -1
    s_cmp_ge_u32 s61, 18
    s_cbranch_scc1 L_idle_286
    buffer_load_dwordx4 v[24:27], v32, s[40:43], s79 offen offset:0 sc1
    buffer_load_dwordx4 v[28:31], v32, s[40:43], s79 offen offset:1024 sc1
    s_waitcnt vmcnt(3)
    ds_read_b64_tr_b16 v[40:41], v2 offset:0
    s_add_u32 s70, s88, 3584
    v_lshl_add_u32 v78, v0, 2, s70
    ds_read_b64_tr_b16 v[42:43], v2 offset:1024
    s_mov_b32 s71, 151040
    v_and_b32 v74, 7, v0
    ds_read_b64_tr_b16 v[44:45], v7 offset:0
    v_lshlrev_b32 v74, 4, v74
    v_bfe_u32 v79, v0, 2, 1
    ds_read_b64_tr_b16 v[46:47], v7 offset:1024
    v_lshl_add_u32 v79, v79, 7, v74
    v_bfe_u32 v75, v0, 4, 1
    ds_read_b64_tr_b16 v[48:49], v2 offset:2048
    v_lshl_add_u32 v75, v75, 13, v74
    v_bfe_u32 v8, v0, 3, 1
    ds_read_b64_tr_b16 v[50:51], v2 offset:3072
    v_lshl_add_u32 v75, v8, 11, v75
    v_lshl_add_u32 v74, v8, 8, v74
    ds_read_b64_tr_b16 v[52:53], v7 offset:2048
    v_lshlrev_b32 v8, 12, v8
    v_add3_u32 v79, v79, v8, s71
    ds_read_b64_tr_b16 v[54:55], v7 offset:3072
    s_and_b32 s70, s61, 30
    buffer_load_dwordx4 v[24:27], v32, s[40:43], s79 offen offset:0 sc1
    buffer_load_dwordx4 v[28:31], v32, s[40:43], s79 offen offset:1024 sc1
    s_add_u32 s73, s70, 54
    ds_read_b64_tr_b16 v[56:57], v2 offset:4096
    s_and_b32 s71, s73, -4
    s_add_u32 s73, s73, s71
    ds_read_b64_tr_b16 v[58:59], v2 offset:5120
    s_lshl_b32 s73, s73, 11
    s_add_u32 s73, s73, 901120
    ds_read_b64_tr_b16 v[60:61], v7 offset:4096
    s_and_b32 s71, s61, 1
    s_lshl_b32 s69, s60, 1
    ds_read_b64_tr_b16 v[62:63], v7 offset:5120
    s_add_u32 s69, s69, s71
    s_lshl_b32 s69, s69, 7
    ds_read_b64_tr_b16 v[64:65], v2 offset:6144
    s_add_u32 s73, s73, s69
    s_add_u32 s70, s70, s61
    ds_read_b64_tr_b16 v[66:67], v2 offset:7168
    s_lshl_b32 s70, s70, 7
    s_add_u32 s69, s58, s70
    ds_read_b64_tr_b16 v[68:69], v7 offset:6144
    s_add_u32 s69, s69, 59904
    ds_read_b64_tr_b16 v[70:71], v7 offset:7168
    s_mov_b32 s80, 0
L_spin_288:
    buffer_load_dwordx4 v[24:27], v32, s[40:43], s79 offen offset:0 sc1
    buffer_load_dwordx4 v[28:31], v32, s[40:43], s79 offen offset:1024 sc1
    s_add_u32 s80, s80, 1024
    s_cbranch_scc1 L_abort
    s_waitcnt vmcnt(2)
    v_cmp_u_f32 vcc, v27, v31
    s_cbranch_vccnz L_spin_288
    s_waitcnt lgkmcnt(0)
    v_mfma_f32_16x16x32_bf16 v[16:19], v[24:27], v[48:51], 0
    v_mfma_f32_16x16x32_bf16 v[16:19], v[28:31], v[64:67], v[16:19]
    v_mfma_f32_16x16x32_bf16 v[12:15], v[24:27], v[44:47], 0
    v_mfma_f32_16x16x32_bf16 v[12:15], v[28:31], v[60:63], v[12:15]
    v_mfma_f32_16x16x32_bf16 v[8:11], v[24:27], v[40:43], 0
    v_mfma_f32_16x16x32_bf16 v[8:11], v[28:31], v[56:59], v[8:11]
    v_mfma_f32_16x16x32_bf16 v[20:23], v[24:27], v[52:55], 0
    v_mfma_f32_16x16x32_bf16 v[20:23], v[28:31], v[68:71], v[20:23]
    s_nop 1
    v_pk_add_f32 v[16:17], v[16:17], v[18:19]
    v_add_f32 v16, v16, v17
    v_pk_add_f32 v[12:13], v[12:13], v[14:15]
    v_add_f32 v12, v12, v13
    v_pk_add_f32 v[8:9], v[8:9], v[10:11]
    v_add_f32 v8, v8, v9
    v_permlane32_swap_b32 v16, v12
    v_add_f32 v8, v8, v12
    v_pk_add_f32 v[20:21], v[20:21], v[22:23]
    v_add_f32 v20, v20, v21
    v_add_f32 v20, v20, v16
    s_nop 1
    v_permlane16_swap_b32 v8, v20
    v_add_f32 v34, v8, v20
    ds_write_b32 v78, v34
    v_cmp_u_f32 vcc, v34, v34
    s_cbranch_vccnz L_spin_288
    s_cmp_lg_u32 s3, 0
    s_waitcnt lgkmcnt(0)
    s_barrier
    s_cbranch_scc1 L_skip_291
    s_mov_b32 exec_hi, 0
    ds_read_b128 v[8:11], v79
    ds_read_b128 v[12:15], v79 offset:8192
    s_waitcnt vmcnt(0) lgkmcnt(0)
    v_pk_add_f32 v[32:33], v[8:9], v[12:13]
    v_pk_add_f32 v[34:35], v[10:11], v[14:15]
    buffer_store_dwordx4 v[32:35], v75, s[40:43], s73 offen sc1
    s_mov_b64 exec, -1
    s_branch L_skip_291x
L_skip_291:
    s_waitcnt vmcnt(0)
L_skip_291x:
L_join_287:
    s_sub_u32 s70, s61, 24
    s_cmp_lt_u32 s70, 6
    s_cselect_b32 s70, s60, 1
    s_cmp_eq_u32 s3, 3
    s_cselect_b32 s70, 1, s70
    s_cmp_eq_u32 s70, 0
    s_cbranch_scc1 L_fin_292
    s_endpgm
L_fin_292:
    v_lshrrev_b32 v14, 3, v0
    v_lshlrev_b32 v12, 8, v14
    v_and_b32 v13, 7, v0
    v_lshl_add_u32 v12, v13, 4, v12
    s_mul_i32 s70, s63, 3
    s_add_u32 s70, s70, s3
    s_add_u32 s76, s70, 54
    s_and_b32 s71, s76, -4
    s_add_u32 s76, s76, s71
    s_lshl_b32 s76, s76, 11
    s_add_u32 s76, s76, 901120
    s_add_u32 s76, s76, s52
    s_sub_u32 s70, s70, s60
    s_lshl_b32 s70, s70, 8
    s_add_u32 s70, s70, s58
    s_add_u32 s70, s70, 59904
    s_sub_u32 s70, s70, s76
    s_cmp_eq_u32 s3, 3
    s_cselect_b32 s70, 1073741824, 0
    v_add_u32 v12, s70, v12
    v_lshrrev_b32 v14, 4, v0
    v_lshlrev_b32 v13, 3, v13
    v_lshl_add_u32 v13, v14, 1, v13
    s_lshl_b32 s70, s3, 6
    s_add_u32 s70, s70, 150784
    v_add_u32 v13, s70, v13
    v_lshlrev_b32 v14, 4, v14
    v_and_b32 v15, 3, v0
    v_lshl_add_u32 v14, v15, 6, v14
    v_add_u32 v14, 150784, v14
    v_mov_b32 v24, -1
    v_mov_b32 v25, -1
    v_mov_b32 v26, -1
    v_mov_b32 v27, -1
    v_mov_b32 v28, -1
    v_mov_b32 v29, -1
    v_mov_b32 v30, -1
    v_mov_b32 v31, -1
    v_subrev_u32 v13, 150784, v13
    s_mul_i32 s73, s63, 192
    s_mov_b32 s80, 0
L_spin_293:
    s_waitcnt vmcnt(16)
    buffer_load_dwordx4 v[24:27], v12, s[40:43], s76 offen sc1
    buffer_load_dwordx4 v[28:31], v12, s[40:43], s76 offen offset:128 sc1
    s_add_u32 s80, s80, 1024
    s_cbranch_scc1 L_abort
L_chk_295:
    v_cmp_u_f32 vcc, v27, v31
    s_cbranch_vccz L_go_294
    v_cmp_u_f32 vcc, v27, v31
    s_cbranch_vccz L_go_294
    v_cmp_u_f32 vcc, v27, v31
    s_cbranch_vccz L_go_294
    v_cmp_u_f32 vcc, v27, v31
    s_cbranch_vccz L_go_294
    v_cmp_u_f32 vcc, v27, v31
    s_cbranch_vccz L_go_294
    v_cmp_u_f32 vcc, v27, v31
    s_cbranch_vccz L_go_294
    v_cmp_u_f32 vcc, v27, v31
    s_cbranch_vccz L_go_294
    v_cmp_u_f32 vcc, v27, v31
    s_cbranch_vccz L_go_294
    v_cmp_u_f32 vcc, v27, v31
    s_cbranch_vccz L_go_294
    v_cmp_u_f32 vcc, v27, v31
    s_cbranch_vccnz L_spin_293
L_go_294:
    v_pk_add_f32 v[8:9], v[24:25], v[28:29]
    v_pk_add_f32 v[10:11], v[26:27], v[30:31]
    s_nop 1
    v_permlane32_swap_b32 v8, v10
    v_permlane32_swap_b32 v9, v11
    v_add_f32 v8, v8, v10
    v_add_f32 v9, v9, v11
    s_nop 1
    v_permlane16_swap_b32 v8, v9
    v_add_f32 v8, v8, v9
    s_nop 1
    v_add_f32_dpp v8, v8, v8 row_ror:8 row_mask:0xf bank_mask:0xf
    v_add_f32 v8, v8, v4
    v_cvt_pk_bf16_f32 v9, v8, v8
    v_cmp_u_f32 vcc, v8, v8
    s_cbranch_vccnz L_spin_293
    buffer_store_short v9, v13, s[48:51], s73 offen
    s_endpgm
L_retry_184:
    s_add_u32 s80, s80, 1
    s_cmp_ge_u32 s80, 1048576
    s_cbranch_scc1 L_abort
    s_nop 3
    buffer_load_dwordx4 v[40:43], v36, s[40:43], s76 offen sc1
    buffer_load_dwordx4 v[44:47], v37, s[40:43], s76 offen offset:1024 sc1
    buffer_load_dwordx4 v[26:29], v36, s[40:43], s77 offen sc1
    buffer_load_dwordx4 v[30:33], v37, s[40:43], s77 offen offset:1024 sc1
    s_waitcnt vmcnt(0)
    s_branch L_qw_183
L_retry_185:
    s_add_u32 s80, s80, 1
    s_cmp_ge_u32 s80, 1048576
    s_cbranch_scc1 L_abort
    s_nop 3
    buffer_load_dwordx4 v[40:43], v36, s[40:43], s76 offen sc1
    buffer_load_dwordx4 v[44:47], v37, s[40:43], s76 offen offset:1024 sc1
    buffer_load_dwordx4 v[26:29], v36, s[40:43], s77 offen sc1
    buffer_load_dwordx4 v[30:33], v37, s[40:43], s77 offen offset:1024 sc1
    s_waitcnt vmcnt(0)
    s_branch L_qw_183
L_retry_192:
    s_add_u32 s80, s80, 1
    s_cmp_ge_u32 s80, 1048576
    s_cbranch_scc1 L_abort
    s_nop 3
    buffer_load_dword v29, v28, s[40:43], 0 offen sc1
    s_waitcnt vmcnt(0)
    s_branch L_pz_191
L_mlr_206:
    s_add_u32 s80, s80, 1
    s_cmp_ge_u32 s80, 1048576
    s_cbranch_scc1 L_abort
    buffer_load_dwordx2 v[36:37], v33, s[40:43], s79 offen offset:2048 sc1
    s_waitcnt vmcnt(0)
    v_max_f32_dpp v9, v36, v36 row_ror:1 row_mask:0xf bank_mask:0xf
    s_nop 1
    v_max_f32_dpp v9, v9, v9 row_ror:2 row_mask:0xf bank_mask:0xf
    s_nop 1
    v_max_f32_dpp v9, v9, v9 row_ror:4 row_mask:0xf bank_mask:0xf
    v_sub_f32 v9, v36, v9
    v_exp_f32 v9, v9
    s_nop 0
    v_mul_f32 v11, v9, v37
    s_nop 1
    v_add_f32_dpp v11, v11, v11 row_ror:1 row_mask:0xf bank_mask:0xf
    s_nop 1
    v_add_f32_dpp v11, v11, v11 row_ror:2 row_mask:0xf bank_mask:0xf
    s_nop 1
    v_add_f32_dpp v11, v11, v11 row_ror:4 row_mask:0xf bank_mask:0xf
    v_rcp_f32 v11, v11
    s_nop 0
    v_mul_f32 v9, v9, v11
    s_nop 1
    v_mov_b32_dpp v36, v9 row_newbcast:0 row_mask:0xf bank_mask:0xf
    v_mov_b32_dpp v37, v9 row_newbcast:1 row_mask:0xf bank_mask:0xf
    v_mov_b32_dpp v72, v9 row_newbcast:2 row_mask:0xf bank_mask:0xf
    v_mov_b32_dpp v73, v9 row_newbcast:3 row_mask:0xf bank_mask:0xf
    s_nop 1
    s_branch L_mlw_205
L_idle_203:
    s_barrier
    v_mov_b32 v42, -1
    v_mov_b32 v43, -1
    v_mov_b32 v44, -1
    v_mov_b32 v45, -1
    s_mul_i32 s90, s60, 14
    s_add_u32 s90, s90, s61
    s_sub_u32 s90, s90, 18
    s_lshl_b32 s90, s90, 2
    s_add_u32 s90, s90, s3
    s_mul_i32 s90, s90, 256
    s_add_u32 s90, s90, 1048576
    s_cmp_lt_u32 s90, 1130496
    s_cselect_b32 s90, s90, 1073741824
    v_lshl_add_u32 v40, v0, 4, s90
    s_mov_b64 exec, 0xffff
    buffer_store_dwordx4 v[42:45], v40, s[40:43], 0 offen sc1
    s_mov_b64 exec, -1
    s_sub_u32 s90, s61, 18
    s_xor_b32 s92, s68, 1073741824
    s_lshl_b32 s90, s90, 2
    s_add_u32 s90, s90, s3
    s_mul_i32 s90, s90, 37
    v_min_u32 v40, 36, v0
    v_add_u32 v40, s90, v40
    v_min_u32 v40, 2047, v40
    v_add_u32 v40, 2048, v40
    v_lshrrev_b32 v41, 3, v40
    v_and_b32 v40, 7, v40
    v_lshlrev_b32 v40, 7, v40
    v_lshl_add_u32 v40, v41, 13, v40
    s_lshl_b32 s91, s60, 10
    v_add_u32 v40, s92, v40
    v_subrev_u32 v41, 37, v0
    v_ashrrev_i32 v41, 31, v41
    v_bfi_b32 v40, v41, v40, 2.0
    buffer_load_dword v3, v40, s[28:31], s91 offen
    v_mov_b32 v42, -1
    v_mov_b32 v43, -1
    v_mov_b32 v44, -1
    v_mov_b32 v45, -1
    v_lshlrev_b32 v40, 4, v0
    s_mul_i32 s90, s86, 6
    s_sub_u32 s90, s61, s90
    s_sub_u32 s90, s90, 18
    s_lshl_b32 s90, s90, 2
    s_add_u32 s90, s90, s3
    s_cmp_lt_u32 s90, 24
    s_cselect_b32 s92, 0, 1073741824
    v_add_u32 v40, s92, v40
    s_and_b32 s91, s90, 24
    s_add_u32 s91, s91, s90
    s_lshl_b32 s91, s91, 10
    s_and_b32 s92, s47, 0xfff82000
    s_add_u32 s91, s91, s92
    buffer_store_dwordx4 v[42:45], v40, s[40:43], s91 offen sc1
    s_add_u32 s91, s91, 49152
    buffer_store_dwordx4 v[42:45], v40, s[40:43], s91 offen sc1
    s_add_u32 s91, s91, 49152
    buffer_store_dwordx4 v[42:45], v40, s[40:43], s91 offen sc1
    s_add_u32 s91, s91, 49152
    buffer_store_dwordx4 v[42:45], v40, s[40:43], s91 offen sc1
    s_add_u32 s91, s91, 49152
    buffer_store_dwordx4 v[42:45], v40, s[40:43], s91 offen sc1
    s_add_u32 s91, s91, 49152
    buffer_store_dwordx4 v[42:45], v40, s[40:43], s91 offen sc1
    s_add_u32 s91, s91, 49152
    buffer_store_dwordx4 v[42:45], v40, s[40:43], s91 offen sc1
    s_add_u32 s91, s91, 49152
    buffer_store_dwordx4 v[42:45], v40, s[40:43], s91 offen sc1
    s_add_u32 s91, s91, 49152
    buffer_store_dwordx4 v[42:45], v40, s[40:43], s91 offen sc1
    s_add_u32 s91, s91, 49152
    buffer_store_dwordx4 v[42:45], v40, s[40:43], s91 offen sc1
    s_add_u32 s91, s91, 49152
    s_and_b32 s92, s90, 1
    s_lshl_b32 s92, s92, 10
    s_and_b32 s74, s1, 0xfffff800
    s_add_u32 s92, s92, s74
    s_cmp_lt_u32 s90, 16
    s_cselect_b32 s91, s91, s92
    buffer_store_dwordx4 v[42:45], v40, s[40:43], s91 offen sc1
    s_sub_u32 s90, s61, 18
    s_xor_b32 s92, s68, 1073741824
    s_lshl_b32 s90, s90, 2
    s_add_u32 s90, s90, s3
    s_mul_i32 s90, s90, 74
    v_min_u32 v40, 36, v0
    v_add_u32 v40, s90, v40
    v_min_u32 v40, 4095, v40
    v_lshrrev_b32 v41, 3, v40
    v_and_b32 v40, 7, v40
    v_lshlrev_b32 v40, 7, v40
    v_lshl_add_u32 v40, v41, 13, v40
    s_lshl_b32 s91, s60, 10
    v_add_u32 v40, s92, v40
    v_subrev_u32 v41, 37, v0
    v_ashrrev_i32 v41, 31, v41
    v_bfi_b32 v40, v41, v40, 2.0
    buffer_load_dword v3, v40, s[32:35], s91 offen
    v_min_u32 v40, 36, v0
    v_add_u32 v40, s90, v40
    v_add_u32 v40, 37, v40
    v_min_u32 v40, 4095, v40
    v_lshrrev_b32 v41, 3, v40
    v_and_b32 v40, 7, v40
    v_lshlrev_b32 v40, 7, v40
    v_lshl_add_u32 v40, v41, 13, v40
    s_lshl_b32 s91, s60, 10
    v_add_u32 v40, s92, v40
    v_subrev_u32 v41, 37, v0
    v_ashrrev_i32 v41, 31, v41
    v_bfi_b32 v40, v41, v40, 2.0
    buffer_load_dword v3, v40, s[32:35], s91 offen
    v_bfe_u32 v76, v0, 2, 3
    v_lshlrev_b32 v76, 10, v76
    v_lshrrev_b32 v77, 5, v0
    v_lshl_add_u32 v76, v77, 6, v76
    v_bfe_u32 v77, v0, 4, 1
    v_lshlrev_b32 v77, 1, v77
    v_xor_b32 v77, v0, v77
    v_and_b32 v77, 3, v77
    v_lshl_add_u32 v76, v77, 4, v76
    s_waitcnt vmcnt(15)
    s_barrier
    s_branch L_join_204
L_qidle_211:
    v_bfe_u32 v16, v0, 2, 3
    v_lshlrev_b32 v16, 13, v16
    v_lshrrev_b32 v17, 5, v0
    v_lshl_add_u32 v16, v17, 6, v16
    v_bfe_u32 v17, v0, 4, 1
    v_lshlrev_b32 v17, 1, v17
    v_xor_b32 v17, v0, v17
    v_and_b32 v17, 3, v17
    v_lshl_add_u32 v16, v17, 4, v16
    s_lshl_b32 s90, s63, 2
    s_add_u32 s90, s90, s3
    s_lshl_b32 s90, s90, 9
    s_lshr_b32 s91, s64, 21
    s_add_u32 s90, s90, s91
    s_lshl_b32 s90, s90, 8
    s_add_u32 m0, s66, 0
    s_add_u32 s91, s90, 0
    buffer_load_dwordx4 v16, s[28:31], s91 offen  lds
    s_add_u32 m0, s66, 896
    s_nop 0
    buffer_load_dwordx4 v16, s[28:31], s91 offen offset:128  lds
    s_add_u32 m0, s66, 2048
    s_add_u32 s91, s90, 65536
    buffer_load_dwordx4 v16, s[28:31], s91 offen  lds
    s_add_u32 m0, s66, 2944
    s_nop 0
    buffer_load_dwordx4 v16, s[28:31], s91 offen offset:128  lds
    v_lshlrev_b32 v36, 4, v0
    v_and_b32 v37, 32, v0
    v_lshl_add_u32 v37, v37, 26, v36
    v_mov_b32 v40, -1
    v_mov_b32 v41, -1
    v_mov_b32 v42, -1
    v_mov_b32 v43, -1
    v_mov_b32 v44, -1
    v_mov_b32 v45, -1
    v_mov_b32 v46, -1
    v_mov_b32 v47, -1
    s_lshl_b32 s76, s60, 8
    s_add_u32 s76, s76, 901120
    v_lshrrev_b32 v12, 5, v0
    v_lshlrev_b32 v12, 7, v12
    v_mov_b32 v24, -1
    buffer_load_dword v24, v12, s[40:43], s76 offen sc1
    s_mov_b32 s80, 0
L_spin_216:
    buffer_load_dword v24, v12, s[40:43], s76 offen sc1
    s_add_u32 s80, s80, 1024
    s_cbranch_scc1 L_abort
    s_waitcnt vmcnt(1)
    v_cmp_u_f32 vcc, v24, v24
    s_cbranch_vccnz L_spin_216
    s_waitcnt vmcnt(0)
    s_branch L_qjoin_212
L_redo_224:
    s_waitcnt vmcnt(0) lgkmcnt(0)
    s_barrier
    v_bfe_u32 v72, v0, 2, 3
    v_lshlrev_b32 v72, 11, v72
    v_lshrrev_b32 v73, 5, v0
    v_lshl_add_u32 v72, v73, 6, v72
    v_bfe_u32 v73, v0, 4, 1
    v_lshlrev_b32 v73, 1, v73
    v_xor_b32 v73, v0, v73
    v_and_b32 v73, 3, v73
    v_lshl_add_u32 v72, v73, 4, v72
    v_and_b32 v74, 0x2000, v72
    v_add_u32 v72, v72, v74
    v_add_u32 v74, 32768, v72
    s_mov_b32 s71, 147456
    v_and_b32 v76, 7, v0
    v_lshlrev_b32 v76, 6, v76
    v_bfe_u32 v77, v0, 3, 1
    v_lshl_add_u32 v76, v77, 11, v76
    v_lshlrev_b32 v77, 3, v0
    v_and_b32 v77, 32, v77
    v_xor_b32 v77, v0, v77
    v_and_b32 v77, 48, v77
    v_add3_u32 v76, v76, v77, s71
    s_lshl_b32 s70, s3, 12
    s_sub_u32 s70, s70, 65536
    v_add_u32 v77, s70, v76
    v_lshlrev_b32 v73, 6, v0
    v_bfe_u32 v75, v0, 1, 3
    v_lshl_add_u32 v73, v75, 2, v73
    v_add_u32 v73, s88, v73
    v_mov_b32 v3, 1073741824
    v_mov_b32 v75, 1073741824
    s_add_u32 m0, s88, 0
    s_nop 0
    buffer_load_dwordx4 v72, s[40:43], s76 offen offset:0 sc1 lds
    s_add_u32 m0, s88, 896
    s_nop 0
    buffer_load_dwordx4 v72, s[40:43], s76 offen offset:128 sc1 lds
    s_add_u32 m0, s88, 2048
    s_nop 0
    buffer_load_dwordx4 v74, s[40:43], s76 offen offset:0 sc1 lds
    s_add_u32 m0, s88, 2944
    s_nop 0
    buffer_load_dwordx4 v74, s[40:43], s76 offen offset:128 sc1 lds
    ds_read_b128 v[32:35], v77 offset:0
    ds_read_b128 v[36:39], v77 offset:512
    ds_read_b128 v[40:43], v77 offset:1024
    ds_read_b128 v[44:47], v77 offset:1536
    ds_read_b128 v[48:51], v77 offset:16384
    ds_read_b128 v[52:55], v77 offset:16896
    ds_read_b128 v[56:59], v77 offset:17408
    ds_read_b128 v[60:63], v77 offset:17920
    ds_read_b128 v[64:67], v77 offset:32768
    ds_read_b128 v[68:71], v77 offset:33280
    s_branch L_qaa_223
L_retry_229:
    s_add_u32 s80, s80, 1
    s_cmp_ge_u32 s80, 1048576
    s_cbranch_scc1 L_abort
    s_nop 3
    buffer_load_dwordx4 v[8:11], v72, s[40:43], s0 offen sc1
    buffer_load_dwordx4 v[12:15], v72, s[40:43], s95 offen sc1
    buffer_load_dwordx4 v[16:19], v72, s[40:43], s96 offen sc1
    buffer_load_dwordx4 v[20:23], v72, s[40:43], s97 offen sc1
    s_waitcnt vmcnt(0)
    s_branch L_paw_228
L_idle_236:
    s_barrier
    v_mov_b32 v42, -1
    v_mov_b32 v43, -1
    v_mov_b32 v44, -1
    v_mov_b32 v45, -1
    s_mul_i32 s90, s60, 14
    s_add_u32 s90, s90, s61
    s_sub_u32 s90, s90, 18
    s_lshl_b32 s90, s90, 2
    s_add_u32 s90, s90, s3
    s_mul_i32 s90, s90, 1024
    s_add_u32 s90, s90, 1130496
    s_cmp_lt_u32 s90, 1572864
    s_cselect_b32 s90, s90, 1073741824
    v_lshl_add_u32 v40, v0, 4, s90
    buffer_store_dwordx4 v[42:45], v40, s[40:43], 0 offen sc1
    s_mov_b64 exec, -1
    v_bfe_u32 v76, v0, 4, 1
    v_bfe_u32 v77, v0, 2, 2
    v_lshl_add_u32 v76, v76, 3, v77
    v_mul_u32_u24 v76, 8192, v76
    v_lshrrev_b32 v77, 5, v0
    v_lshl_add_u32 v76, v77, 6, v76
    v_bfe_u32 v77, v0, 4, 1
    v_lshlrev_b32 v77, 1, v77
    v_xor_b32 v77, v0, v77
    v_and_b32 v77, 3, v77
    v_lshl_add_u32 v76, v77, 4, v76
    s_and_b32 s90, s3, 1
    s_mul_i32 s90, s90, 131008
    s_add_u32 s90, s90, s67
    v_add_u32 v76, s90, v76
    s_waitcnt vmcnt(1)
    s_barrier
    s_branch L_join_237
L_qidle_242:
    v_bfe_u32 v72, v0, 2, 3
    v_lshlrev_b32 v72, 10, v72
    v_lshrrev_b32 v60, 5, v0
    v_lshl_add_u32 v72, v60, 6, v72
    v_bfe_u32 v60, v0, 4, 1
    v_lshlrev_b32 v60, 1, v60
    v_xor_b32 v60, v0, v60
    v_and_b32 v60, 3, v60
    v_lshl_add_u32 v72, v60, 4, v72
    v_bfe_u32 v73, v0, 4, 1
    v_bfe_u32 v60, v0, 2, 2
    v_lshl_add_u32 v73, v73, 3, v60
    v_mul_u32_u24 v73, 1152, v73
    v_lshrrev_b32 v60, 5, v0
    v_lshl_add_u32 v73, v60, 6, v73
    v_bfe_u32 v60, v0, 4, 1
    v_lshlrev_b32 v60, 1, v60
    v_xor_b32 v60, v0, v60
    v_and_b32 v60, 3, v60
    v_lshl_add_u32 v73, v60, 4, v73
    s_and_b32 s90, s3, 1
    s_mul_i32 s90, s90, 18368
    s_add_u32 s90, s90, s68
    v_add_u32 v73, s90, v73
    v_lshrrev_b32 v74, 5, v0
    v_lshlrev_b32 v74, 11, v74
    v_bfe_u32 v75, v0, 2, 3
    v_lshl_add_u32 v74, v75, 6, v74
    v_bfe_u32 v75, v0, 4, 1
    v_lshl_add_u32 v74, v75, 5, v74
    v_and_b32 v75, 3, v0
    v_lshl_add_u32 v74, v75, 3, v74
    v_add_u32 v74, s65, v74
    v_xor_b32 v75, 32, v74
    v_mov_b64 v[60:61], 0
    v_mov_b64 v[62:63], 0
    v_mov_b64 v[64:65], 0
    v_mov_b64 v[66:67], 0
    v_mov_b64 v[68:69], 0
    v_mov_b64 v[70:71], 0
    v_lshlrev_b32 v36, 4, v0
    v_and_b32 v37, 32, v0
    v_lshl_add_u32 v37, v37, 26, v36
    v_mov_b32 v40, -1
    v_mov_b32 v41, -1
    v_mov_b32 v42, -1
    v_mov_b32 v43, -1
    v_mov_b32 v44, -1
    v_mov_b32 v45, -1
    v_mov_b32 v46, -1
    v_mov_b32 v47, -1
    s_lshl_b32 s76, s60, 8
    s_add_u32 s76, s76, 970752
    v_lshrrev_b32 v12, 5, v0
    v_lshlrev_b32 v12, 7, v12
    v_mov_b32 v24, -1
    buffer_load_dword v24, v12, s[40:43], s76 offen sc1
    s_mov_b32 s80, 0
L_spin_247:
    buffer_load_dword v24, v12, s[40:43], s76 offen sc1
    s_add_u32 s80, s80, 1024
    s_cbranch_scc1 L_abort
    s_waitcnt vmcnt(1)
    v_cmp_u_f32 vcc, v24, v24
    s_cbranch_vccnz L_spin_247
    s_waitcnt vmcnt(0)
    s_branch L_qjoin_243
L_mlagain_259:
    buffer_load_dwordx2 v[72:73], v33, s[40:43], s79 offen offset:2048 sc1
    s_branch L_spin_256
L_idle_254:
    v_bfe_u32 v208, v0, 4, 1
    v_bfe_u32 v209, v0, 2, 2
    v_lshl_add_u32 v208, v208, 3, v209
    v_mul_u32_u24 v208, 8192, v208
    v_lshrrev_b32 v209, 5, v0
    v_lshl_add_u32 v208, v209, 6, v208
    v_bfe_u32 v209, v0, 4, 1
    v_lshlrev_b32 v209, 1, v209
    v_xor_b32 v209, v0, v209
    v_and_b32 v209, 3, v209
    v_lshl_add_u32 v208, v209, 4, v208
    s_and_b32 s90, s3, 1
    s_mul_i32 s90, s90, 131008
    s_add_u32 s90, s90, s67
    v_add_u32 v208, s90, v208
    s_waitcnt vmcnt(0)
    s_barrier
    s_branch L_join_255
L_qidle_261:
    v_lshlrev_b32 v36, 4, v0
    v_and_b32 v37, 32, v0
    v_lshl_add_u32 v37, v37, 26, v36
    v_mov_b32 v40, -1
    v_mov_b32 v41, -1
    v_mov_b32 v42, -1
    v_mov_b32 v43, -1
    v_mov_b32 v44, -1
    v_mov_b32 v45, -1
    v_mov_b32 v46, -1
    v_mov_b32 v47, -1
    s_lshl_b32 s76, s60, 8
    s_add_u32 s76, s76, 1048576
    v_lshrrev_b32 v12, 5, v0
    v_lshlrev_b32 v12, 7, v12
    v_mov_b32 v24, -1
    buffer_load_dword v24, v12, s[40:43], s76 offen sc1
    s_mov_b32 s80, 0
L_spin_266:
    buffer_load_dword v24, v12, s[40:43], s76 offen sc1
    s_add_u32 s80, s80, 1024
    s_cbranch_scc1 L_abort
    s_waitcnt vmcnt(1)
    v_cmp_u_f32 vcc, v24, v24
    s_cbranch_vccnz L_spin_266
    s_waitcnt vmcnt(0)
    s_branch L_qjoin_262
L_redo_274:
    s_waitcnt vmcnt(0) lgkmcnt(0)
    s_barrier
    v_bfe_u32 v72, v0, 2, 3
    v_lshlrev_b32 v72, 11, v72
    v_lshrrev_b32 v73, 5, v0
    v_lshl_add_u32 v72, v73, 6, v72
    v_bfe_u32 v73, v0, 4, 1
    v_lshlrev_b32 v73, 1, v73
    v_xor_b32 v73, v0, v73
    v_and_b32 v73, 3, v73
    v_lshl_add_u32 v72, v73, 4, v72
    v_and_b32 v74, 0x2000, v72
    v_add_u32 v72, v72, v74
    v_add_u32 v74, 32768, v72
    s_mov_b32 s71, 147456
    v_and_b32 v76, 7, v0
    v_lshlrev_b32 v76, 6, v76
    v_bfe_u32 v77, v0, 3, 1
    v_lshl_add_u32 v76, v77, 11, v76
    v_lshlrev_b32 v77, 3, v0
    v_and_b32 v77, 32, v77
    v_xor_b32 v77, v0, v77
    v_and_b32 v77, 48, v77
    v_add3_u32 v76, v76, v77, s71
    s_lshl_b32 s70, s3, 12
    s_sub_u32 s70, s70, 65536
    v_add_u32 v77, s70, v76
    v_lshlrev_b32 v73, 6, v0
    v_bfe_u32 v75, v0, 1, 3
    v_lshl_add_u32 v73, v75, 2, v73
    v_add_u32 v73, s88, v73
    v_mov_b32 v3, 1073741824
    v_mov_b32 v75, 1073741824
    s_add_u32 m0, s88, 0
    s_nop 0
    buffer_load_dwordx4 v72, s[40:43], s76 offen offset:0 sc1 lds
    s_add_u32 m0, s88, 896
    s_nop 0
    buffer_load_dwordx4 v72, s[40:43], s76 offen offset:128 sc1 lds
    s_add_u32 m0, s88, 2048
    s_nop 0
    buffer_load_dwordx4 v74, s[40:43], s76 offen offset:0 sc1 lds
    s_add_u32 m0, s88, 2944
    s_nop 0
    buffer_load_dwordx4 v74, s[40:43], s76 offen offset:128 sc1 lds
    ds_read_b128 v[80:83], v77 offset:0
    ds_read_b128 v[84:87], v77 offset:512
    ds_read_b128 v[88:91], v77 offset:1024
    ds_read_b128 v[92:95], v77 offset:1536
    ds_read_b128 v[96:99], v77 offset:16384
    ds_read_b128 v[100:103], v77 offset:16896
    ds_read_b128 v[104:107], v77 offset:17408
    ds_read_b128 v[108:111], v77 offset:17920
    ds_read_b128 v[112:115], v77 offset:32768
    ds_read_b128 v[116:119], v77 offset:33280
    ds_read_b128 v[120:123], v77 offset:33792
    ds_read_b128 v[124:127], v77 offset:34304
    ds_read_b128 v[128:131], v77 offset:49152
    ds_read_b128 v[132:135], v77 offset:49664
    ds_read_b128 v[136:139], v77 offset:50176
    ds_read_b128 v[140:143], v77 offset:50688
    s_branch L_qaa_273
L_retry_279:
    s_add_u32 s80, s80, 1
    s_cmp_ge_u32 s80, 1048576
    s_cbranch_scc1 L_abort
    s_nop 3
    buffer_load_dwordx4 v[8:11], v72, s[40:43], s0 offen sc1
    buffer_load_dwordx4 v[12:15], v72, s[40:43], s95 offen sc1
    buffer_load_dwordx4 v[16:19], v72, s[40:43], s96 offen sc1
    buffer_load_dwordx4 v[20:23], v72, s[40:43], s97 offen sc1
    s_waitcnt vmcnt(0)
    s_branch L_paw_278
L_idle_286:
    s_waitcnt vmcnt(0)
    s_barrier
    s_branch L_join_287
L_end_slow:
    s_endpgm

.section .rodata,"a"
.p2align 6
.amdhsa_kernel interleave_layers__mha_block_cached__compressed_kv_cla__decode_kernel
  .amdhsa_next_free_vgpr 512
  .amdhsa_next_free_sgpr 102
  .amdhsa_accum_offset 256
  .amdhsa_group_segment_fixed_size 0
  .amdhsa_kernarg_size 112
  .amdhsa_user_sgpr_count 2
  .amdhsa_user_sgpr_kernarg_segment_ptr 1
  .amdhsa_system_sgpr_workgroup_id_x 1
.end_amdhsa_kernel
```
